```python
import torch

def _softmax(x, axis=-1):
    return torch.softmax(x, dim=axis)

def _gelu(x):
    return torch.nn.functional.gelu(x, approximate='tanh')

def _silu(x):
    return torch.nn.functional.silu(x)

def _sigmoid(x):
    return torch.sigmoid(x)

def _layernorm(x, axis=-1, eps=1e-05):
    m = x.mean(dim=axis, keepdim=True)
    v = x.var(dim=axis, keepdim=True, unbiased=False)
    return (x - m) / torch.sqrt(v + eps)

def _scatter_add(tgt, idx, src, axis=0):
    return tgt.clone().index_add_(axis, idx, src)

def _segment_sum(src, seg, n):
    out = torch.zeros((n,) + src.shape[1:], dtype=src.dtype)
    return out.index_add_(0, seg, src)

def _pad(x, pw):
    flat = tuple((v for pair in reversed(pw) for v in pair))
    return torch.nn.functional.pad(x, flat)
kernel_name = 'interleave_layers__linear_attn_block__mixer_gmlp__prompt'

def setup_inputs():

    _w = lambda a: (lambda t: t.to(torch.bfloat16) if t.is_floating_point() else t)(torch.as_tensor(a))

    def _A_setup():
        B, S, D = (1, 2048, 640)
        return {'x': _w((lambda *s: torch.randn(*s, dtype=torch.bfloat16) * 0.05)(B, S, D)), 'wqkv': _w((lambda *s: torch.randn(*s, dtype=torch.bfloat16) * 0.05)(D, 3 * D)), 'wo': _w((lambda *s: torch.randn(*s, dtype=torch.bfloat16) * 0.05)(D, D))}
    _A_in = _A_setup()

    def _B_setup():
        B, S, D, F = (1, 2048, 640, 1536)
        Fh = F // 2
        return {'x': _w((lambda *s: torch.randn(*s, dtype=torch.bfloat16) * 0.05)(B, S, D)), 'w_in': _w((lambda *s: torch.randn(*s, dtype=torch.bfloat16) * 0.2)(D, 2 * Fh)), 'w_sp': _w(0.01 * (lambda *s: torch.randn(*s, dtype=torch.bfloat16) * 0.2)(S, S)), 'b_sp': _w(1.0 + 0.01 * (lambda *s: torch.randn(*s, dtype=torch.bfloat16) * 0.05)(S)), 'w_out': _w((lambda *s: torch.randn(*s, dtype=torch.bfloat16) * 0.05)(Fh, D))}
    _B_in = _B_setup()
    return {'A_x': _A_in['x'], 'A_wqkv': _A_in['wqkv'], 'A_wo': _A_in['wo'], 'B_x': _B_in['x'], 'B_w_in': _B_in['w_in'], 'B_w_sp': _B_in['w_sp'], 'B_b_sp': _B_in['b_sp'], 'B_w_out': _B_in['w_out']}

def reference(A_x, A_wqkv, A_wo, B_x, B_w_in, B_w_sp, B_b_sp, B_w_out):

    def _A_ref(x, wqkv, wo):
        B, S, D = x.shape
        H = 32
        Dh = D // H
        qkv = (lambda x, *d: x.permute(*d))((x @ wqkv).reshape(B, S, 3, H, Dh), 2, 0, 3, 1, 4)
        q, k, v = (qkv[0], qkv[1], qkv[2])
        phi = lambda t: torch.where(t > 0, t + 1, torch.exp(t)) + 1e-06
        pq, pk = (phi(q), phi(k))
        kv = torch.einsum('bhsd,bhse->bhde', pk, v)
        z = torch.einsum('bhsd->bhd', pk)
        num = torch.einsum('bhqd,bhde->bhqe', pq, kv)
        den = torch.einsum('bhqd,bhd->bhq', pq, z)[..., None] + 1e-06
        o = num / den
        return (lambda x, *d: x.permute(*d))(o, 0, 2, 1, 3).reshape(B, S, D) @ wo

    def _B_ref(x, w_in, w_sp, b_sp, w_out):
        B, S, D = x.shape
        F = w_in.shape[-1]
        Fh = F // 2
        z = _gelu(torch.einsum('bsd,df->bsf', x, w_in))
        z1 = z[..., :Fh].clone()
        z2 = _layernorm(z[..., Fh:], axis=-1)
        g = torch.einsum('ts,bsf->btf', w_sp, z2) + b_sp[None, :, None]
        return torch.einsum('bsf,fd->bsd', z1 * g, w_out)
    x = A_x
    x = x + _A_ref(_layernorm(x, axis=-1), A_wqkv, A_wo)
    x = x + _B_ref(_layernorm(x, axis=-1), B_w_in, B_w_sp, B_b_sp, B_w_out)
    x = x + _A_ref(_layernorm(x, axis=-1), A_wqkv, A_wo)
    x = x + _B_ref(_layernorm(x, axis=-1), B_w_in, B_w_sp, B_b_sp, B_w_out)
    return x
```

```asm
; @launch grid=(256,1,1) block=(256,1,1) lds=163840
.amdgcn_target "amdgcn-amd-amdhsa--gfx950"
.text
.globl interleave_layers__linear_attn_block__mixer_gmlp__prompt_kernel
.p2align 8
.type interleave_layers__linear_attn_block__mixer_gmlp__prompt_kernel,@function
interleave_layers__linear_attn_block__mixer_gmlp__prompt_kernel:
    s_cmp_ge_u32 s2, 256
    s_cbranch_scc1 LEND
    s_load_dwordx16 s[64:79], s[0:1], 0
    s_load_dwordx4 s[88:91], s[0:1], 64
    s_load_dwordx2 s[92:93], s[0:1], 80
    s_getpc_b64 s[60:61]
    s_lshr_b32 s46, s2, 3
    s_lshl_b32 s62, s46, 4
    v_lshrrev_b32 v24, 6, v0
    v_and_b32 v25, 3, v0
    v_lshl_add_u32 v25, v24, 2, v25
    v_add_lshl_u32 v25, v25, s62, 7
    v_min_u32 v25, LCODE_END - interleave_layers__linear_attn_block__mixer_gmlp__prompt_kernel - 64, v25
    global_load_dword v135, v25, s[60:61]
    s_getreg_b32 s59, hwreg(HW_REG_XCC_ID, 0, 4)
    v_and_b32 v15, 63, v0
    v_lshlrev_b32 v1, 4, v15
    v_readfirstlane_b32 s44, v24
    v_lshrrev_b32 v22, 4, v15
    v_and_b32 v23, 15, v15
    v_mov_b32 v36, 0x40000000
    s_and_b32 s45, s2, 7
    s_lshr_b32 s53, s46, 4
    s_and_b32 s54, s46, 15
    s_lshr_b32 s55, s46, 3
    s_and_b32 s56, s46, 7
    s_lshl_b32 s60, s45, 4
    s_lshl_b32 s61, s53, 3
    s_add_u32 s57, s60, s61
    s_lshl_b32 s61, s44, 1
    s_add_u32 s57, s57, s61
    s_lshl_b32 s61, s55, 2
    s_add_u32 s58, s60, s61
    s_add_u32 s58, s58, s44
    s_lshl_b32 s81, s44, 10
    s_lshl_b32 s86, s44, 13
    s_mul_i32 s87, s57, 20480
    v_add_u32 v26, 0, v22
    v_xor_b32 v26, v26, v23
    v_lshlrev_b32 v26, 4, v26
    v_mul_u32_u24 v27, 1280, v22
    v_add_u32 v100, v26, v27
    v_add_u32 v26, 4, v22
    v_xor_b32 v26, v26, v23
    v_lshlrev_b32 v26, 4, v26
    v_mul_u32_u24 v27, 1280, v22
    v_add_u32 v101, v26, v27
    v_add_u32 v26, 8, v22
    v_xor_b32 v26, v26, v23
    v_lshlrev_b32 v26, 4, v26
    v_mul_u32_u24 v27, 1280, v22
    v_add_u32 v102, v26, v27
    v_add_u32 v26, 12, v22
    v_xor_b32 v26, v26, v23
    v_lshlrev_b32 v26, 4, v26
    v_mul_u32_u24 v27, 1280, v22
    v_add_u32 v103, v26, v27
    v_mov_b32 v28, -1
    v_mov_b32 v29, -1
    v_mov_b32 v30, -1
    v_mov_b32 v31, -1
    s_lshl_b32 s60, s54, 4
    s_lshl_b32 s61, s45, 1
    s_add_u32 s60, s60, s61
    s_add_u32 s60, s60, s53
    s_mul_i32 s60, s60, 1792
    s_lshr_b32 s61, s44, 1
    s_mul_i32 s61, s61, 458752
    s_add_u32 s60, s60, s61
    s_and_b32 s61, s44, 1
    s_mul_i32 s61, s61, 896
    s_add_u32 s60, s60, s61
    s_add_u32 s60, s60, 32768
    v_add_u32 v33, s60, v1
    v_cmp_gt_u32 vcc, 56, v15
    s_nop 1
    v_cndmask_b32 v33, v36, v33, vcc
    s_lshr_b32 s60, s57, 1
    s_lshl_b32 s60, s60, 4
    s_add_u32 s60, s60, s54
    s_lshl_b32 s60, s60, 8
    s_add_u32 s60, s60, 950272
    v_mul_u32_u24 v35, 262144, v22
    v_lshl_add_u32 v35, v23, 4, v35
    v_add_u32 v35, s60, v35
    v_cmp_gt_u32 vcc, 32, v15
    s_nop 1
    v_cndmask_b32 v35, v36, v35, vcc
    s_lshl_b32 s60, s2, 12
    s_add_u32 s60, s60, 0
    s_lshl_b32 s61, s2, 2
    s_add_u32 s61, s61, s44
    s_and_b32 s62, s61, 0x3e3
    s_cmp_eq_u32 s62, 3
    s_cselect_b32 s63, s60, 0x40000000
    s_waitcnt lgkmcnt(0)
    s_mov_b32 s4, s92
    s_and_b32 s5, s93, 0xffff
    s_mov_b32 s6, 0x1176000
    s_mov_b32 s7, 0x20000
    s_mov_b32 s8, s64
    s_and_b32 s9, s65, 0xffff
    s_mov_b32 s10, 0x280000
    s_mov_b32 s11, 0x20000
    buffer_load_dwordx4 v[104:107], v1, s[4:7], s63 offen offset:0 sc1
    buffer_load_dwordx4 v[108:111], v1, s[4:7], s63 offen offset:1024 sc1
    buffer_load_dwordx4 v[112:115], v1, s[4:7], s63 offen offset:2048 sc1
    buffer_load_dwordx4 v[116:119], v1, s[4:7], s63 offen offset:3072 sc1
    s_mov_b32 s12, s66
    s_and_b32 s13, s67, 0xffff
    s_mov_b32 s14, 0x258000
    s_mov_b32 s15, 0x20000
    s_mul_i32 s60, s2, 9600
    s_mul_i32 s61, s44, 2400
    s_add_u32 s60, s60, s61
    buffer_load_dwordx4 v[120:123], v1, s[12:15], s60 offen offset:0
    buffer_load_dwordx4 v[124:127], v1, s[12:15], s60 offen offset:1024
    buffer_load_dwordx4 v[120:123], v1, s[12:15], s60 offen offset:1376
    s_add_u32 s80, s87, 0
    s_add_u32 m0, s86, 65536
    s_nop 0
    buffer_load_dwordx4 v100, s[8:11], s80 offen nt lds
    s_add_u32 s80, s87, 5120
    s_add_u32 m0, s86, 66560
    s_nop 0
    buffer_load_dwordx4 v101, s[8:11], s80 offen nt lds
    s_add_u32 s80, s87, 10240
    s_add_u32 m0, s86, 67584
    s_nop 0
    buffer_load_dwordx4 v102, s[8:11], s80 offen nt lds
    s_add_u32 s80, s87, 15360
    s_add_u32 m0, s86, 68608
    s_nop 0
    buffer_load_dwordx4 v103, s[8:11], s80 offen nt lds
    s_add_u32 s80, s87, 20480
    s_add_u32 m0, s86, 69632
    s_nop 0
    buffer_load_dwordx4 v100, s[8:11], s80 offen nt lds
    s_add_u32 s80, s87, 25600
    s_add_u32 m0, s86, 70656
    s_nop 0
    buffer_load_dwordx4 v101, s[8:11], s80 offen nt lds
    s_add_u32 s80, s87, 30720
    s_add_u32 m0, s86, 71680
    s_nop 0
    buffer_load_dwordx4 v102, s[8:11], s80 offen nt lds
    s_add_u32 s80, s87, 35840
    s_add_u32 m0, s86, 72704
    s_nop 0
    buffer_load_dwordx4 v103, s[8:11], s80 offen nt lds
    buffer_store_dwordx4 v[28:31], v33, s[4:7], 0 offen sc1
    buffer_store_dwordx4 v[28:31], v35, s[4:7], 0 offen sc1
    s_mov_b32 s16, s68
    s_and_b32 s17, s69, 0xffff
    s_mov_b32 s18, 0xc8000
    s_mov_b32 s19, 0x20000
    s_mov_b32 s20, s72
    s_and_b32 s21, s73, 0xffff
    s_mov_b32 s22, 0x1e0000
    s_mov_b32 s23, 0x20000
    s_mov_b32 s24, s74
    s_and_b32 s25, s75, 0xffff
    s_mov_b32 s26, 0x800000
    s_mov_b32 s27, 0x20000
    s_mov_b32 s28, s76
    s_and_b32 s29, s77, 0xffff
    s_mov_b32 s30, 0x1000
    s_mov_b32 s31, 0x20000
    s_mov_b32 s32, s78
    s_and_b32 s33, s79, 0xffff
    s_mov_b32 s34, 0xf0000
    s_mov_b32 s35, 0x20000
    s_mov_b32 s36, s88
    s_and_b32 s37, s89, 0xffff
    s_mov_b32 s38, 0x280000
    s_mov_b32 s39, 0x20000
    s_mov_b32 s40, s90
    s_and_b32 s41, s91, 0xffff
    s_mov_b32 s42, 0x100
    s_mov_b32 s43, 0x20000
    s_mov_b32 s93, s63
    s_mul_i32 s64, s2, 171
    s_lshr_b32 s64, s64, 11
    s_mul_i32 s60, s64, 12
    s_sub_u32 s65, s2, s60
    s_lshl_b32 s65, s65, 2
    s_add_u32 s65, s65, s44
    s_lshl_b32 s65, s65, 1
    s_cmp_lt_u32 s2, 240
    s_cselect_b32 s66, 0, 0x40000000
    v_and_b32 v87, 1, v23
    v_lshl_add_u32 v39, v22, 3, v87
    v_mul_u32_u24 v39, 3072, v39
    s_mul_i32 s75, s64, 98304
    s_add_u32 s75, s75, s66
    s_add_u32 s63, s65, 0
    s_cmp_ge_u32 s63, 48
    s_cselect_b32 s60, 48, 0
    s_sub_u32 s63, s63, s60
    s_mul_i32 s67, s63, 43
    s_lshr_b32 s67, s67, 7
    s_mul_i32 s60, s67, 3
    s_sub_u32 s68, s63, s60
    s_mul_i32 s76, s67, 122880
    s_lshl_b32 s60, s68, 10
    s_add_u32 s76, s76, s60
    s_mul_i32 s60, s64, 3072
    s_add_u32 s76, s76, s60
    s_add_u32 s76, s76, 4874240
    s_add_u32 s76, s76, s66
    s_mul_i32 s69, s67, 20
    s_add_u32 s69, s69, s64
    s_mul_i32 s69, s69, 384
    s_lshl_b32 s60, s68, 6
    s_add_u32 s69, s69, s60
    s_add_u32 s69, s69, 1474560
    s_add_u32 s69, s69, s66
    s_cmp_ge_u32 s65, 48
    s_cbranch_scc1 Lz2b_1
    s_add_u32 s76, s76, 61440
    s_add_u32 s69, s69, 192
    s_mul_i32 s63, s67, 48
    s_lshr_b32 s61, s68, 1
    s_lshl_b32 s61, s61, 5
    s_add_u32 s60, s63, s61
    s_and_b32 s61, s68, 1
    s_lshl_b32 s61, s61, 2
    s_add_u32 s60, s60, s61
    s_cmp_eq_u32 s68, 2
    s_cselect_b32 s62, 4, 8
    v_lshrrev_b32 v40, 2, v23
    v_and_b32 v38, 2, v23
    v_mad_u32_u24 v38, v40, s62, v38
    v_add_lshl_u32 v38, v38, s60, 1
    s_branch Lcdone_2
Lz2b_1:
    s_lshr_b32 s63, s67, 1
    s_mul_i32 s63, s63, 96
    s_add_u32 s63, s63, 768
    s_and_b32 s60, s67, 1
    s_mul_i32 s60, s60, 3
    s_add_u32 s68, s68, s60
    s_lshr_b32 s61, s68, 1
    s_lshl_b32 s61, s61, 5
    s_add_u32 s60, s63, s61
    s_and_b32 s61, s68, 1
    s_lshl_b32 s61, s61, 2
    s_add_u32 s60, s60, s61
    s_cmp_eq_u32 s68, 99
    s_cselect_b32 s62, 4, 8
    v_lshrrev_b32 v40, 2, v23
    v_and_b32 v38, 2, v23
    v_mad_u32_u24 v38, v40, s62, v38
    v_add_lshl_u32 v38, v38, s60, 1
Lcdone_2:
    v_add_u32 v80, v38, v39
    v_lshl_add_u32 v142, v23, 2, s69
    s_add_u32 s63, s65, 1
    s_cmp_ge_u32 s63, 48
    s_cselect_b32 s60, 48, 0
    s_sub_u32 s63, s63, s60
    s_mul_i32 s67, s63, 43
    s_lshr_b32 s67, s67, 7
    s_mul_i32 s60, s67, 3
    s_sub_u32 s68, s63, s60
    s_mul_i32 s77, s67, 122880
    s_lshl_b32 s60, s68, 10
    s_add_u32 s77, s77, s60
    s_mul_i32 s60, s64, 3072
    s_add_u32 s77, s77, s60
    s_add_u32 s77, s77, 4874240
    s_add_u32 s77, s77, s66
    s_mul_i32 s69, s67, 20
    s_add_u32 s69, s69, s64
    s_mul_i32 s69, s69, 384
    s_lshl_b32 s60, s68, 6
    s_add_u32 s69, s69, s60
    s_add_u32 s69, s69, 1474560
    s_add_u32 s69, s69, s66
    s_cmp_ge_u32 s65, 48
    s_cbranch_scc1 Lz2b_3
    s_add_u32 s77, s77, 61440
    s_add_u32 s69, s69, 192
    s_mul_i32 s63, s67, 48
    s_lshr_b32 s61, s68, 1
    s_lshl_b32 s61, s61, 5
    s_add_u32 s60, s63, s61
    s_and_b32 s61, s68, 1
    s_lshl_b32 s61, s61, 2
    s_add_u32 s60, s60, s61
    s_cmp_eq_u32 s68, 2
    s_cselect_b32 s62, 4, 8
    v_lshrrev_b32 v40, 2, v23
    v_and_b32 v38, 2, v23
    v_mad_u32_u24 v38, v40, s62, v38
    v_add_lshl_u32 v38, v38, s60, 1
    s_branch Lcdone_4
Lz2b_3:
    s_lshr_b32 s63, s67, 1
    s_mul_i32 s63, s63, 96
    s_add_u32 s63, s63, 768
    s_and_b32 s60, s67, 1
    s_mul_i32 s60, s60, 3
    s_add_u32 s68, s68, s60
    s_lshr_b32 s61, s68, 1
    s_lshl_b32 s61, s61, 5
    s_add_u32 s60, s63, s61
    s_and_b32 s61, s68, 1
    s_lshl_b32 s61, s61, 2
    s_add_u32 s60, s60, s61
    s_cmp_eq_u32 s68, 99
    s_cselect_b32 s62, 4, 8
    v_lshrrev_b32 v40, 2, v23
    v_and_b32 v38, 2, v23
    v_mad_u32_u24 v38, v40, s62, v38
    v_add_lshl_u32 v38, v38, s60, 1
Lcdone_4:
    v_add_u32 v81, v38, v39
    v_lshl_add_u32 v143, v23, 2, s69
    s_mul_i32 s64, s2, 205
    s_lshr_b32 s64, s64, 10
    s_mul_i32 s60, s64, 5
    s_sub_u32 s65, s2, s60
    s_lshl_b32 s65, s65, 2
    s_add_u32 s65, s65, s44
    s_lshl_b32 s65, s65, 1
    s_cmp_lt_u32 s2, 220
    s_cselect_b32 s78, 0, 0x40000000
    s_cmp_ge_u32 s64, 20
    s_cbranch_scc1 Lwout_5
    s_mov_b32 s66, 102400
    s_mov_b32 s67, 4055040
    s_mov_b32 s79, 19200
    s_mov_b32 s88, s16
    s_mov_b32 s89, s17
    s_mov_b32 s90, 819200
    s_lshl_b32 s60, s64, 2
    v_add_u32 v40, s60, v22
    v_mul_u32_u24 v41, 103, v40
    v_lshrrev_b32 v41, 9, v41
    v_mul_u32_u24 v42, 5, v41
    v_sub_u32 v40, v40, v42
    v_cmp_eq_u32 vcc, 4, v40
    s_nop 1
    v_cndmask_b32 v86, 0, 1, vcc
    v_cndmask_b32 v40, v40, 0, vcc
    v_mul_u32_u24 v40, 5, v40
    v_mad_u32_u24 v39, v41, 40, v40
    s_branch Lcdone_6
Lwout_5:
    s_sub_u32 s64, s64, 20
    s_mov_b32 s66, 122880
    s_mov_b32 s67, 6840320
    s_mov_b32 s79, 0
    s_mov_b32 s88, s32
    s_mov_b32 s89, s33
    s_mov_b32 s90, 983040
    s_lshl_b32 s60, s64, 5
    v_lshlrev_b32 v39, 3, v22
    v_add_u32 v39, s60, v39
    v_mov_b32 v86, 0
Lcdone_6:
    s_mov_b32 s91, 0x20000
    v_add_u32 v39, v39, v87
    v_mul_u32_u24 v39, 1280, v39
    s_mul_i32 s60, s64, 5120
    s_add_u32 s67, s67, s60
    s_add_u32 s67, s67, s78
    s_add_u32 s63, s65, 0
    s_mul_i32 s68, s63, 13
    s_lshr_b32 s68, s68, 6
    s_mul_i32 s60, s68, 5
    s_sub_u32 s69, s63, s60
    s_mul_i32 s84, s68, s66
    s_add_u32 s84, s84, s67
    s_lshl_b32 s60, s69, 10
    s_add_u32 s84, s84, s60
    s_mul_i32 s63, s68, 80
    s_lshr_b32 s61, s69, 1
    s_lshl_b32 s61, s61, 5
    s_add_u32 s60, s63, s61
    s_and_b32 s61, s69, 1
    s_lshl_b32 s61, s61, 2
    s_add_u32 s60, s60, s61
    s_cmp_eq_u32 s69, 4
    s_cselect_b32 s62, 4, 8
    v_lshrrev_b32 v40, 2, v23
    v_and_b32 v38, 2, v23
    v_mad_u32_u24 v38, v40, s62, v38
    v_add_lshl_u32 v38, v38, s60, 1
    v_add_u32 v84, v38, v39
    s_add_u32 s63, s65, 1
    s_mul_i32 s68, s63, 13
    s_lshr_b32 s68, s68, 6
    s_mul_i32 s60, s68, 5
    s_sub_u32 s69, s63, s60
    s_mul_i32 s85, s68, s66
    s_add_u32 s85, s85, s67
    s_lshl_b32 s60, s69, 10
    s_add_u32 s85, s85, s60
    s_mul_i32 s63, s68, 80
    s_lshr_b32 s61, s69, 1
    s_lshl_b32 s61, s61, 5
    s_add_u32 s60, s63, s61
    s_and_b32 s61, s69, 1
    s_lshl_b32 s61, s61, 2
    s_add_u32 s60, s60, s61
    s_cmp_eq_u32 s69, 4
    s_cselect_b32 s62, 4, 8
    v_lshrrev_b32 v40, 2, v23
    v_and_b32 v38, 2, v23
    v_mad_u32_u24 v38, v40, s62, v38
    v_add_lshl_u32 v38, v38, s60, 1
    v_add_u32 v85, v38, v39
    v_xor_b32 v25, 1, v86
    v_mul_u32_u24 v25, v25, v87
    v_mul_lo_u32 v25, v25, s79
    v_mov_b32 v141, 0x05040100
    v_mov_b32 v24, 0x03020706
    v_cmp_eq_u32 vcc, 1, v87
    s_nop 1
    v_cndmask_b32 v141, v141, v24, vcc
    s_mov_b32 s80, 29440
    v_mad_u32_u24 v24, v86, s80, v84
    s_add_u32 s80, s78, 0
    buffer_load_dword v224, v24, s[88:91], s80 offen nt
    s_mov_b32 s80, 33280
    v_mad_u32_u24 v24, v86, s80, v84
    s_add_u32 s80, s78, 2560
    buffer_load_dword v225, v24, s[88:91], s80 offen nt
    s_mov_b32 s80, 37120
    v_mad_u32_u24 v24, v86, s80, v84
    s_add_u32 s80, s78, 5120
    v_add_u32 v24, v24, v25
    buffer_load_dword v226, v24, s[88:91], s80 offen nt
    s_mov_b32 s80, 21760
    v_mad_u32_u24 v24, v86, s80, v84
    s_add_u32 s80, s78, 7680
    s_add_u32 s80, s80, s79
    buffer_load_dword v227, v24, s[88:91], s80 offen nt
    s_mov_b32 s80, 29440
    v_mad_u32_u24 v24, v86, s80, v85
    s_add_u32 s80, s78, 0
    buffer_load_dword v228, v24, s[88:91], s80 offen nt
    s_mov_b32 s80, 33280
    v_mad_u32_u24 v24, v86, s80, v85
    s_add_u32 s80, s78, 2560
    buffer_load_dword v229, v24, s[88:91], s80 offen nt
    s_mov_b32 s80, 37120
    v_mad_u32_u24 v24, v86, s80, v85
    s_add_u32 s80, s78, 5120
    v_add_u32 v24, v24, v25
    buffer_load_dword v230, v24, s[88:91], s80 offen nt
    s_mov_b32 s80, 21760
    v_mad_u32_u24 v24, v86, s80, v85
    s_add_u32 s80, s78, 7680
    s_add_u32 s80, s80, s79
    buffer_load_dword v231, v24, s[88:91], s80 offen nt
    s_add_u32 s80, s75, 0
    buffer_load_dword v232, v80, s[20:23], s80 offen nt
    s_add_u32 s80, s75, 6144
    buffer_load_dword v233, v80, s[20:23], s80 offen nt
    s_add_u32 s80, s75, 12288
    buffer_load_dword v234, v80, s[20:23], s80 offen nt
    s_add_u32 s80, s75, 18432
    buffer_load_dword v235, v80, s[20:23], s80 offen nt
    s_add_u32 s80, s75, 0
    buffer_load_dword v236, v81, s[20:23], s80 offen nt
    s_add_u32 s80, s75, 6144
    buffer_load_dword v237, v81, s[20:23], s80 offen nt
    s_add_u32 s80, s75, 12288
    buffer_load_dword v238, v81, s[20:23], s80 offen nt
    s_add_u32 s80, s75, 18432
    buffer_load_dword v239, v81, s[20:23], s80 offen nt
    s_add_u32 s80, s87, 256
    s_add_u32 m0, s86, 98304
    s_nop 0
    buffer_load_dwordx4 v100, s[8:11], s80 offen nt lds
    s_add_u32 s80, s87, 5376
    s_add_u32 m0, s86, 99328
    s_nop 0
    buffer_load_dwordx4 v101, s[8:11], s80 offen nt lds
    s_add_u32 s80, s87, 10496
    s_add_u32 m0, s86, 100352
    s_nop 0
    buffer_load_dwordx4 v102, s[8:11], s80 offen nt lds
    s_add_u32 s80, s87, 15616
    s_add_u32 m0, s86, 101376
    s_nop 0
    buffer_load_dwordx4 v103, s[8:11], s80 offen nt lds
    s_add_u32 s80, s87, 20736
    s_add_u32 m0, s86, 102400
    s_nop 0
    buffer_load_dwordx4 v100, s[8:11], s80 offen nt lds
    s_add_u32 s80, s87, 25856
    s_add_u32 m0, s86, 103424
    s_nop 0
    buffer_load_dwordx4 v101, s[8:11], s80 offen nt lds
    s_add_u32 s80, s87, 30976
    s_add_u32 m0, s86, 104448
    s_nop 0
    buffer_load_dwordx4 v102, s[8:11], s80 offen nt lds
    s_add_u32 s80, s87, 36096
    s_add_u32 m0, s86, 105472
    s_nop 0
    buffer_load_dwordx4 v103, s[8:11], s80 offen nt lds
    v_add_u32 v2, 0x10000, v1
    v_add_u32 v3, 0x20000, v1
    s_mov_b32 s48, 0
    s_mov_b32 s49, 0
    s_mov_b32 s52, 0
    s_mul_i32 s94, s54, 80
    s_movk_i32 s62, 3840
    s_movk_i32 s63, 1200
    v_add_u32 v26, 0, v0
    v_mul_u32_u24 v27, 1639, v26
    v_lshrrev_b32 v27, 14, v27
    v_mad_i32_i24 v26, v27, -10, v26
    v_mul_u32_u24 v28, 52, v26
    v_lshrrev_b32 v28, 8, v28
    v_lshlrev_b32 v26, 4, v26
    v_mad_u32_u24 v26, v28, s63, v26
    v_lshrrev_b32 v28, 1, v27
    v_xor_b32 v28, v28, v27
    v_and_b32 v28, 4, v28
    v_mul_u32_u24 v28, 3, v28
    v_xor_b32 v27, v27, v28
    v_mad_u32_u24 v212, v27, s62, v26
    v_add_u32 v26, 256, v0
    v_mul_u32_u24 v27, 1639, v26
    v_lshrrev_b32 v27, 14, v27
    v_mad_i32_i24 v26, v27, -10, v26
    v_mul_u32_u24 v28, 52, v26
    v_lshrrev_b32 v28, 8, v28
    v_lshlrev_b32 v26, 4, v26
    v_mad_u32_u24 v26, v28, s63, v26
    v_lshrrev_b32 v28, 1, v27
    v_xor_b32 v28, v28, v27
    v_and_b32 v28, 4, v28
    v_mul_u32_u24 v28, 3, v28
    v_xor_b32 v27, v27, v28
    v_mad_u32_u24 v213, v27, s62, v26
    v_add_u32 v26, 512, v0
    v_mul_u32_u24 v27, 1639, v26
    v_lshrrev_b32 v27, 14, v27
    v_mad_i32_i24 v26, v27, -10, v26
    v_mul_u32_u24 v28, 52, v26
    v_lshrrev_b32 v28, 8, v28
    v_lshlrev_b32 v26, 4, v26
    v_mad_u32_u24 v26, v28, s63, v26
    v_lshrrev_b32 v28, 1, v27
    v_xor_b32 v28, v28, v27
    v_and_b32 v28, 4, v28
    v_mul_u32_u24 v28, 3, v28
    v_xor_b32 v27, v27, v28
    v_mad_u32_u24 v214, v27, s62, v26
    v_add_u32 v26, 768, v0
    v_mul_u32_u24 v27, 1639, v26
    v_lshrrev_b32 v27, 14, v27
    v_mad_i32_i24 v26, v27, -10, v26
    v_mul_u32_u24 v28, 52, v26
    v_lshrrev_b32 v28, 8, v28
    v_lshlrev_b32 v26, 4, v26
    v_mad_u32_u24 v26, v28, s63, v26
    v_lshrrev_b32 v28, 1, v27
    v_xor_b32 v28, v28, v27
    v_and_b32 v28, 4, v28
    v_mul_u32_u24 v28, 3, v28
    v_xor_b32 v27, v27, v28
    v_mad_u32_u24 v215, v27, s62, v26
    v_add_u32 v26, 1024, v0
    v_mul_u32_u24 v27, 1639, v26
    v_lshrrev_b32 v27, 14, v27
    v_mad_i32_i24 v26, v27, -10, v26
    v_mul_u32_u24 v28, 52, v26
    v_lshrrev_b32 v28, 8, v28
    v_lshlrev_b32 v26, 4, v26
    v_mad_u32_u24 v26, v28, s63, v26
    v_lshrrev_b32 v28, 1, v27
    v_xor_b32 v28, v28, v27
    v_and_b32 v28, 4, v28
    v_mul_u32_u24 v28, 3, v28
    v_xor_b32 v27, v27, v28
    v_mad_u32_u24 v216, v27, s62, v26
    v_xor_b32 v26, v22, v23
    v_lshlrev_b32 v26, 4, v26
    v_lshl_add_u32 v26, v23, 8, v26
    s_add_u32 s60, s86, 65536
    v_add_u32 v96, s60, v26
    v_xor_b32 v97, 64, v96
    v_xor_b32 v98, 128, v96
    v_xor_b32 v99, 192, v96
    v_mov_b32 v168, 0x3f803f80
    v_mov_b32 v169, 0x3f803f80
    v_mov_b32 v170, 0x3f803f80
    v_mov_b32 v171, 0x3f803f80
    v_lshrrev_b32 v26, 2, v23
    v_and_b32 v27, 1, v22
    v_lshl_add_u32 v26, v27, 2, v26
    v_lshrrev_b32 v27, 1, v22
    v_lshl_add_u32 v28, v27, 4, v26
    v_mul_u32_u24 v28, 160, v28
    v_and_b32 v29, 3, v23
    v_lshl_add_u32 v136, v29, 3, v28
    v_add_u32 v137, 0x10000, v136
    v_add_u32 v138, 0x20000, v136
    v_lshlrev_b32 v26, 1, v26
    v_lshl_add_u32 v28, v27, 4, v26
    v_mul_u32_u24 v28, 80, v28
    v_lshl_add_u32 v139, v29, 3, v28
    v_add_u32 v140, 0x10000, v139
    s_lshl_b32 s60, s44, 5
    v_add_u32 v90, s60, v136
    v_add_u32 v91, s60, v137
    v_add_u32 v92, s60, v138
    s_waitcnt vmcnt(37)
    s_cmp_eq_u32 s93, 0x40000000
    s_cbranch_scc1 Lnoscan_7
    s_mov_b32 s60, 0x5a5a5a00
    v_bfrev_b32 v24, 1
    v_subrev_u32 v25, s60, v104
    v_lshrrev_b32 v25, 4, v25
    v_min_u32 v25, 31, v25
    v_lshl_or_b32 v24, 1, v25, v24
    v_subrev_u32 v25, s60, v105
    v_lshrrev_b32 v25, 4, v25
    v_min_u32 v25, 31, v25
    v_lshl_or_b32 v24, 1, v25, v24
    v_subrev_u32 v25, s60, v106
    v_lshrrev_b32 v25, 4, v25
    v_min_u32 v25, 31, v25
    v_lshl_or_b32 v24, 1, v25, v24
    v_subrev_u32 v25, s60, v107
    v_lshrrev_b32 v25, 4, v25
    v_min_u32 v25, 31, v25
    v_lshl_or_b32 v24, 1, v25, v24
    v_subrev_u32 v25, s60, v108
    v_lshrrev_b32 v25, 4, v25
    v_min_u32 v25, 31, v25
    v_lshl_or_b32 v24, 1, v25, v24
    v_subrev_u32 v25, s60, v109
    v_lshrrev_b32 v25, 4, v25
    v_min_u32 v25, 31, v25
    v_lshl_or_b32 v24, 1, v25, v24
    v_subrev_u32 v25, s60, v110
    v_lshrrev_b32 v25, 4, v25
    v_min_u32 v25, 31, v25
    v_lshl_or_b32 v24, 1, v25, v24
    v_subrev_u32 v25, s60, v111
    v_lshrrev_b32 v25, 4, v25
    v_min_u32 v25, 31, v25
    v_lshl_or_b32 v24, 1, v25, v24
    v_subrev_u32 v25, s60, v112
    v_lshrrev_b32 v25, 4, v25
    v_min_u32 v25, 31, v25
    v_lshl_or_b32 v24, 1, v25, v24
    v_subrev_u32 v25, s60, v113
    v_lshrrev_b32 v25, 4, v25
    v_min_u32 v25, 31, v25
    v_lshl_or_b32 v24, 1, v25, v24
    v_subrev_u32 v25, s60, v114
    v_lshrrev_b32 v25, 4, v25
    v_min_u32 v25, 31, v25
    v_lshl_or_b32 v24, 1, v25, v24
    v_subrev_u32 v25, s60, v115
    v_lshrrev_b32 v25, 4, v25
    v_min_u32 v25, 31, v25
    v_lshl_or_b32 v24, 1, v25, v24
    v_subrev_u32 v25, s60, v116
    v_lshrrev_b32 v25, 4, v25
    v_min_u32 v25, 31, v25
    v_lshl_or_b32 v24, 1, v25, v24
    v_subrev_u32 v25, s60, v117
    v_lshrrev_b32 v25, 4, v25
    v_min_u32 v25, 31, v25
    v_lshl_or_b32 v24, 1, v25, v24
    v_subrev_u32 v25, s60, v118
    v_lshrrev_b32 v25, 4, v25
    v_min_u32 v25, 31, v25
    v_lshl_or_b32 v24, 1, v25, v24
    v_subrev_u32 v25, s60, v119
    v_lshrrev_b32 v25, 4, v25
    v_min_u32 v25, 31, v25
    v_lshl_or_b32 v24, 1, v25, v24
    s_nop 1
    v_or_b32_dpp v24, v24, v24 row_ror:8 row_mask:0xf bank_mask:0xf
    s_nop 1
    v_or_b32_dpp v24, v24, v24 row_ror:4 row_mask:0xf bank_mask:0xf
    s_nop 1
    v_or_b32_dpp v24, v24, v24 row_ror:2 row_mask:0xf bank_mask:0xf
    s_nop 1
    v_or_b32_dpp v24, v24, v24 row_ror:1 row_mask:0xf bank_mask:0xf
    v_mov_b32 v25, v24
    s_nop 1
    v_permlane16_swap_b32 v24, v25
    v_or_b32 v24, v24, v25
    v_mov_b32 v25, v24
    s_nop 1
    v_permlane32_swap_b32 v24, v25
    v_or_b32 v24, v24, v25
    s_lshl_b32 s60, s2, 2
    v_mov_b32 v25, s60
    s_mov_b64 exec, 1
    buffer_store_dword v24, v25, s[40:43], 0 offen sc1
    s_mov_b64 exec, -1
Lnoscan_7:
    s_waitcnt vmcnt(26)
    ds_read_b128 a[0:3], v96 offset:0
    ds_read_b128 a[4:7], v96 offset:4096
    ds_read_b128 a[8:11], v97 offset:0
    ds_read_b128 a[12:15], v97 offset:4096
    ds_read_b128 a[16:19], v98 offset:0
    ds_read_b128 a[20:23], v98 offset:4096
    ds_read_b128 a[24:27], v99 offset:0
    ds_read_b128 a[28:31], v99 offset:4096
    s_add_u32 s80, s87, 512
    s_add_u32 m0, s86, 131072
    s_nop 0
    buffer_load_dwordx4 v100, s[8:11], s80 offen nt lds
    s_add_u32 s80, s87, 5632
    s_add_u32 m0, s86, 132096
    s_nop 0
    buffer_load_dwordx4 v101, s[8:11], s80 offen nt lds
    s_add_u32 s80, s87, 10752
    s_add_u32 m0, s86, 133120
    s_nop 0
    buffer_load_dwordx4 v102, s[8:11], s80 offen nt lds
    s_add_u32 s80, s87, 15872
    s_add_u32 m0, s86, 134144
    s_nop 0
    buffer_load_dwordx4 v103, s[8:11], s80 offen nt lds
    s_add_u32 s80, s87, 20992
    s_add_u32 m0, s86, 135168
    s_nop 0
    buffer_load_dwordx4 v100, s[8:11], s80 offen nt lds
    s_add_u32 s80, s87, 26112
    s_add_u32 m0, s86, 136192
    s_nop 0
    buffer_load_dwordx4 v101, s[8:11], s80 offen nt lds
    s_add_u32 s80, s87, 31232
    s_add_u32 m0, s86, 137216
    s_nop 0
    buffer_load_dwordx4 v102, s[8:11], s80 offen nt lds
    s_add_u32 s80, s87, 36352
    s_add_u32 m0, s86, 138240
    s_nop 0
    buffer_load_dwordx4 v103, s[8:11], s80 offen nt lds
    s_waitcnt vmcnt(16)
    v_mov_b32_dpp v104, v224 quad_perm:[1,0,3,2] row_mask:0xf bank_mask:0xf
    v_mov_b32_dpp v105, v225 quad_perm:[1,0,3,2] row_mask:0xf bank_mask:0xf
    v_mov_b32_dpp v106, v226 quad_perm:[1,0,3,2] row_mask:0xf bank_mask:0xf
    v_mov_b32_dpp v107, v227 quad_perm:[1,0,3,2] row_mask:0xf bank_mask:0xf
    v_perm_b32 v104, v104, v224, v141
    v_perm_b32 v105, v105, v225, v141
    v_perm_b32 v106, v106, v226, v141
    v_perm_b32 v107, v107, v227, v141
    v_mov_b32_dpp v108, v228 quad_perm:[1,0,3,2] row_mask:0xf bank_mask:0xf
    v_mov_b32_dpp v109, v229 quad_perm:[1,0,3,2] row_mask:0xf bank_mask:0xf
    v_mov_b32_dpp v110, v230 quad_perm:[1,0,3,2] row_mask:0xf bank_mask:0xf
    v_mov_b32_dpp v111, v231 quad_perm:[1,0,3,2] row_mask:0xf bank_mask:0xf
    v_perm_b32 v108, v108, v228, v141
    v_perm_b32 v109, v109, v229, v141
    v_perm_b32 v110, v110, v230, v141
    v_perm_b32 v111, v111, v231, v141
    v_mov_b32_dpp v112, v232 quad_perm:[1,0,3,2] row_mask:0xf bank_mask:0xf
    v_mov_b32_dpp v113, v233 quad_perm:[1,0,3,2] row_mask:0xf bank_mask:0xf
    v_mov_b32_dpp v114, v234 quad_perm:[1,0,3,2] row_mask:0xf bank_mask:0xf
    v_mov_b32_dpp v115, v235 quad_perm:[1,0,3,2] row_mask:0xf bank_mask:0xf
    v_perm_b32 v112, v112, v232, v141
    v_perm_b32 v113, v113, v233, v141
    v_perm_b32 v114, v114, v234, v141
    v_perm_b32 v115, v115, v235, v141
    v_mov_b32_dpp v116, v236 quad_perm:[1,0,3,2] row_mask:0xf bank_mask:0xf
    v_mov_b32_dpp v117, v237 quad_perm:[1,0,3,2] row_mask:0xf bank_mask:0xf
    v_mov_b32_dpp v118, v238 quad_perm:[1,0,3,2] row_mask:0xf bank_mask:0xf
    v_mov_b32_dpp v119, v239 quad_perm:[1,0,3,2] row_mask:0xf bank_mask:0xf
    v_perm_b32 v116, v116, v236, v141
    v_perm_b32 v117, v117, v237, v141
    v_perm_b32 v118, v118, v238, v141
    v_perm_b32 v119, v119, v239, v141
    v_mfma_f32_16x16x32_bf16 v[72:75], v[168:171], v[112:115], 0
    s_nop 0
    v_mfma_f32_16x16x32_bf16 v[76:79], v[168:171], v[116:119], 0
    buffer_store_dwordx4 v[104:107], v1, s[4:7], s84 offen sc1
    buffer_store_dwordx4 v[108:111], v1, s[4:7], s85 offen sc1
    buffer_store_dwordx4 v[112:115], v1, s[4:7], s76 offen sc1
    buffer_store_dwordx4 v[116:119], v1, s[4:7], s77 offen sc1
    v_cmp_eq_u32 vcc, 1, v22
    s_nop 2
    v_cndmask_b32 v72, v72, v76, vcc
    v_cndmask_b32 v142, v142, v143, vcc
    v_cmp_gt_u32 vcc, 32, v15
    s_nop 1
    v_cndmask_b32 v73, v36, v142, vcc
    buffer_store_dword v72, v73, s[4:7], 0 offen sc1
    s_waitcnt vmcnt(13)
    ds_read_b128 a[32:35], v96 offset:32768
    ds_read_b128 a[36:39], v96 offset:36864
    ds_read_b128 a[40:43], v97 offset:32768
    ds_read_b128 a[44:47], v97 offset:36864
    ds_read_b128 a[48:51], v98 offset:32768
    ds_read_b128 a[52:55], v98 offset:36864
    ds_read_b128 a[56:59], v99 offset:32768
    s_waitcnt lgkmcnt(14)
    ds_read_b128 a[60:63], v99 offset:36864
    s_waitcnt lgkmcnt(8)
    v_mfma_f32_16x16x32_bf16 v[200:203], v[168:171], a[0:3], 0
    v_mfma_f32_16x16x32_bf16 v[228:231], a[0:3], a[0:3], 0
    v_mfma_f32_16x16x32_bf16 v[204:207], v[168:171], a[4:7], 0
    v_mfma_f32_16x16x32_bf16 v[232:235], a[4:7], a[4:7], 0
    v_mfma_f32_16x16x32_bf16 v[200:203], v[168:171], a[8:11], v[200:203]
    v_mfma_f32_16x16x32_bf16 v[228:231], a[8:11], a[8:11], v[228:231]
    v_mfma_f32_16x16x32_bf16 v[204:207], v[168:171], a[12:15], v[204:207]
    v_mfma_f32_16x16x32_bf16 v[232:235], a[12:15], a[12:15], v[232:235]
    v_mfma_f32_16x16x32_bf16 v[200:203], v[168:171], a[16:19], v[200:203]
    v_mfma_f32_16x16x32_bf16 v[228:231], a[16:19], a[16:19], v[228:231]
    v_mfma_f32_16x16x32_bf16 v[204:207], v[168:171], a[20:23], v[204:207]
    v_mfma_f32_16x16x32_bf16 v[232:235], a[20:23], a[20:23], v[232:235]
    v_mfma_f32_16x16x32_bf16 v[200:203], v[168:171], a[24:27], v[200:203]
    v_mfma_f32_16x16x32_bf16 v[228:231], a[24:27], a[24:27], v[228:231]
    v_mfma_f32_16x16x32_bf16 v[204:207], v[168:171], a[28:31], v[204:207]
    v_mfma_f32_16x16x32_bf16 v[232:235], a[28:31], a[28:31], v[232:235]
    s_waitcnt lgkmcnt(0)
    s_barrier
    s_add_u32 s80, s94, 1280
    s_add_u32 m0, s81, 73728
    s_nop 0
    buffer_load_dwordx4 v212, s[12:15], s80 offen lds
    s_add_u32 s80, s94, 1280
    s_add_u32 m0, s81, 77824
    s_nop 0
    buffer_load_dwordx4 v213, s[12:15], s80 offen lds
    s_add_u32 s80, s94, 1280
    s_add_u32 m0, s81, 81920
    s_nop 0
    buffer_load_dwordx4 v214, s[12:15], s80 offen lds
    s_add_u32 s80, s94, 1280
    s_add_u32 m0, s81, 86016
    s_nop 0
    buffer_load_dwordx4 v215, s[12:15], s80 offen lds
    v_add_u32 v96, 65536, v96
    v_add_u32 v97, 65536, v97
    v_add_u32 v98, 65536, v98
    v_add_u32 v99, 65536, v99
    s_waitcnt vmcnt(9)
    ds_read_b128 a[64:67], v96 offset:0
    ds_read_b128 a[68:71], v96 offset:4096
    ds_read_b128 a[72:75], v97 offset:0
    ds_read_b128 a[76:79], v97 offset:4096
    ds_read_b128 a[80:83], v98 offset:0
    ds_read_b128 a[84:87], v98 offset:4096
    ds_read_b128 a[88:91], v99 offset:0
    ds_read_b128 a[92:95], v99 offset:4096
    s_add_u32 s80, s94, 1280
    s_add_u32 m0, s81, 90112
    s_nop 0
    buffer_load_dwordx4 v216, s[12:15], s80 offen lds
    s_add_u32 s80, s94, 492800
    s_add_u32 m0, s81, 94208
    s_nop 0
    buffer_load_dwordx4 v212, s[12:15], s80 offen lds
    s_add_u32 s80, s87, 768
    s_add_u32 m0, s86, 0
    s_nop 0
    buffer_load_dwordx4 v100, s[8:11], s80 offen nt lds
    s_add_u32 s80, s87, 5888
    s_add_u32 m0, s86, 1024
    s_nop 0
    buffer_load_dwordx4 v101, s[8:11], s80 offen nt lds
    s_add_u32 s80, s87, 11008
    s_add_u32 m0, s86, 2048
    s_nop 0
    buffer_load_dwordx4 v102, s[8:11], s80 offen nt lds
    s_add_u32 s80, s87, 16128
    s_add_u32 m0, s86, 3072
    s_nop 0
    buffer_load_dwordx4 v103, s[8:11], s80 offen nt lds
    s_add_u32 s80, s94, 492800
    s_add_u32 m0, s81, 98304
    s_nop 0
    buffer_load_dwordx4 v213, s[12:15], s80 offen lds
    v_mfma_f32_16x16x32_bf16 v[200:203], v[168:171], a[32:35], v[200:203]
    v_mfma_f32_16x16x32_bf16 v[228:231], a[32:35], a[32:35], v[228:231]
    v_mfma_f32_16x16x32_bf16 v[204:207], v[168:171], a[36:39], v[204:207]
    v_mfma_f32_16x16x32_bf16 v[232:235], a[36:39], a[36:39], v[232:235]
    v_mfma_f32_16x16x32_bf16 v[200:203], v[168:171], a[40:43], v[200:203]
    v_mfma_f32_16x16x32_bf16 v[228:231], a[40:43], a[40:43], v[228:231]
    v_mfma_f32_16x16x32_bf16 v[204:207], v[168:171], a[44:47], v[204:207]
    v_mfma_f32_16x16x32_bf16 v[232:235], a[44:47], a[44:47], v[232:235]
    v_mfma_f32_16x16x32_bf16 v[200:203], v[168:171], a[48:51], v[200:203]
    v_mfma_f32_16x16x32_bf16 v[228:231], a[48:51], a[48:51], v[228:231]
    v_mfma_f32_16x16x32_bf16 v[204:207], v[168:171], a[52:55], v[204:207]
    v_mfma_f32_16x16x32_bf16 v[232:235], a[52:55], a[52:55], v[232:235]
    v_mfma_f32_16x16x32_bf16 v[200:203], v[168:171], a[56:59], v[200:203]
    v_mfma_f32_16x16x32_bf16 v[228:231], a[56:59], a[56:59], v[228:231]
    v_mfma_f32_16x16x32_bf16 v[204:207], v[168:171], a[60:63], v[204:207]
    v_mfma_f32_16x16x32_bf16 v[232:235], a[60:63], a[60:63], v[232:235]
    s_waitcnt lgkmcnt(0)
    v_mfma_f32_16x16x32_bf16 v[200:203], v[168:171], a[64:67], v[200:203]
    v_mfma_f32_16x16x32_bf16 v[228:231], a[64:67], a[64:67], v[228:231]
    v_mfma_f32_16x16x32_bf16 v[204:207], v[168:171], a[68:71], v[204:207]
    v_mfma_f32_16x16x32_bf16 v[232:235], a[68:71], a[68:71], v[232:235]
    v_mfma_f32_16x16x32_bf16 v[200:203], v[168:171], a[72:75], v[200:203]
    v_mfma_f32_16x16x32_bf16 v[228:231], a[72:75], a[72:75], v[228:231]
    v_mfma_f32_16x16x32_bf16 v[204:207], v[168:171], a[76:79], v[204:207]
    v_mfma_f32_16x16x32_bf16 v[232:235], a[76:79], a[76:79], v[232:235]
    v_mfma_f32_16x16x32_bf16 v[200:203], v[168:171], a[80:83], v[200:203]
    v_mfma_f32_16x16x32_bf16 v[228:231], a[80:83], a[80:83], v[228:231]
    v_mfma_f32_16x16x32_bf16 v[204:207], v[168:171], a[84:87], v[204:207]
    v_mfma_f32_16x16x32_bf16 v[232:235], a[84:87], a[84:87], v[232:235]
    v_mfma_f32_16x16x32_bf16 v[200:203], v[168:171], a[88:91], v[200:203]
    v_mfma_f32_16x16x32_bf16 v[228:231], a[88:91], a[88:91], v[228:231]
    v_mfma_f32_16x16x32_bf16 v[204:207], v[168:171], a[92:95], v[204:207]
    v_mfma_f32_16x16x32_bf16 v[232:235], a[92:95], a[92:95], v[232:235]
    s_waitcnt vmcnt(7)
    s_barrier
    ds_read_b64_tr_b16 v[104:105], v137 offset:8192
    ds_read_b64_tr_b16 v[106:107], v137 offset:9472
    ds_read_b64_tr_b16 v[108:109], v137 offset:8224
    ds_read_b64_tr_b16 v[110:111], v137 offset:9504
    ds_read_b64_tr_b16 v[112:113], v137 offset:8256
    ds_read_b64_tr_b16 v[114:115], v137 offset:9536
    ds_read_b64_tr_b16 v[116:117], v137 offset:8288
    ds_read_b64_tr_b16 v[118:119], v137 offset:9568
    ds_read_b64_tr_b16 v[120:121], v137 offset:8320
    ds_read_b64_tr_b16 v[122:123], v137 offset:9600
    ds_read_b64_tr_b16 v[124:125], v91 offset:8192
    ds_read_b64_tr_b16 v[126:127], v91 offset:9472
    ds_read_b64_tr_b16 v[128:129], v137 offset:13312
    ds_read_b64_tr_b16 v[130:131], v137 offset:14592
    s_waitcnt lgkmcnt(12)
    v_mfma_f32_16x16x32_bf16 v[40:43], a[0:3], v[104:107], 0
    ds_read_b64_tr_b16 v[132:133], v137 offset:13344
    s_add_u32 s80, s94, 492800
    s_add_u32 m0, s81, 102400
    s_nop 0
    buffer_load_dwordx4 v214, s[12:15], s80 offen lds
    v_mfma_f32_16x16x32_bf16 v[44:47], a[4:7], v[104:107], 0
    ds_read_b64_tr_b16 v[134:135], v137 offset:14624
    s_movk_i32 s62, 3840
    s_waitcnt lgkmcnt(12)
    v_mfma_f32_16x16x32_bf16 v[48:51], a[0:3], v[108:111], 0
    ds_read_b64_tr_b16 v[104:105], v137 offset:13376
    s_add_u32 s80, s94, 492800
    s_add_u32 m0, s81, 106496
    s_nop 0
    buffer_load_dwordx4 v215, s[12:15], s80 offen lds
    v_mfma_f32_16x16x32_bf16 v[52:55], a[4:7], v[108:111], 0
    ds_read_b64_tr_b16 v[106:107], v137 offset:14656
    s_movk_i32 s63, 1200
    s_waitcnt lgkmcnt(12)
    v_mfma_f32_16x16x32_bf16 v[56:59], a[0:3], v[112:115], 0
    ds_read_b64_tr_b16 v[108:109], v137 offset:13408
    v_add_u32 v26, 0, v0
    v_mul_u32_u24 v27, 1639, v26
    v_lshrrev_b32 v27, 13, v27
    v_mfma_f32_16x16x32_bf16 v[60:63], a[4:7], v[112:115], 0
    ds_read_b64_tr_b16 v[110:111], v137 offset:14688
    v_mad_i32_i24 v26, v27, -5, v26
    v_lshlrev_b32 v26, 4, v26
    s_waitcnt lgkmcnt(12)
    v_mfma_f32_16x16x32_bf16 v[64:67], a[0:3], v[116:119], 0
    ds_read_b64_tr_b16 v[112:113], v137 offset:13440
    s_add_u32 s80, s87, 21248
    s_add_u32 m0, s86, 4096
    s_nop 0
    buffer_load_dwordx4 v100, s[8:11], s80 offen nt lds
    v_mfma_f32_16x16x32_bf16 v[68:71], a[4:7], v[116:119], 0
    ds_read_b64_tr_b16 v[114:115], v137 offset:14720
    v_bfe_u32 v28, v27, 1, 2
    s_waitcnt lgkmcnt(12)
    v_mfma_f32_16x16x32_bf16 v[72:75], a[0:3], v[120:123], 0
    ds_read_b64_tr_b16 v[116:117], v91 offset:13312
    s_add_u32 s80, s87, 26368
    s_add_u32 m0, s86, 5120
    s_nop 0
    buffer_load_dwordx4 v101, s[8:11], s80 offen nt lds
    v_mfma_f32_16x16x32_bf16 v[76:79], a[4:7], v[120:123], 0
    v_and_or_b32 v28, v27, -8, v28
    v_and_b32 v27, 1, v27
    v_lshl_or_b32 v28, v27, 2, v28
    v_mfma_f32_16x16x32_bf16 v[196:199], v[168:171], v[120:123], 0
    ds_read_b64_tr_b16 v[118:119], v91 offset:14592
    v_mad_u32_u24 v217, v28, s62, v26
    v_add_u32 v26, 256, v0
    s_waitcnt lgkmcnt(12)
    v_mfma_f32_16x16x32_bf16 v[192:195], v[168:171], v[124:127], 0
    ds_read_b64_tr_b16 v[120:121], v137 offset:18432
    ds_read_b64_tr_b16 v[122:123], v137 offset:19712
    v_mul_u32_u24 v27, 1639, v26
    s_waitcnt lgkmcnt(12)
    v_mfma_f32_16x16x32_bf16 v[40:43], a[8:11], v[128:131], v[40:43]
    ds_read_b64_tr_b16 v[124:125], v137 offset:18464
    s_add_u32 s80, s87, 31488
    s_add_u32 m0, s86, 6144
    s_nop 0
    buffer_load_dwordx4 v102, s[8:11], s80 offen nt lds
    v_mfma_f32_16x16x32_bf16 v[44:47], a[12:15], v[128:131], v[44:47]
    ds_read_b64_tr_b16 v[126:127], v137 offset:19744
    v_lshrrev_b32 v27, 13, v27
    s_waitcnt lgkmcnt(12)
    v_mfma_f32_16x16x32_bf16 v[48:51], a[8:11], v[132:135], v[48:51]
    ds_read_b64_tr_b16 v[128:129], v137 offset:18496
    s_add_u32 s80, s87, 36608
    s_add_u32 m0, s86, 7168
    s_nop 0
    buffer_load_dwordx4 v103, s[8:11], s80 offen nt lds
    v_mfma_f32_16x16x32_bf16 v[52:55], a[12:15], v[132:135], v[52:55]
    ds_read_b64_tr_b16 v[130:131], v137 offset:19776
    v_mad_i32_i24 v26, v27, -5, v26
    s_waitcnt lgkmcnt(12)
    v_mfma_f32_16x16x32_bf16 v[56:59], a[8:11], v[104:107], v[56:59]
    ds_read_b64_tr_b16 v[132:133], v137 offset:18528
    v_lshlrev_b32 v26, 4, v26
    v_bfe_u32 v28, v27, 1, 2
    v_and_or_b32 v28, v27, -8, v28
    v_mfma_f32_16x16x32_bf16 v[60:63], a[12:15], v[104:107], v[60:63]
    ds_read_b64_tr_b16 v[134:135], v137 offset:19808
    v_and_b32 v27, 1, v27
    v_lshl_or_b32 v28, v27, 2, v28
    s_waitcnt lgkmcnt(12)
    v_mfma_f32_16x16x32_bf16 v[64:67], a[8:11], v[108:111], v[64:67]
    ds_read_b64_tr_b16 v[104:105], v137 offset:18560
    s_add_u32 s80, s94, 492800
    s_add_u32 m0, s81, 110592
    s_nop 0
    buffer_load_dwordx4 v216, s[12:15], s80 offen lds
    v_mfma_f32_16x16x32_bf16 v[68:71], a[12:15], v[108:111], v[68:71]
    ds_read_b64_tr_b16 v[106:107], v137 offset:19840
    v_mad_u32_u24 v218, v28, s62, v26
    s_waitcnt lgkmcnt(12)
    v_mfma_f32_16x16x32_bf16 v[72:75], a[8:11], v[112:115], v[72:75]
    ds_read_b64_tr_b16 v[108:109], v91 offset:18432
    s_add_u32 s80, s94, 984320
    s_add_u32 m0, s81, 114688
    s_nop 0
    buffer_load_dwordx4 v212, s[12:15], s80 offen lds
    v_mfma_f32_16x16x32_bf16 v[76:79], a[12:15], v[112:115], v[76:79]
    v_add_u32 v26, 512, v0
    v_mul_u32_u24 v27, 1639, v26
    v_lshrrev_b32 v27, 13, v27
    v_mfma_f32_16x16x32_bf16 v[196:199], v[168:171], v[112:115], v[196:199]
    ds_read_b64_tr_b16 v[110:111], v91 offset:19712
    v_mad_i32_i24 v26, v27, -5, v26
    v_lshlrev_b32 v26, 4, v26
    s_waitcnt lgkmcnt(12)
    v_mfma_f32_16x16x32_bf16 v[192:195], v[168:171], v[116:119], v[192:195]
    s_waitcnt vmcnt(6)
    s_barrier
    ds_read_b64_tr_b16 v[112:113], v137 offset:23552
    ds_read_b64_tr_b16 v[114:115], v137 offset:24832
    s_waitcnt lgkmcnt(12)
    v_mfma_f32_16x16x32_bf16 v[40:43], a[16:19], v[120:123], v[40:43]
    ds_read_b64_tr_b16 v[116:117], v137 offset:23584
    s_add_u32 s80, s87, 1024
    v_mfma_f32_16x16x32_bf16 v[44:47], a[20:23], v[120:123], v[44:47]
    ds_read_b64_tr_b16 v[118:119], v137 offset:24864
    s_add_u32 m0, s86, 32768
    s_nop 0
    buffer_load_dwordx4 v100, s[8:11], s80 offen nt lds
    s_waitcnt lgkmcnt(12)
    v_mfma_f32_16x16x32_bf16 v[48:51], a[16:19], v[124:127], v[48:51]
    ds_read_b64_tr_b16 v[120:121], v137 offset:23616
    v_lshlrev_b32 v24, 2, v15
    buffer_load_dword v141, v24, s[40:43], 0 offen sc1
    v_mfma_f32_16x16x32_bf16 v[52:55], a[20:23], v[124:127], v[52:55]
    ds_read_b64_tr_b16 v[122:123], v137 offset:24896
    s_waitcnt lgkmcnt(12)
    v_mfma_f32_16x16x32_bf16 v[56:59], a[16:19], v[128:131], v[56:59]
    ds_read_b64_tr_b16 v[124:125], v137 offset:23648
    s_add_u32 s80, s87, 6144
    s_add_u32 m0, s86, 33792
    s_nop 0
    buffer_load_dwordx4 v101, s[8:11], s80 offen nt lds
    v_mfma_f32_16x16x32_bf16 v[60:63], a[20:23], v[128:131], v[60:63]
    ds_read_b64_tr_b16 v[126:127], v137 offset:24928
    v_bfe_u32 v28, v27, 1, 2
    s_waitcnt lgkmcnt(12)
    v_mfma_f32_16x16x32_bf16 v[64:67], a[16:19], v[132:135], v[64:67]
    ds_read_b64_tr_b16 v[128:129], v137 offset:23680
    s_add_u32 s80, s87, 11264
    s_add_u32 m0, s86, 34816
    s_nop 0
    buffer_load_dwordx4 v102, s[8:11], s80 offen nt lds
    v_mfma_f32_16x16x32_bf16 v[68:71], a[20:23], v[132:135], v[68:71]
    ds_read_b64_tr_b16 v[130:131], v137 offset:24960
    v_and_or_b32 v28, v27, -8, v28
    s_waitcnt lgkmcnt(12)
    v_mfma_f32_16x16x32_bf16 v[72:75], a[16:19], v[104:107], v[72:75]
    ds_read_b64_tr_b16 v[132:133], v91 offset:23552
    s_add_u32 s80, s87, 16384
    s_add_u32 m0, s86, 35840
    s_nop 0
    buffer_load_dwordx4 v103, s[8:11], s80 offen nt lds
    v_mfma_f32_16x16x32_bf16 v[76:79], a[20:23], v[104:107], v[76:79]
    v_and_b32 v27, 1, v27
    v_lshl_or_b32 v28, v27, 2, v28
    v_mad_u32_u24 v219, v28, s62, v26
    v_mfma_f32_16x16x32_bf16 v[196:199], v[168:171], v[104:107], v[196:199]
    ds_read_b64_tr_b16 v[134:135], v91 offset:24832
    v_add_u32 v26, 768, v0
    v_mul_u32_u24 v27, 1639, v26
    s_waitcnt lgkmcnt(12)
    v_mfma_f32_16x16x32_bf16 v[192:195], v[168:171], v[108:111], v[192:195]
    ds_read_b64_tr_b16 v[104:105], v137 offset:28672
    ds_read_b64_tr_b16 v[106:107], v137 offset:29952
    v_lshrrev_b32 v27, 13, v27
    s_waitcnt lgkmcnt(12)
    v_mfma_f32_16x16x32_bf16 v[40:43], a[24:27], v[112:115], v[40:43]
    ds_read_b64_tr_b16 v[108:109], v137 offset:28704
    s_add_u32 s80, s94, 984320
    s_add_u32 m0, s81, 118784
    s_nop 0
    buffer_load_dwordx4 v213, s[12:15], s80 offen lds
    v_mfma_f32_16x16x32_bf16 v[44:47], a[28:31], v[112:115], v[44:47]
    ds_read_b64_tr_b16 v[110:111], v137 offset:29984
    v_mad_i32_i24 v26, v27, -5, v26
    s_waitcnt lgkmcnt(12)
    v_mfma_f32_16x16x32_bf16 v[48:51], a[24:27], v[116:119], v[48:51]
    ds_read_b64_tr_b16 v[112:113], v137 offset:28736
    s_add_u32 s80, s94, 984320
    s_add_u32 m0, s81, 122880
    s_nop 0
    buffer_load_dwordx4 v214, s[12:15], s80 offen lds
    v_mfma_f32_16x16x32_bf16 v[52:55], a[28:31], v[116:119], v[52:55]
    ds_read_b64_tr_b16 v[114:115], v137 offset:30016
    v_lshlrev_b32 v26, 4, v26
    s_waitcnt lgkmcnt(12)
    v_mfma_f32_16x16x32_bf16 v[56:59], a[24:27], v[120:123], v[56:59]
    ds_read_b64_tr_b16 v[116:117], v137 offset:28768
    v_add_u32 v96, -131072, v96
    v_add_u32 v97, -131072, v97
    v_add_u32 v98, -131072, v98
    v_add_u32 v99, -131072, v99
    s_waitcnt vmcnt(9)
    ds_read_b128 a[96:99], v96 offset:0
    ds_read_b128 a[100:103], v96 offset:4096
    s_waitcnt lgkmcnt(14)
    ds_read_b128 a[104:107], v97 offset:0
    s_waitcnt lgkmcnt(14)
    ds_read_b128 a[108:111], v97 offset:4096
    s_waitcnt lgkmcnt(14)
    ds_read_b128 a[112:115], v98 offset:0
    s_waitcnt lgkmcnt(14)
    ds_read_b128 a[116:119], v98 offset:4096
    s_waitcnt lgkmcnt(14)
    ds_read_b128 a[120:123], v99 offset:0
    s_waitcnt lgkmcnt(14)
    ds_read_b128 a[124:127], v99 offset:4096
    v_mfma_f32_16x16x32_bf16 v[60:63], a[28:31], v[120:123], v[60:63]
    s_waitcnt lgkmcnt(14)
    ds_read_b64_tr_b16 v[118:119], v137 offset:30048
    v_mfma_f32_16x16x32_bf16 v[64:67], a[24:27], v[124:127], v[64:67]
    s_waitcnt lgkmcnt(14)
    ds_read_b64_tr_b16 v[120:121], v137 offset:28800
    v_mfma_f32_16x16x32_bf16 v[68:71], a[28:31], v[124:127], v[68:71]
    s_waitcnt lgkmcnt(14)
    ds_read_b64_tr_b16 v[122:123], v137 offset:30080
    v_mfma_f32_16x16x32_bf16 v[72:75], a[24:27], v[128:131], v[72:75]
    s_waitcnt lgkmcnt(14)
    ds_read_b64_tr_b16 v[124:125], v91 offset:28672
    s_add_u32 s80, s94, 984320
    s_add_u32 m0, s81, 126976
    v_mfma_f32_16x16x32_bf16 v[76:79], a[28:31], v[128:131], v[76:79]
    buffer_load_dwordx4 v215, s[12:15], s80 offen lds
    s_add_u32 s80, s87, 21504
    s_add_u32 m0, s86, 36864
    v_mfma_f32_16x16x32_bf16 v[196:199], v[168:171], v[128:131], v[196:199]
    s_waitcnt lgkmcnt(14)
    ds_read_b64_tr_b16 v[126:127], v91 offset:29952
    buffer_load_dwordx4 v100, s[8:11], s80 offen nt lds
    v_mfma_f32_16x16x32_bf16 v[192:195], v[168:171], v[132:135], v[192:195]
    s_waitcnt lgkmcnt(14)
    ds_read_b64_tr_b16 v[128:129], v137 offset:33792
    s_waitcnt lgkmcnt(14)
    ds_read_b64_tr_b16 v[130:131], v137 offset:35072
    v_mfma_f32_16x16x32_bf16 v[40:43], a[32:35], v[104:107], v[40:43]
    s_waitcnt lgkmcnt(14)
    ds_read_b64_tr_b16 v[132:133], v137 offset:33824
    v_mfma_f32_16x16x32_bf16 v[44:47], a[36:39], v[104:107], v[44:47]
    s_waitcnt lgkmcnt(14)
    ds_read_b64_tr_b16 v[134:135], v137 offset:35104
    s_add_u32 s80, s87, 26624
    v_mfma_f32_16x16x32_bf16 v[48:51], a[32:35], v[108:111], v[48:51]
    s_waitcnt lgkmcnt(14)
    ds_read_b64_tr_b16 v[104:105], v137 offset:33856
    s_add_u32 m0, s86, 37888
    s_nop 0
    buffer_load_dwordx4 v101, s[8:11], s80 offen nt lds
    v_mfma_f32_16x16x32_bf16 v[52:55], a[36:39], v[108:111], v[52:55]
    s_waitcnt lgkmcnt(14)
    ds_read_b64_tr_b16 v[106:107], v137 offset:35136
    v_mfma_f32_16x16x32_bf16 v[56:59], a[32:35], v[112:115], v[56:59]
    s_waitcnt lgkmcnt(14)
    ds_read_b64_tr_b16 v[108:109], v137 offset:33888
    s_add_u32 s80, s87, 31744
    s_add_u32 m0, s86, 38912
    v_mfma_f32_16x16x32_bf16 v[60:63], a[36:39], v[112:115], v[60:63]
    s_waitcnt lgkmcnt(14)
    ds_read_b64_tr_b16 v[110:111], v137 offset:35168
    buffer_load_dwordx4 v102, s[8:11], s80 offen nt lds
    s_waitcnt lgkmcnt(12)
    v_mfma_f32_16x16x32_bf16 v[64:67], a[32:35], v[116:119], v[64:67]
    ds_read_b64_tr_b16 v[112:113], v137 offset:33920
    v_mfma_f32_16x16x32_bf16 v[200:203], v[168:171], a[96:99], v[200:203]
    v_mfma_f32_16x16x32_bf16 v[228:231], a[96:99], a[96:99], v[228:231]
    v_mfma_f32_16x16x32_bf16 v[204:207], v[168:171], a[100:103], v[204:207]
    v_mfma_f32_16x16x32_bf16 v[232:235], a[100:103], a[100:103], v[232:235]
    v_mfma_f32_16x16x32_bf16 v[200:203], v[168:171], a[104:107], v[200:203]
    v_mfma_f32_16x16x32_bf16 v[228:231], a[104:107], a[104:107], v[228:231]
    v_mfma_f32_16x16x32_bf16 v[204:207], v[168:171], a[108:111], v[204:207]
    v_mfma_f32_16x16x32_bf16 v[232:235], a[108:111], a[108:111], v[232:235]
    v_mfma_f32_16x16x32_bf16 v[200:203], v[168:171], a[112:115], v[200:203]
    v_mfma_f32_16x16x32_bf16 v[228:231], a[112:115], a[112:115], v[228:231]
    v_mfma_f32_16x16x32_bf16 v[204:207], v[168:171], a[116:119], v[204:207]
    v_mfma_f32_16x16x32_bf16 v[232:235], a[116:119], a[116:119], v[232:235]
    v_mfma_f32_16x16x32_bf16 v[200:203], v[168:171], a[120:123], v[200:203]
    v_mfma_f32_16x16x32_bf16 v[228:231], a[120:123], a[120:123], v[228:231]
    v_mfma_f32_16x16x32_bf16 v[204:207], v[168:171], a[124:127], v[204:207]
    v_mfma_f32_16x16x32_bf16 v[232:235], a[124:127], a[124:127], v[232:235]
    v_mfma_f32_16x16x32_bf16 v[68:71], a[36:39], v[116:119], v[68:71]
    ds_read_b64_tr_b16 v[114:115], v137 offset:35200
    s_waitcnt lgkmcnt(12)
    v_mfma_f32_16x16x32_bf16 v[72:75], a[32:35], v[120:123], v[72:75]
    ds_read_b64_tr_b16 v[116:117], v91 offset:33792
    v_mfma_f32_16x16x32_bf16 v[76:79], a[36:39], v[120:123], v[76:79]
    s_add_u32 s80, s87, 36864
    s_add_u32 m0, s86, 39936
    s_nop 0
    buffer_load_dwordx4 v103, s[8:11], s80 offen nt lds
    v_mfma_f32_16x16x32_bf16 v[196:199], v[168:171], v[120:123], v[196:199]
    ds_read_b64_tr_b16 v[118:119], v91 offset:35072
    s_add_u32 s80, s94, 984320
    s_add_u32 m0, s81, 131072
    s_waitcnt lgkmcnt(12)
    v_mfma_f32_16x16x32_bf16 v[192:195], v[168:171], v[124:127], v[192:195]
    ds_read_b64_tr_b16 v[120:121], v137 offset:38912
    ds_read_b64_tr_b16 v[122:123], v137 offset:40192
    buffer_load_dwordx4 v216, s[12:15], s80 offen lds
    s_waitcnt lgkmcnt(12)
    v_mfma_f32_16x16x32_bf16 v[40:43], a[40:43], v[128:131], v[40:43]
    ds_read_b64_tr_b16 v[124:125], v137 offset:38944
    s_add_u32 s80, s94, 1475840
    v_mfma_f32_16x16x32_bf16 v[44:47], a[44:47], v[128:131], v[44:47]
    ds_read_b64_tr_b16 v[126:127], v137 offset:40224
    s_add_u32 m0, s81, 135168
    s_nop 0
    buffer_load_dwordx4 v212, s[12:15], s80 offen lds
    s_waitcnt lgkmcnt(12)
    v_mfma_f32_16x16x32_bf16 v[48:51], a[40:43], v[132:135], v[48:51]
    ds_read_b64_tr_b16 v[128:129], v137 offset:38976
    s_add_u32 s80, s94, 1475840
    v_mfma_f32_16x16x32_bf16 v[52:55], a[44:47], v[132:135], v[52:55]
    ds_read_b64_tr_b16 v[130:131], v137 offset:40256
    s_add_u32 m0, s81, 139264
    s_nop 0
    buffer_load_dwordx4 v213, s[12:15], s80 offen lds
    s_waitcnt lgkmcnt(12)
    v_mfma_f32_16x16x32_bf16 v[56:59], a[40:43], v[104:107], v[56:59]
    ds_read_b64_tr_b16 v[132:133], v137 offset:39008
    v_bfe_u32 v28, v27, 1, 2
    v_mfma_f32_16x16x32_bf16 v[60:63], a[44:47], v[104:107], v[60:63]
    ds_read_b64_tr_b16 v[134:135], v137 offset:40288
    v_and_or_b32 v28, v27, -8, v28
    v_and_b32 v27, 1, v27
    s_waitcnt lgkmcnt(12)
    v_mfma_f32_16x16x32_bf16 v[64:67], a[40:43], v[108:111], v[64:67]
    ds_read_b64_tr_b16 v[104:105], v137 offset:39040
    s_add_u32 s80, s94, 1475840
    s_add_u32 m0, s81, 143360
    s_nop 0
    buffer_load_dwordx4 v214, s[12:15], s80 offen lds
    v_mfma_f32_16x16x32_bf16 v[68:71], a[44:47], v[108:111], v[68:71]
    ds_read_b64_tr_b16 v[106:107], v137 offset:40320
    v_lshl_or_b32 v28, v27, 2, v28
    s_waitcnt lgkmcnt(12)
    v_mfma_f32_16x16x32_bf16 v[72:75], a[40:43], v[112:115], v[72:75]
    ds_read_b64_tr_b16 v[108:109], v91 offset:38912
    s_add_u32 s80, s94, 1475840
    s_add_u32 m0, s81, 147456
    s_nop 0
    buffer_load_dwordx4 v215, s[12:15], s80 offen lds
    v_mfma_f32_16x16x32_bf16 v[76:79], a[44:47], v[112:115], v[76:79]
    v_mad_u32_u24 v220, v28, s62, v26
    v_add_u32 v26, 1024, v0
    v_mul_u32_u24 v27, 1639, v26
    v_mfma_f32_16x16x32_bf16 v[196:199], v[168:171], v[112:115], v[196:199]
    ds_read_b64_tr_b16 v[110:111], v91 offset:40192
    v_lshrrev_b32 v27, 13, v27
    v_mad_i32_i24 v26, v27, -5, v26
    s_waitcnt lgkmcnt(12)
    v_mfma_f32_16x16x32_bf16 v[192:195], v[168:171], v[116:119], v[192:195]
    s_waitcnt vmcnt(9)
    s_barrier
    ds_read_b64_tr_b16 v[112:113], v137 offset:44032
    ds_read_b64_tr_b16 v[114:115], v137 offset:45312
    s_waitcnt lgkmcnt(12)
    v_mfma_f32_16x16x32_bf16 v[40:43], a[48:51], v[120:123], v[40:43]
    ds_read_b64_tr_b16 v[116:117], v137 offset:44064
    s_mov_b32 s82, 0
Ltag_8:
    v_cmp_gt_i32 s[76:77], 0, v141
    s_and_b32 s80, s76, 255
    s_cmp_eq_u32 s80, 255
    s_cbranch_scc1 Ltagok_9
    s_add_u32 s82, s82, 1
    s_cmp_ge_u32 s82, 200000
    s_cbranch_scc1 LEND
    v_lshlrev_b32 v24, 2, v15
    buffer_load_dword v141, v24, s[40:43], 0 offen sc1
    s_waitcnt vmcnt(0)
    s_branch Ltag_8
Ltagok_9:
    v_readlane_b32 s83, v141, 0
    v_readlane_b32 s80, v141, 1
    s_or_b32 s83, s83, s80
    v_readlane_b32 s80, v141, 2
    s_or_b32 s83, s83, s80
    v_readlane_b32 s80, v141, 3
    s_or_b32 s83, s83, s80
    v_readlane_b32 s80, v141, 4
    s_or_b32 s83, s83, s80
    v_readlane_b32 s80, v141, 5
    s_or_b32 s83, s83, s80
    v_readlane_b32 s80, v141, 6
    s_or_b32 s83, s83, s80
    v_readlane_b32 s80, v141, 7
    s_or_b32 s83, s83, s80
    s_ff0_i32_b32 s83, s83
    s_lshl_b32 s83, s83, 4
    s_add_u32 s83, s83, 0x5a5a5a00
    s_mov_b32 s50, s83
    s_add_u32 s80, s83, s59
    v_mov_b32 v24, s80
    s_lshl_b32 s80, s45, 5
    s_add_u32 s80, s80, s46
    s_lshl_b32 s80, s80, 4
    s_add_u32 s92, s80, 28672
    s_add_u32 s80, s80, 24576
    s_cmp_eq_u32 s44, 0
    s_cselect_b32 s80, s80, 0x40000000
    s_cselect_b32 s92, s92, 0x40000000
    v_mov_b32 v25, 0
    s_mov_b64 exec, 1
    buffer_store_dword v24, v25, s[4:7], s80 offen sc1
    s_mov_b64 exec, -1
    v_mfma_f32_16x16x32_bf16 v[44:47], a[52:55], v[120:123], v[44:47]
    ds_read_b64_tr_b16 v[118:119], v137 offset:45344
    s_waitcnt lgkmcnt(12)
    v_mfma_f32_16x16x32_bf16 v[48:51], a[48:51], v[124:127], v[48:51]
    ds_read_b64_tr_b16 v[120:121], v137 offset:44096
    v_mfma_f32_16x16x32_bf16 v[52:55], a[52:55], v[124:127], v[52:55]
    ds_read_b64_tr_b16 v[122:123], v137 offset:45376
    v_lshlrev_b32 v26, 4, v26
    v_bfe_u32 v28, v27, 1, 2
    s_waitcnt lgkmcnt(12)
    v_mfma_f32_16x16x32_bf16 v[56:59], a[48:51], v[128:131], v[56:59]
    ds_read_b64_tr_b16 v[124:125], v137 offset:44128
    s_add_u32 s80, s94, 1475840
    s_add_u32 m0, s81, 151552
    s_nop 0
    buffer_load_dwordx4 v216, s[12:15], s80 offen lds
    v_mfma_f32_16x16x32_bf16 v[60:63], a[52:55], v[128:131], v[60:63]
    ds_read_b64_tr_b16 v[126:127], v137 offset:45408
    v_and_or_b32 v28, v27, -8, v28
    s_waitcnt lgkmcnt(12)
    v_mfma_f32_16x16x32_bf16 v[64:67], a[48:51], v[132:135], v[64:67]
    ds_read_b64_tr_b16 v[128:129], v137 offset:44160
    v_and_b32 v27, 1, v27
    v_lshl_or_b32 v28, v27, 2, v28
    v_mad_u32_u24 v221, v28, s62, v26
    v_mfma_f32_16x16x32_bf16 v[68:71], a[52:55], v[132:135], v[68:71]
    ds_read_b64_tr_b16 v[130:131], v137 offset:45440
    v_mov_b32 v16, 0xc0135761
    v_mov_b32 v17, 0xbdd2d3e8
    s_waitcnt lgkmcnt(12)
    v_mfma_f32_16x16x32_bf16 v[72:75], a[48:51], v[104:107], v[72:75]
    ds_read_b64_tr_b16 v[132:133], v91 offset:44032
    v_mov_b32 v18, 1.0
    v_mov_b32 v19, 0x358637bd
    s_mul_i32 s60, s56, 10
    v_mfma_f32_16x16x32_bf16 v[76:79], a[52:55], v[104:107], v[76:79]
    v_add_u32 v26, s60, v22
    v_lshlrev_b32 v20, 8, v26
    v_lshl_add_u32 v20, v23, 4, v20
    v_lshrrev_b32 v26, 1, v22
    v_mfma_f32_16x16x32_bf16 v[196:199], v[168:171], v[104:107], v[196:199]
    ds_read_b64_tr_b16 v[134:135], v91 offset:45312
    v_add3_u32 v26, v26, s60, 8
    v_lshlrev_b32 v21, 8, v26
    s_waitcnt lgkmcnt(12)
    v_mfma_f32_16x16x32_bf16 v[192:195], v[168:171], v[108:111], v[192:195]
    ds_read_b64_tr_b16 v[104:105], v137 offset:49152
    ds_read_b64_tr_b16 v[106:107], v137 offset:50432
    s_add_u32 s80, s94, 1967360
    s_waitcnt lgkmcnt(12)
    v_mfma_f32_16x16x32_bf16 v[40:43], a[56:59], v[112:115], v[40:43]
    ds_read_b64_tr_b16 v[108:109], v137 offset:49184
    s_add_u32 m0, s81, 0
    s_nop 0
    buffer_load_dwordx4 v212, s[12:15], s80 offen lds
    v_mfma_f32_16x16x32_bf16 v[44:47], a[60:63], v[112:115], v[44:47]
    ds_read_b64_tr_b16 v[110:111], v137 offset:50464
    v_lshl_add_u32 v21, v23, 4, v21
    v_and_b32 v26, 1, v22
    s_waitcnt lgkmcnt(12)
    v_mfma_f32_16x16x32_bf16 v[48:51], a[56:59], v[116:119], v[48:51]
    ds_read_b64_tr_b16 v[112:113], v137 offset:49216
    v_lshl_add_u32 v21, v26, 3, v21
    s_mul_i32 s51, s54, 153600
    s_add_u32 s51, s51, 1597440
    v_mfma_f32_16x16x32_bf16 v[52:55], a[60:63], v[116:119], v[52:55]
    ds_read_b64_tr_b16 v[114:115], v137 offset:50496
    s_add_u32 s51, s51, s81
    s_mul_i32 s95, s56, 102400
    s_waitcnt lgkmcnt(12)
    v_mfma_f32_16x16x32_bf16 v[56:59], a[56:59], v[120:123], v[56:59]
    ds_read_b64_tr_b16 v[116:117], v137 offset:49248
    s_add_u32 s80, s94, 1967360
    s_add_u32 m0, s81, 4096
    s_nop 0
    buffer_load_dwordx4 v213, s[12:15], s80 offen lds
    v_mfma_f32_16x16x32_bf16 v[60:63], a[60:63], v[120:123], v[60:63]
    ds_read_b64_tr_b16 v[118:119], v137 offset:50528
    s_add_u32 s95, s95, 4055040
    s_waitcnt lgkmcnt(12)
    v_mfma_f32_16x16x32_bf16 v[64:67], a[56:59], v[124:127], v[64:67]
    ds_read_b64_tr_b16 v[120:121], v137 offset:49280
    s_add_u32 s95, s95, s81
    s_mul_i32 s96, s54, 122880
    s_add_u32 s96, s96, 4874240
    v_mfma_f32_16x16x32_bf16 v[68:71], a[60:63], v[124:127], v[68:71]
    ds_read_b64_tr_b16 v[122:123], v137 offset:50560
    s_add_u32 s96, s96, s81
    s_mul_i32 s97, s56, 122880
    s_waitcnt lgkmcnt(12)
    v_mfma_f32_16x16x32_bf16 v[72:75], a[56:59], v[128:131], v[72:75]
    ds_read_b64_tr_b16 v[124:125], v91 offset:49152
    s_waitcnt vmcnt(9)
    ds_read_b128 a[128:131], v96 offset:32768
    ds_read_b128 a[132:135], v96 offset:36864
    s_waitcnt lgkmcnt(14)
    ds_read_b128 a[136:139], v97 offset:32768
    s_waitcnt lgkmcnt(14)
    ds_read_b128 a[140:143], v97 offset:36864
    s_waitcnt lgkmcnt(14)
    ds_read_b128 a[144:147], v98 offset:32768
    s_waitcnt lgkmcnt(14)
    ds_read_b128 a[148:151], v98 offset:36864
    s_waitcnt lgkmcnt(14)
    ds_read_b128 a[152:155], v99 offset:32768
    s_waitcnt lgkmcnt(14)
    ds_read_b128 a[156:159], v99 offset:36864
    v_mfma_f32_16x16x32_bf16 v[76:79], a[60:63], v[128:131], v[76:79]
    v_mfma_f32_16x16x32_bf16 v[196:199], v[168:171], v[128:131], v[196:199]
    s_waitcnt lgkmcnt(14)
    ds_read_b64_tr_b16 v[126:127], v91 offset:50432
    s_add_u32 s97, s97, 6840320
    v_mfma_f32_16x16x32_bf16 v[192:195], v[168:171], v[132:135], v[192:195]
    s_waitcnt lgkmcnt(14)
    ds_read_b64_tr_b16 v[128:129], v137 offset:54272
    s_waitcnt lgkmcnt(14)
    ds_read_b64_tr_b16 v[130:131], v137 offset:55552
    v_mfma_f32_16x16x32_bf16 v[40:43], a[64:67], v[104:107], v[40:43]
    s_waitcnt lgkmcnt(14)
    ds_read_b64_tr_b16 v[132:133], v137 offset:54304
    s_add_u32 s80, s94, 1967360
    v_mfma_f32_16x16x32_bf16 v[44:47], a[68:71], v[104:107], v[44:47]
    s_waitcnt lgkmcnt(14)
    ds_read_b64_tr_b16 v[134:135], v137 offset:55584
    s_add_u32 m0, s81, 8192
    v_mfma_f32_16x16x32_bf16 v[48:51], a[64:67], v[108:111], v[48:51]
    s_waitcnt lgkmcnt(14)
    ds_read_b64_tr_b16 v[104:105], v137 offset:54336
    buffer_load_dwordx4 v214, s[12:15], s80 offen lds
    v_mfma_f32_16x16x32_bf16 v[52:55], a[68:71], v[108:111], v[52:55]
    s_waitcnt lgkmcnt(14)
    ds_read_b64_tr_b16 v[106:107], v137 offset:55616
    s_add_u32 s97, s97, s81
    v_mfma_f32_16x16x32_bf16 v[56:59], a[64:67], v[112:115], v[56:59]
    s_waitcnt lgkmcnt(14)
    ds_read_b64_tr_b16 v[108:109], v137 offset:54368
    s_add_u32 s80, s94, 1967360
    s_add_u32 m0, s81, 12288
    v_mfma_f32_16x16x32_bf16 v[60:63], a[68:71], v[112:115], v[60:63]
    s_waitcnt lgkmcnt(14)
    ds_read_b64_tr_b16 v[110:111], v137 offset:55648
    buffer_load_dwordx4 v215, s[12:15], s80 offen lds
    v_mfma_f32_16x16x32_bf16 v[64:67], a[64:67], v[116:119], v[64:67]
    s_waitcnt lgkmcnt(14)
    ds_read_b64_tr_b16 v[112:113], v137 offset:54400
    v_add_u32 v26, s81, v1
    v_mfma_f32_16x16x32_bf16 v[68:71], a[68:71], v[116:119], v[68:71]
    s_waitcnt lgkmcnt(14)
    ds_read_b64_tr_b16 v[114:115], v137 offset:55680
    s_add_u32 s68, s44, 1
    v_mfma_f32_16x16x32_bf16 v[72:75], a[64:67], v[120:123], v[72:75]
    s_waitcnt lgkmcnt(14)
    ds_read_b64_tr_b16 v[116:117], v91 offset:54272
    s_waitcnt lgkmcnt(12)
    v_mfma_f32_16x16x32_bf16 v[200:203], v[168:171], a[128:131], v[200:203]
    v_mfma_f32_16x16x32_bf16 v[228:231], a[128:131], a[128:131], v[228:231]
    v_mfma_f32_16x16x32_bf16 v[204:207], v[168:171], a[132:135], v[204:207]
    v_mfma_f32_16x16x32_bf16 v[232:235], a[132:135], a[132:135], v[232:235]
    v_mfma_f32_16x16x32_bf16 v[200:203], v[168:171], a[136:139], v[200:203]
    v_mfma_f32_16x16x32_bf16 v[228:231], a[136:139], a[136:139], v[228:231]
    v_mfma_f32_16x16x32_bf16 v[204:207], v[168:171], a[140:143], v[204:207]
    v_mfma_f32_16x16x32_bf16 v[232:235], a[140:143], a[140:143], v[232:235]
    v_mfma_f32_16x16x32_bf16 v[200:203], v[168:171], a[144:147], v[200:203]
    v_mfma_f32_16x16x32_bf16 v[228:231], a[144:147], a[144:147], v[228:231]
    v_mfma_f32_16x16x32_bf16 v[204:207], v[168:171], a[148:151], v[204:207]
    v_mfma_f32_16x16x32_bf16 v[232:235], a[148:151], a[148:151], v[232:235]
    v_mfma_f32_16x16x32_bf16 v[200:203], v[168:171], a[152:155], v[200:203]
    v_mfma_f32_16x16x32_bf16 v[228:231], a[152:155], a[152:155], v[228:231]
    v_mfma_f32_16x16x32_bf16 v[204:207], v[168:171], a[156:159], v[204:207]
    v_mfma_f32_16x16x32_bf16 v[232:235], a[156:159], a[156:159], v[232:235]
    v_mfma_f32_16x16x32_bf16 v[76:79], a[68:71], v[120:123], v[76:79]
    v_mfma_f32_16x16x32_bf16 v[196:199], v[168:171], v[120:123], v[196:199]
    ds_read_b64_tr_b16 v[118:119], v91 offset:55552
    s_lshr_b32 s68, s68, 1
    s_lshl_b32 s60, s44, 2
    s_waitcnt lgkmcnt(12)
    v_mfma_f32_16x16x32_bf16 v[192:195], v[168:171], v[124:127], v[192:195]
    ds_read_b64_tr_b16 v[120:121], v137 offset:59392
    ds_read_b64_tr_b16 v[122:123], v137 offset:60672
    s_add_u32 s80, s94, 1967360
    s_waitcnt lgkmcnt(12)
    v_mfma_f32_16x16x32_bf16 v[40:43], a[72:75], v[128:131], v[40:43]
    ds_read_b64_tr_b16 v[124:125], v137 offset:59424
    s_add_u32 m0, s81, 16384
    s_nop 0
    buffer_load_dwordx4 v216, s[12:15], s80 offen lds
    v_mfma_f32_16x16x32_bf16 v[44:47], a[76:79], v[128:131], v[44:47]
    ds_read_b64_tr_b16 v[126:127], v137 offset:60704
    s_lshr_b32 s69, 0x3422, s60
    s_and_b32 s69, s69, 15
    s_waitcnt lgkmcnt(12)
    v_mfma_f32_16x16x32_bf16 v[48:51], a[72:75], v[132:135], v[48:51]
    ds_read_b64_tr_b16 v[128:129], v137 offset:59456
    s_lshr_b32 s70, 0x4433, s60
    s_and_b32 s70, s70, 15
    s_lshl_b32 s60, s68, 12
    v_mfma_f32_16x16x32_bf16 v[52:55], a[76:79], v[132:135], v[52:55]
    ds_read_b64_tr_b16 v[130:131], v137 offset:60736
    v_add_u32 v27, s60, v1
    s_lshl_b32 s60, s69, 12
    s_waitcnt lgkmcnt(12)
    v_mfma_f32_16x16x32_bf16 v[56:59], a[72:75], v[104:107], v[56:59]
    ds_read_b64_tr_b16 v[132:133], v137 offset:59488
    v_add_u32 v28, s60, v1
    s_lshl_b32 s60, s70, 12
    v_add_u32 v29, s60, v1
    v_mfma_f32_16x16x32_bf16 v[60:63], a[76:79], v[104:107], v[60:63]
    ds_read_b64_tr_b16 v[134:135], v137 offset:60768
    s_lshl_b32 s60, s68, 4
    v_lshl_add_u32 v39, v22, 2, s60
    s_waitcnt lgkmcnt(12)
    v_mfma_f32_16x16x32_bf16 v[64:67], a[72:75], v[108:111], v[64:67]
    ds_read_b64_tr_b16 v[104:105], v137 offset:59520
    v_cmp_le_u32 vcc, 20, v39
    v_cmp_gt_u32 s[72:73], 40, v39
    v_mov_b32 v36, 0x40000000
    v_mfma_f32_16x16x32_bf16 v[68:71], a[76:79], v[108:111], v[68:71]
    ds_read_b64_tr_b16 v[106:107], v137 offset:60800
    v_cndmask_b32 v30, 0, 1, vcc
    v_mul_u32_u24 v31, 800, v30
    s_waitcnt lgkmcnt(12)
    v_mfma_f32_16x16x32_bf16 v[72:75], a[72:75], v[112:115], v[72:75]
    ds_read_b64_tr_b16 v[108:109], v91 offset:59392
    v_lshl_add_u32 v31, v39, 1, v31
    v_mul_u32_u24 v35, 20, v30
    s_lshl_b32 s60, s69, 4
    v_mfma_f32_16x16x32_bf16 v[76:79], a[76:79], v[112:115], v[76:79]
    s_sub_u32 s60, s60, 40
    v_add_u32 v37, s60, v23
    v_sub_u32 v37, v37, v35
    v_cmp_gt_u32 vcc, 20, v37
    v_mfma_f32_16x16x32_bf16 v[196:199], v[168:171], v[112:115], v[196:199]
    ds_read_b64_tr_b16 v[110:111], v91 offset:60672
    v_mul_u32_u24 v37, 40, v37
    s_and_b64 vcc, vcc, s[72:73]
    s_waitcnt lgkmcnt(12)
    v_mfma_f32_16x16x32_bf16 v[192:195], v[168:171], v[116:119], v[192:195]
    s_waitcnt vmcnt(7)
    s_barrier
    ds_read_b64_tr_b16 v[112:113], v137 offset:64512
    ds_read_b64_tr_b16 v[114:115], v138 offset:256
    s_waitcnt lgkmcnt(12)
    v_mfma_f32_16x16x32_bf16 v[40:43], a[80:83], v[120:123], v[40:43]
    ds_read_b64_tr_b16 v[116:117], v137 offset:64544
    v_add_u32 v37, v37, v31
    v_mfma_f32_16x16x32_bf16 v[44:47], a[84:87], v[120:123], v[44:47]
    ds_read_b64_tr_b16 v[118:119], v138 offset:288
    v_cndmask_b32 v33, v36, v37, vcc
    s_lshl_b32 s60, s70, 4
    s_waitcnt lgkmcnt(12)
    v_mfma_f32_16x16x32_bf16 v[48:51], a[80:83], v[124:127], v[48:51]
    ds_read_b64_tr_b16 v[120:121], v137 offset:64576
    s_sub_u32 s60, s60, 40
    v_add_u32 v37, s60, v23
    v_sub_u32 v37, v37, v35
    v_mfma_f32_16x16x32_bf16 v[52:55], a[84:87], v[124:127], v[52:55]
    ds_read_b64_tr_b16 v[122:123], v138 offset:320
    v_cmp_gt_u32 vcc, 20, v37
    v_mul_u32_u24 v37, 40, v37
    s_waitcnt lgkmcnt(12)
    v_mfma_f32_16x16x32_bf16 v[56:59], a[80:83], v[128:131], v[56:59]
    ds_read_b64_tr_b16 v[124:125], v137 offset:64608
    s_add_u32 s80, s94, 0
    s_add_u32 m0, s81, 20480
    s_nop 0
    buffer_load_dwordx4 v217, s[12:15], s80 offen lds
    v_mfma_f32_16x16x32_bf16 v[60:63], a[84:87], v[128:131], v[60:63]
    ds_read_b64_tr_b16 v[126:127], v138 offset:352
    s_and_b64 vcc, vcc, s[72:73]
    s_waitcnt lgkmcnt(12)
    v_mfma_f32_16x16x32_bf16 v[64:67], a[80:83], v[132:135], v[64:67]
    ds_read_b64_tr_b16 v[128:129], v137 offset:64640
    v_add_u32 v37, v37, v31
    v_cndmask_b32 v34, v36, v37, vcc
    v_cmp_eq_u32 vcc, 0, v23
    v_mfma_f32_16x16x32_bf16 v[68:71], a[84:87], v[132:135], v[68:71]
    ds_read_b64_tr_b16 v[130:131], v138 offset:384
    v_add_u32 v37, 800, v31
    s_and_b64 vcc, vcc, s[72:73]
    s_waitcnt lgkmcnt(12)
    v_mfma_f32_16x16x32_bf16 v[72:75], a[80:83], v[104:107], v[72:75]
    ds_read_b64_tr_b16 v[132:133], v91 offset:64512
    v_cndmask_b32 v35, v36, v37, vcc
    s_mul_i32 s71, s54, 28672
    s_add_u32 s71, s71, 32768
    v_mfma_f32_16x16x32_bf16 v[76:79], a[84:87], v[104:107], v[76:79]
    s_lshl_b32 s60, s45, 1
    s_add_u32 s60, s60, s53
    s_mul_i32 s60, s60, 1792
    s_add_u32 s74, s60, s71
    v_mfma_f32_16x16x32_bf16 v[196:199], v[168:171], v[104:107], v[196:199]
    ds_read_b64_tr_b16 v[134:135], v92 offset:256
    v_cmp_gt_u32 s[66:67], 8, v23
    v_and_b32 v30, 31, v15
    s_waitcnt lgkmcnt(12)
    v_mfma_f32_16x16x32_bf16 v[192:195], v[168:171], v[108:111], v[192:195]
    ds_read_b64_tr_b16 v[104:105], v138 offset:4096
    ds_read_b64_tr_b16 v[106:107], v138 offset:5376
    s_mul_i32 s60, s44, 27
    s_waitcnt lgkmcnt(12)
    v_mfma_f32_16x16x32_bf16 v[40:43], a[88:91], v[112:115], v[40:43]
    ds_read_b64_tr_b16 v[108:109], v138 offset:4128
    s_add_u32 s80, s94, 0
    s_add_u32 m0, s81, 24576
    s_nop 0
    buffer_load_dwordx4 v218, s[12:15], s80 offen lds
    v_mfma_f32_16x16x32_bf16 v[44:47], a[92:95], v[112:115], v[44:47]
    ds_read_b64_tr_b16 v[110:111], v138 offset:5408
    v_add_u32 v39, s60, v30
    s_waitcnt lgkmcnt(12)
    v_mfma_f32_16x16x32_bf16 v[48:51], a[88:91], v[116:119], v[48:51]
    ds_read_b64_tr_b16 v[112:113], v138 offset:4160
    v_lshrrev_b32 v31, 5, v15
    v_mul_u32_u24 v37, 1792, v31
    v_lshl_add_u32 v37, v39, 4, v37
    v_mfma_f32_16x16x32_bf16 v[52:55], a[92:95], v[116:119], v[52:55]
    ds_read_b64_tr_b16 v[114:115], v138 offset:5440
    v_cmp_gt_u32 vcc, 105, v39
    s_nop 1
    v_cndmask_b32 v37, v36, v37, vcc
    s_waitcnt lgkmcnt(12)
    v_mfma_f32_16x16x32_bf16 v[56:59], a[88:91], v[120:123], v[56:59]
    ds_read_b64_tr_b16 v[116:117], v138 offset:4192
    v_cmp_gt_u32 vcc, 27, v30
    s_nop 1
    v_cndmask_b32 v37, v36, v37, vcc
    v_lshlrev_b32 v39, 5, v39
    v_mfma_f32_16x16x32_bf16 v[60:63], a[92:95], v[120:123], v[60:63]
    ds_read_b64_tr_b16 v[118:119], v138 offset:5472
    v_lshl_add_u32 v39, v31, 4, v39
    v_add_u32 v39, 157952, v39
    s_waitcnt lgkmcnt(12)
    v_mfma_f32_16x16x32_bf16 v[64:67], a[88:91], v[124:127], v[64:67]
    ds_read_b64_tr_b16 v[120:121], v138 offset:4224
    v_lshlrev_b32 v32, 2, v23
    v_add_u32 v32, 156928, v32
    v_lshlrev_b32 v38, 4, v22
    v_mfma_f32_16x16x32_bf16 v[68:71], a[92:95], v[124:127], v[68:71]
    ds_read_b64_tr_b16 v[122:123], v138 offset:5504
    v_add_u32 v38, 157248, v38
    s_lshl_b32 s65, s44, 8
    s_waitcnt lgkmcnt(12)
    v_mfma_f32_16x16x32_bf16 v[72:75], a[88:91], v[128:131], v[72:75]
    ds_read_b64_tr_b16 v[124:125], v92 offset:4096
    s_add_u32 s80, s94, 0
    s_add_u32 m0, s81, 28672
    s_nop 0
    buffer_load_dwordx4 v219, s[12:15], s80 offen lds
    v_mfma_f32_16x16x32_bf16 v[76:79], a[92:95], v[128:131], v[76:79]
    s_add_u32 s65, s65, 155904
    v_lshl_add_u32 v30, v23, 2, s65
    v_and_b32 v31, 3, v23
    v_mfma_f32_16x16x32_bf16 v[196:199], v[168:171], v[128:131], v[196:199]
    ds_read_b64_tr_b16 v[126:127], v92 offset:5376
    v_cmp_eq_u32 s[84:85], 1, v31
    v_cmp_eq_u32 s[76:77], 2, v31
    s_waitcnt lgkmcnt(12)
    v_mfma_f32_16x16x32_bf16 v[192:195], v[168:171], v[132:135], v[192:195]
    ds_read_b64_tr_b16 v[128:129], v138 offset:9216
    ds_read_b64_tr_b16 v[130:131], v138 offset:10496
    v_cmp_eq_u32 s[88:89], 3, v31
    s_waitcnt lgkmcnt(12)
    v_mfma_f32_16x16x32_bf16 v[40:43], a[96:99], v[104:107], v[40:43]
    ds_read_b64_tr_b16 v[132:133], v138 offset:9248
    v_mov_b32 v201, v204
    v_cndmask_b32 v228, v228, v229, s[84:85]
    v_cndmask_b32 v228, v228, v230, s[76:77]
    v_mfma_f32_16x16x32_bf16 v[44:47], a[100:103], v[104:107], v[44:47]
    ds_read_b64_tr_b16 v[134:135], v138 offset:10528
    v_cndmask_b32 v204, v228, v231, s[88:89]
    v_cndmask_b32 v232, v232, v233, s[84:85]
    s_waitcnt lgkmcnt(12)
    v_mfma_f32_16x16x32_bf16 v[48:51], a[96:99], v[108:111], v[48:51]
    ds_read_b64_tr_b16 v[104:105], v138 offset:9280
    v_cndmask_b32 v232, v232, v234, s[76:77]
    v_cndmask_b32 v205, v232, v235, s[88:89]
    s_mov_b32 s60, 0xbacccccd
    v_mfma_f32_16x16x32_bf16 v[52:55], a[100:103], v[108:111], v[52:55]
    ds_read_b64_tr_b16 v[106:107], v138 offset:10560
    s_mov_b32 s61, 0x3acccccd
    v_mul_f32 v200, s60, v200
    s_waitcnt lgkmcnt(12)
    v_mfma_f32_16x16x32_bf16 v[56:59], a[96:99], v[112:115], v[56:59]
    ds_read_b64_tr_b16 v[108:109], v138 offset:9312
    v_mul_f32 v201, s60, v201
    v_mul_f32 v202, s60, v202
    v_mul_f32 v203, s60, v203
    v_mfma_f32_16x16x32_bf16 v[60:63], a[100:103], v[112:115], v[60:63]
    ds_read_b64_tr_b16 v[110:111], v138 offset:10592
    v_mul_f32 v208, v200, v200
    v_mul_f32 v209, v201, v201
    s_waitcnt lgkmcnt(12)
    v_mfma_f32_16x16x32_bf16 v[64:67], a[96:99], v[116:119], v[64:67]
    ds_read_b64_tr_b16 v[112:113], v138 offset:9344
    s_add_u32 s80, s94, 0
    s_add_u32 m0, s81, 32768
    s_nop 0
    buffer_load_dwordx4 v220, s[12:15], s80 offen lds
    v_mfma_f32_16x16x32_bf16 v[68:71], a[100:103], v[116:119], v[68:71]
    ds_read_b64_tr_b16 v[114:115], v138 offset:10624
    v_mul_f32 v210, v202, v202
    s_waitcnt lgkmcnt(12)
    v_mfma_f32_16x16x32_bf16 v[72:75], a[96:99], v[120:123], v[72:75]
    ds_read_b64_tr_b16 v[116:117], v92 offset:9216
    v_mul_f32 v211, v203, v203
    v_fma_f32 v204, v204, s61, -v208
    v_fma_f32 v205, v205, s61, -v209
    v_mfma_f32_16x16x32_bf16 v[76:79], a[100:103], v[120:123], v[76:79]
    v_fma_f32 v206, v206, s61, -v210
    v_fma_f32 v207, v207, s61, -v211
    v_max_f32 v204, 0, v204
    v_max_f32 v205, 0, v205
    v_mfma_f32_16x16x32_bf16 v[196:199], v[168:171], v[120:123], v[196:199]
    ds_read_b64_tr_b16 v[118:119], v92 offset:10496
    v_max_f32 v206, 0, v206
    v_max_f32 v207, 0, v207
    s_waitcnt lgkmcnt(12)
    v_mfma_f32_16x16x32_bf16 v[192:195], v[168:171], v[124:127], v[192:195]
    ds_read_b64_tr_b16 v[120:121], v138 offset:14336
    ds_read_b64_tr_b16 v[122:123], v138 offset:15616
    v_add_f32 v204, 0x3727c5ac, v204
    s_waitcnt lgkmcnt(12)
    v_mfma_f32_16x16x32_bf16 v[40:43], a[104:107], v[128:131], v[40:43]
    ds_read_b64_tr_b16 v[124:125], v138 offset:14368
    v_add_f32 v205, 0x3727c5ac, v205
    v_add_f32 v206, 0x3727c5ac, v206
    v_add_f32 v207, 0x3727c5ac, v207
    v_mfma_f32_16x16x32_bf16 v[44:47], a[108:111], v[128:131], v[44:47]
    ds_read_b64_tr_b16 v[126:127], v138 offset:15648
    v_rsq_f32 v204, v204
    v_rsq_f32 v205, v205
    s_waitcnt lgkmcnt(12)
    v_mfma_f32_16x16x32_bf16 v[48:51], a[104:107], v[132:135], v[48:51]
    ds_read_b64_tr_b16 v[128:129], v138 offset:14400
    s_add_u32 s80, s94, 0
    s_add_u32 m0, s81, 36864
    s_nop 0
    buffer_load_dwordx4 v221, s[12:15], s80 offen lds
    v_mfma_f32_16x16x32_bf16 v[52:55], a[108:111], v[132:135], v[52:55]
    ds_read_b64_tr_b16 v[130:131], v138 offset:15680
    v_rsq_f32 v206, v206
    s_waitcnt lgkmcnt(12)
    v_mfma_f32_16x16x32_bf16 v[56:59], a[104:107], v[104:107], v[56:59]
    ds_read_b64_tr_b16 v[132:133], v138 offset:14432
    v_rsq_f32 v207, v207
    s_mov_b32 exec_lo, 0x00f0000f
    s_mov_b32 exec_hi, 0xf0000f00
    ds_write_b32 v30, v200 offset:0
    ds_write_b32 v30, v204 offset:128
    s_waitcnt lgkmcnt(14)
    ds_write_b32 v30, v201 offset:64
    s_waitcnt lgkmcnt(14)
    ds_write_b32 v30, v205 offset:192
    s_mov_b64 exec, -1
    v_mfma_f32_16x16x32_bf16 v[60:63], a[108:111], v[104:107], v[60:63]
    s_waitcnt lgkmcnt(14)
    ds_read_b64_tr_b16 v[134:135], v138 offset:15712
    v_mfma_f32_16x16x32_bf16 v[64:67], a[104:107], v[108:111], v[64:67]
    s_waitcnt lgkmcnt(14)
    ds_read_b64_tr_b16 v[104:105], v138 offset:14464
    v_mfma_f32_16x16x32_bf16 v[68:71], a[108:111], v[108:111], v[68:71]
    s_waitcnt lgkmcnt(14)
    ds_read_b64_tr_b16 v[106:107], v138 offset:15744
    v_mfma_f32_16x16x32_bf16 v[72:75], a[104:107], v[112:115], v[72:75]
    s_waitcnt lgkmcnt(14)
    ds_read_b64_tr_b16 v[108:109], v92 offset:14336
    v_lshl_add_u32 v30, v22, 4, s65
    v_lshl_add_u32 v31, v23, 2, s65
    v_mfma_f32_16x16x32_bf16 v[76:79], a[108:111], v[112:115], v[76:79]
    s_waitcnt lgkmcnt(14)
    ds_read_b128 v[144:147], v30 offset:0
    s_waitcnt lgkmcnt(14)
    ds_read_b128 v[152:155], v30 offset:128
    v_mfma_f32_16x16x32_bf16 v[196:199], v[168:171], v[112:115], v[196:199]
    s_waitcnt lgkmcnt(14)
    ds_read_b64_tr_b16 v[110:111], v92 offset:15616
    s_waitcnt lgkmcnt(14)
    ds_read_b32 v174, v31 offset:0
    v_mfma_f32_16x16x32_bf16 v[192:195], v[168:171], v[116:119], v[192:195]
    s_waitcnt vmcnt(5)
    s_barrier
    s_waitcnt lgkmcnt(14)
    ds_read_b64_tr_b16 v[112:113], v138 offset:19456
    s_waitcnt lgkmcnt(14)
    ds_read_b64_tr_b16 v[114:115], v138 offset:20736
    v_mfma_f32_16x16x32_bf16 v[40:43], a[112:115], v[120:123], v[40:43]
    s_waitcnt lgkmcnt(14)
    ds_read_b64_tr_b16 v[116:117], v138 offset:19488
    v_mfma_f32_16x16x32_bf16 v[44:47], a[116:119], v[120:123], v[44:47]
    s_waitcnt lgkmcnt(14)
    ds_read_b64_tr_b16 v[118:119], v138 offset:20768
    v_mfma_f32_16x16x32_bf16 v[48:51], a[112:115], v[124:127], v[48:51]
    s_waitcnt lgkmcnt(14)
    ds_read_b64_tr_b16 v[120:121], v138 offset:19520
    s_add_u32 s80, s94, 983040
    v_mfma_f32_16x16x32_bf16 v[52:55], a[116:119], v[124:127], v[52:55]
    s_waitcnt lgkmcnt(14)
    ds_read_b64_tr_b16 v[122:123], v138 offset:20800
    s_add_u32 m0, s81, 40960
    v_mfma_f32_16x16x32_bf16 v[56:59], a[112:115], v[128:131], v[56:59]
    s_waitcnt lgkmcnt(14)
    ds_read_b64_tr_b16 v[124:125], v138 offset:19552
    buffer_load_dwordx4 v217, s[12:15], s80 offen lds
    v_mfma_f32_16x16x32_bf16 v[60:63], a[116:119], v[128:131], v[60:63]
    s_waitcnt lgkmcnt(14)
    ds_read_b64_tr_b16 v[126:127], v138 offset:20832
    s_waitcnt lgkmcnt(14)
    ds_read_b32 v176, v31 offset:128
    v_mfma_f32_16x16x32_bf16 v[64:67], a[112:115], v[132:135], v[64:67]
    s_waitcnt lgkmcnt(14)
    ds_read_b64_tr_b16 v[128:129], v138 offset:19584
    s_waitcnt lgkmcnt(14)
    ds_read_b128 v[148:151], v30 offset:64
    v_mfma_f32_16x16x32_bf16 v[68:71], a[116:119], v[132:135], v[68:71]
    s_waitcnt lgkmcnt(14)
    ds_read_b64_tr_b16 v[130:131], v138 offset:20864
    v_mfma_f32_16x16x32_bf16 v[72:75], a[112:115], v[104:107], v[72:75]
    s_waitcnt lgkmcnt(14)
    ds_read_b64_tr_b16 v[132:133], v92 offset:19456
    s_add_u32 s80, s94, 983040
    s_add_u32 m0, s81, 45056
    v_mfma_f32_16x16x32_bf16 v[76:79], a[116:119], v[104:107], v[76:79]
    buffer_load_dwordx4 v218, s[12:15], s80 offen lds
    s_waitcnt lgkmcnt(14)
    ds_read_b128 v[156:159], v30 offset:192
    v_mfma_f32_16x16x32_bf16 v[196:199], v[168:171], v[104:107], v[196:199]
    s_waitcnt lgkmcnt(14)
    ds_read_b64_tr_b16 v[134:135], v92 offset:20736
    s_waitcnt lgkmcnt(14)
    ds_read_b32 v175, v31 offset:64
    v_mfma_f32_16x16x32_bf16 v[192:195], v[168:171], v[108:111], v[192:195]
    s_waitcnt lgkmcnt(14)
    ds_read_b64_tr_b16 v[104:105], v136 offset:0
    s_waitcnt lgkmcnt(14)
    ds_read_b64_tr_b16 v[106:107], v136 offset:1280
    v_mfma_f32_16x16x32_bf16 v[40:43], a[120:123], v[112:115], v[40:43]
    s_waitcnt lgkmcnt(14)
    ds_read_b64_tr_b16 v[108:109], v136 offset:32
    v_mfma_f32_16x16x32_bf16 v[44:47], a[124:127], v[112:115], v[44:47]
    s_waitcnt lgkmcnt(14)
    ds_read_b64_tr_b16 v[110:111], v136 offset:1312
    s_lshl_b32 s80, s45, 5
    v_and_b32 v88, 31, v15
    v_add_lshl_u32 v88, s80, v88, 4
    v_lshlrev_b32 v89, 4, v0
    s_mov_b32 s93, 24576
    buffer_load_dword v141, v88, s[4:7], s93 offen sc1
    buffer_load_dword v142, v89, s[4:7], s93 offen sc1
    v_mfma_f32_16x16x32_bf16 v[48:51], a[120:123], v[116:119], v[48:51]
    s_waitcnt lgkmcnt(14)
    ds_read_b64_tr_b16 v[112:113], v136 offset:64
    v_mfma_f32_16x16x32_bf16 v[52:55], a[124:127], v[116:119], v[52:55]
    s_waitcnt lgkmcnt(14)
    ds_read_b64_tr_b16 v[114:115], v136 offset:1344
    v_mfma_f32_16x16x32_bf16 v[56:59], a[120:123], v[120:123], v[56:59]
    s_waitcnt lgkmcnt(14)
    ds_read_b64_tr_b16 v[116:117], v136 offset:96
    s_add_u32 s80, s94, 983040
    v_mfma_f32_16x16x32_bf16 v[60:63], a[124:127], v[120:123], v[60:63]
    s_waitcnt lgkmcnt(14)
    ds_read_b64_tr_b16 v[118:119], v136 offset:1376
    s_add_u32 m0, s81, 49152
    v_mfma_f32_16x16x32_bf16 v[64:67], a[120:123], v[124:127], v[64:67]
    s_waitcnt lgkmcnt(14)
    ds_read_b64_tr_b16 v[120:121], v136 offset:128
    buffer_load_dwordx4 v219, s[12:15], s80 offen lds
    v_mfma_f32_16x16x32_bf16 v[68:71], a[124:127], v[124:127], v[68:71]
    s_waitcnt lgkmcnt(14)
    ds_read_b64_tr_b16 v[122:123], v136 offset:1408
    s_waitcnt lgkmcnt(14)
    ds_read_b32 v177, v31 offset:192
    v_mfma_f32_16x16x32_bf16 v[72:75], a[120:123], v[128:131], v[72:75]
    s_waitcnt lgkmcnt(14)
    ds_read_b64_tr_b16 v[124:125], v90 offset:0
    s_mov_b32 s60, 0x3fb8aa3b
    v_mfma_f32_16x16x32_bf16 v[76:79], a[124:127], v[128:131], v[76:79]
    s_waitcnt lgkmcnt(1)
    v_mul_f32 v160, s60, v152
    v_mul_f32 v161, s60, v153
    v_mul_f32 v162, s60, v154
    v_mfma_f32_16x16x32_bf16 v[196:199], v[168:171], v[128:131], v[196:199]
    ds_read_b64_tr_b16 v[126:127], v90 offset:1280
    v_mul_f32 v163, s60, v155
    v_mul_f32 v164, s60, v156
    v_mfma_f32_16x16x32_bf16 v[192:195], v[168:171], v[132:135], v[192:195]
    ds_read_b64_tr_b16 v[128:129], v136 offset:5120
    ds_read_b64_tr_b16 v[130:131], v136 offset:6400
    v_mul_f32 v165, s60, v157
    v_mfma_f32_16x16x32_bf16 v[40:43], a[128:131], v[104:107], v[40:43]
    ds_read_b64_tr_b16 v[132:133], v136 offset:5152
    v_mul_f32 v166, s60, v158
    v_mul_f32 v167, s60, v159
    v_mul_f32 v178, s60, v176
    v_mfma_f32_16x16x32_bf16 v[44:47], a[132:135], v[104:107], v[44:47]
    ds_read_b64_tr_b16 v[134:135], v136 offset:6432
    v_mul_f32 v179, s60, v177
    v_mfma_f32_16x16x32_bf16 v[48:51], a[128:131], v[108:111], v[48:51]
    ds_read_b64_tr_b16 v[104:105], v136 offset:5184
    s_add_u32 s80, s94, 983040
    s_add_u32 m0, s81, 53248
    s_nop 0
    buffer_load_dwordx4 v220, s[12:15], s80 offen lds
    v_mfma_f32_16x16x32_bf16 v[52:55], a[132:135], v[108:111], v[52:55]
    ds_read_b64_tr_b16 v[106:107], v136 offset:6464
    v_mfma_f32_16x16x32_bf16 v[56:59], a[128:131], v[112:115], v[56:59]
    ds_read_b64_tr_b16 v[108:109], v136 offset:5216
    v_mfma_f32_16x16x32_bf16 v[60:63], a[132:135], v[112:115], v[60:63]
    ds_read_b64_tr_b16 v[110:111], v136 offset:6496
    v_mfma_f32_16x16x32_bf16 v[64:67], a[128:131], v[116:119], v[64:67]
    ds_read_b64_tr_b16 v[112:113], v136 offset:5248
    v_mfma_f32_16x16x32_bf16 v[68:71], a[132:135], v[116:119], v[68:71]
    ds_read_b64_tr_b16 v[114:115], v136 offset:6528
    v_mfma_f32_16x16x32_bf16 v[72:75], a[128:131], v[120:123], v[72:75]
    ds_read_b64_tr_b16 v[116:117], v90 offset:5120
    v_mfma_f32_16x16x32_bf16 v[76:79], a[132:135], v[120:123], v[76:79]
    v_mfma_f32_16x16x32_bf16 v[196:199], v[168:171], v[120:123], v[196:199]
    ds_read_b64_tr_b16 v[118:119], v90 offset:6400
    s_waitcnt lgkmcnt(12)
    v_mfma_f32_16x16x32_bf16 v[192:195], v[168:171], v[124:127], v[192:195]
    ds_read_b64_tr_b16 v[120:121], v136 offset:10240
    ds_read_b64_tr_b16 v[122:123], v136 offset:11520
    s_add_u32 s80, s94, 983040
    s_waitcnt lgkmcnt(12)
    v_mfma_f32_16x16x32_bf16 v[40:43], a[136:139], v[128:131], v[40:43]
    ds_read_b64_tr_b16 v[124:125], v136 offset:10272
    s_add_u32 m0, s81, 57344
    s_nop 0
    buffer_load_dwordx4 v221, s[12:15], s80 offen lds
    v_mfma_f32_16x16x32_bf16 v[44:47], a[140:143], v[128:131], v[44:47]
    ds_read_b64_tr_b16 v[126:127], v136 offset:11552
    s_waitcnt lgkmcnt(12)
    v_mfma_f32_16x16x32_bf16 v[48:51], a[136:139], v[132:135], v[48:51]
    ds_read_b64_tr_b16 v[128:129], v136 offset:10304
    v_mfma_f32_16x16x32_bf16 v[52:55], a[140:143], v[132:135], v[52:55]
    ds_read_b64_tr_b16 v[130:131], v136 offset:11584
    s_waitcnt lgkmcnt(12)
    v_mfma_f32_16x16x32_bf16 v[56:59], a[136:139], v[104:107], v[56:59]
    ds_read_b64_tr_b16 v[132:133], v136 offset:10336
    v_mfma_f32_16x16x32_bf16 v[60:63], a[140:143], v[104:107], v[60:63]
    ds_read_b64_tr_b16 v[134:135], v136 offset:11616
    s_waitcnt lgkmcnt(12)
    v_mfma_f32_16x16x32_bf16 v[64:67], a[136:139], v[108:111], v[64:67]
    ds_read_b64_tr_b16 v[104:105], v136 offset:10368
    s_add_u32 s80, s94, 1966080
    s_add_u32 m0, s81, 61440
    s_nop 0
    buffer_load_dwordx4 v217, s[12:15], s80 offen lds
    v_mfma_f32_16x16x32_bf16 v[68:71], a[140:143], v[108:111], v[68:71]
    ds_read_b64_tr_b16 v[106:107], v136 offset:11648
    s_waitcnt lgkmcnt(12)
    v_mfma_f32_16x16x32_bf16 v[72:75], a[136:139], v[112:115], v[72:75]
    ds_read_b64_tr_b16 v[108:109], v90 offset:10240
    v_mfma_f32_16x16x32_bf16 v[76:79], a[140:143], v[112:115], v[76:79]
    v_mfma_f32_16x16x32_bf16 v[196:199], v[168:171], v[112:115], v[196:199]
    ds_read_b64_tr_b16 v[110:111], v90 offset:11520
    s_waitcnt lgkmcnt(12)
    v_mfma_f32_16x16x32_bf16 v[192:195], v[168:171], v[116:119], v[192:195]
    ds_read_b64_tr_b16 v[112:113], v136 offset:15360
    ds_read_b64_tr_b16 v[114:115], v136 offset:16640
    s_waitcnt lgkmcnt(12)
    v_mfma_f32_16x16x32_bf16 v[40:43], a[144:147], v[120:123], v[40:43]
    ds_read_b64_tr_b16 v[116:117], v136 offset:15392
    v_mfma_f32_16x16x32_bf16 v[44:47], a[148:151], v[120:123], v[44:47]
    ds_read_b64_tr_b16 v[118:119], v136 offset:16672
    s_waitcnt lgkmcnt(12)
    v_mfma_f32_16x16x32_bf16 v[48:51], a[144:147], v[124:127], v[48:51]
    ds_read_b64_tr_b16 v[120:121], v136 offset:15424
    v_mfma_f32_16x16x32_bf16 v[52:55], a[148:151], v[124:127], v[52:55]
    ds_read_b64_tr_b16 v[122:123], v136 offset:16704
    s_waitcnt lgkmcnt(12)
    v_mfma_f32_16x16x32_bf16 v[56:59], a[144:147], v[128:131], v[56:59]
    ds_read_b64_tr_b16 v[124:125], v136 offset:15456
    s_add_u32 s80, s94, 1966080
    s_add_u32 m0, s81, 65536
    s_nop 0
    buffer_load_dwordx4 v218, s[12:15], s80 offen lds
    v_mfma_f32_16x16x32_bf16 v[60:63], a[148:151], v[128:131], v[60:63]
    ds_read_b64_tr_b16 v[126:127], v136 offset:16736
    s_waitcnt lgkmcnt(12)
    v_mfma_f32_16x16x32_bf16 v[64:67], a[144:147], v[132:135], v[64:67]
    ds_read_b64_tr_b16 v[128:129], v136 offset:15488
    v_mfma_f32_16x16x32_bf16 v[68:71], a[148:151], v[132:135], v[68:71]
    ds_read_b64_tr_b16 v[130:131], v136 offset:16768
    s_waitcnt lgkmcnt(12)
    v_mfma_f32_16x16x32_bf16 v[72:75], a[144:147], v[104:107], v[72:75]
    ds_read_b64_tr_b16 v[132:133], v90 offset:15360
    v_mfma_f32_16x16x32_bf16 v[76:79], a[148:151], v[104:107], v[76:79]
    v_mfma_f32_16x16x32_bf16 v[196:199], v[168:171], v[104:107], v[196:199]
    ds_read_b64_tr_b16 v[134:135], v90 offset:16640
    s_waitcnt lgkmcnt(12)
    v_mfma_f32_16x16x32_bf16 v[192:195], v[168:171], v[108:111], v[192:195]
    s_waitcnt lgkmcnt(10)
    v_mfma_f32_16x16x32_bf16 v[40:43], a[152:155], v[112:115], v[40:43]
    s_add_u32 s80, s94, 1966080
    s_add_u32 m0, s81, 69632
    s_nop 0
    buffer_load_dwordx4 v219, s[12:15], s80 offen lds
    v_mfma_f32_16x16x32_bf16 v[44:47], a[156:159], v[112:115], v[44:47]
    s_waitcnt lgkmcnt(8)
    v_mfma_f32_16x16x32_bf16 v[48:51], a[152:155], v[116:119], v[48:51]
    v_mfma_f32_16x16x32_bf16 v[52:55], a[156:159], v[116:119], v[52:55]
    s_waitcnt lgkmcnt(6)
    v_mfma_f32_16x16x32_bf16 v[56:59], a[152:155], v[120:123], v[56:59]
    v_mfma_f32_16x16x32_bf16 v[60:63], a[156:159], v[120:123], v[60:63]
    s_waitcnt lgkmcnt(4)
    v_mfma_f32_16x16x32_bf16 v[64:67], a[152:155], v[124:127], v[64:67]
    v_mfma_f32_16x16x32_bf16 v[68:71], a[156:159], v[124:127], v[68:71]
    s_waitcnt lgkmcnt(2)
    v_mfma_f32_16x16x32_bf16 v[72:75], a[152:155], v[128:131], v[72:75]
    v_mfma_f32_16x16x32_bf16 v[76:79], a[156:159], v[128:131], v[76:79]
    v_mfma_f32_16x16x32_bf16 v[196:199], v[168:171], v[128:131], v[196:199]
    s_waitcnt lgkmcnt(0)
    v_mfma_f32_16x16x32_bf16 v[192:195], v[168:171], v[132:135], v[192:195]
    s_lshl_b32 s60, s44, 6
    v_add_u32 v24, s60, v32
    s_nop 5
    ds_write_b32 v24, v192
    ds_write_b32 v32, v196 offset:256
    s_lshl_b32 s86, s45, 1
    s_add_u32 s86, s86, s53
    s_lshl_b32 s86, s86, 2
    s_add_u32 s86, s86, s44
    s_sub_u32 s87, s51, s81
    s_add_u32 s61, s86, 0
    s_lshl_b32 s75, s61, 10
    s_add_u32 s75, s75, s87
    s_cmp_lt_u32 s61, 100
    s_cselect_b32 s75, s75, 0x40000000
    s_cselect_b32 s61, s61, 0
    s_mul_i32 s62, s61, 103
    s_lshr_b32 s62, s62, 9
    s_mul_i32 s63, s62, 4960
    s_lshl_b32 s61, s61, 5
    s_add_u32 s63, s63, s61
    s_cmp_lt_u32 s62, 16
    s_cselect_b32 s61, 155648, 0
    s_sub_u32 s61, s61, 81920
    s_add_u32 s63, s63, s61
    v_add_u32 v24, s63, v136
    ds_read_b64_tr_b16 v[104:105], v24 offset:0
    ds_read_b64_tr_b16 v[106:107], v24 offset:1280
    s_add_u32 s61, s86, 64
    s_lshl_b32 s78, s61, 10
    s_add_u32 s78, s78, s87
    s_cmp_lt_u32 s61, 100
    s_cselect_b32 s78, s78, 0x40000000
    s_cselect_b32 s61, s61, 0
    s_mul_i32 s62, s61, 103
    s_lshr_b32 s62, s62, 9
    s_mul_i32 s63, s62, 4960
    s_lshl_b32 s61, s61, 5
    s_add_u32 s63, s63, s61
    s_cmp_lt_u32 s62, 16
    s_cselect_b32 s61, 155648, 0
    s_sub_u32 s61, s61, 81920
    s_add_u32 s63, s63, s61
    v_add_u32 v24, s63, v136
    ds_read_b64_tr_b16 v[108:109], v24 offset:0
    ds_read_b64_tr_b16 v[110:111], v24 offset:1280
    s_waitcnt lgkmcnt(0)
    s_barrier
    ds_read_b32 v93, v32 offset:0
    ds_read_b32 v94, v32 offset:64
    ds_read_b32 v95, v32 offset:128
    ds_read_b32 v96, v32 offset:192
    ds_read_b32 v97, v32 offset:256
    s_waitcnt lgkmcnt(0)
    v_pk_fma_f32 v[40:41], v[144:145], v[92:93], v[40:41] op_sel:[0,1,0] op_sel_hi:[1,1,1]
    v_pk_fma_f32 v[42:43], v[146:147], v[92:93], v[42:43] op_sel:[0,1,0] op_sel_hi:[1,1,1]
    v_pk_fma_f32 v[44:45], v[148:149], v[92:93], v[44:45] op_sel:[0,1,0] op_sel_hi:[1,1,1]
    v_pk_fma_f32 v[46:47], v[150:151], v[92:93], v[46:47] op_sel:[0,1,0] op_sel_hi:[1,1,1]
    v_pk_fma_f32 v[48:49], v[144:145], v[94:95], v[48:49] op_sel:[0,0,0] op_sel_hi:[1,0,1]
    v_pk_fma_f32 v[50:51], v[146:147], v[94:95], v[50:51] op_sel:[0,0,0] op_sel_hi:[1,0,1]
    v_pk_fma_f32 v[52:53], v[148:149], v[94:95], v[52:53] op_sel:[0,0,0] op_sel_hi:[1,0,1]
    v_pk_fma_f32 v[54:55], v[150:151], v[94:95], v[54:55] op_sel:[0,0,0] op_sel_hi:[1,0,1]
    v_pk_fma_f32 v[56:57], v[144:145], v[94:95], v[56:57] op_sel:[0,1,0] op_sel_hi:[1,1,1]
    v_pk_fma_f32 v[58:59], v[146:147], v[94:95], v[58:59] op_sel:[0,1,0] op_sel_hi:[1,1,1]
    v_pk_fma_f32 v[60:61], v[148:149], v[94:95], v[60:61] op_sel:[0,1,0] op_sel_hi:[1,1,1]
    v_pk_fma_f32 v[62:63], v[150:151], v[94:95], v[62:63] op_sel:[0,1,0] op_sel_hi:[1,1,1]
    v_pk_fma_f32 v[64:65], v[144:145], v[96:97], v[64:65] op_sel:[0,0,0] op_sel_hi:[1,0,1]
    v_pk_fma_f32 v[66:67], v[146:147], v[96:97], v[66:67] op_sel:[0,0,0] op_sel_hi:[1,0,1]
    s_lshl_b32 s90, s45, 5
    s_add_u32 s90, s90, s46
    s_lshl_b32 s90, s90, 2
    s_add_u32 s90, s90, s44
    s_lshl_b32 s90, s90, 13
    s_and_b32 s80, s46, 4
    s_xor_b32 s80, s80, 0
    s_lshl_b32 s80, s80, 9
    s_add_u32 s90, s90, s80
    s_cmp_eq_u32 s48, 0
    s_cselect_b32 s90, s90, 0x40000000
    buffer_load_dwordx4 v[224:227], v1, s[24:27], s90 offen offset:0
    v_pk_fma_f32 v[68:69], v[148:149], v[96:97], v[68:69] op_sel:[0,0,0] op_sel_hi:[1,0,1]
    v_pk_fma_f32 v[70:71], v[150:151], v[96:97], v[70:71] op_sel:[0,0,0] op_sel_hi:[1,0,1]
    v_pk_fma_f32 v[72:73], v[144:145], v[96:97], v[72:73] op_sel:[0,1,0] op_sel_hi:[1,1,1]
    v_pk_fma_f32 v[74:75], v[146:147], v[96:97], v[74:75] op_sel:[0,1,0] op_sel_hi:[1,1,1]
    v_pk_fma_f32 v[76:77], v[148:149], v[96:97], v[76:77] op_sel:[0,1,0] op_sel_hi:[1,1,1]
    v_pk_fma_f32 v[78:79], v[150:151], v[96:97], v[78:79] op_sel:[0,1,0] op_sel_hi:[1,1,1]
    v_pk_mul_f32 v[64:65], v[64:65], v[152:153] op_sel:[0,0] op_sel_hi:[1,1]
    v_pk_mul_f32 v[66:67], v[66:67], v[154:155] op_sel:[0,0] op_sel_hi:[1,1]
    v_pk_mul_f32 v[68:69], v[68:69], v[156:157] op_sel:[0,0] op_sel_hi:[1,1]
    v_pk_mul_f32 v[70:71], v[70:71], v[158:159] op_sel:[0,0] op_sel_hi:[1,1]
    v_cvt_pk_bf16_f32 v208, v64, v65
    v_cvt_pk_bf16_f32 v209, v66, v67
    v_cvt_pk_bf16_f32 v210, v68, v69
    v_cvt_pk_bf16_f32 v211, v70, v71
    ds_write_b128 v26, v[208:211] offset:12288
    v_pk_mul_f32 v[72:73], v[72:73], v[152:153] op_sel:[0,0] op_sel_hi:[1,1]
    v_pk_mul_f32 v[74:75], v[74:75], v[154:155] op_sel:[0,0] op_sel_hi:[1,1]
    v_pk_mul_f32 v[76:77], v[76:77], v[156:157] op_sel:[0,0] op_sel_hi:[1,1]
    v_pk_mul_f32 v[78:79], v[78:79], v[158:159] op_sel:[0,0] op_sel_hi:[1,1]
    v_cvt_pk_bf16_f32 v212, v72, v73
    v_cvt_pk_bf16_f32 v213, v74, v75
    v_cvt_pk_bf16_f32 v214, v76, v77
    v_cvt_pk_bf16_f32 v215, v78, v79
    ds_write_b128 v26, v[212:215] offset:16384
    v_pk_mul_f32 v[216:217], v[40:41], v[160:161] op_sel:[0,0] op_sel_hi:[1,1]
    v_pk_fma_f32 v[218:219], v[40:41], v[152:153], v[18:19] op_sel:[0,0,0] op_sel_hi:[1,1,0]
    v_exp_f32_e64 v216, v216 clamp
    v_exp_f32_e64 v217, v217 clamp
    buffer_load_dwordx4 v[224:227], v1, s[24:27], s90 offen offset:1024
    v_max_f32 v216, v216, v218
    v_max_f32 v217, v217, v219
    v_pk_add_f32 v[216:217], v[216:217], v[18:19] op_sel:[0,1] op_sel_hi:[1,1]
    v_cvt_pk_bf16_f32 v196, v216, v217
    v_pk_mul_f32 v[220:221], v[42:43], v[162:163] op_sel:[0,0] op_sel_hi:[1,1]
    v_pk_fma_f32 v[222:223], v[42:43], v[154:155], v[18:19] op_sel:[0,0,0] op_sel_hi:[1,1,0]
    v_exp_f32_e64 v220, v220 clamp
    v_exp_f32_e64 v221, v221 clamp
    v_max_f32 v220, v220, v222
    v_max_f32 v221, v221, v223
    v_pk_add_f32 v[220:221], v[220:221], v[18:19] op_sel:[0,1] op_sel_hi:[1,1]
    v_cvt_pk_bf16_f32 v197, v220, v221
    v_pk_mul_f32 v[216:217], v[44:45], v[164:165] op_sel:[0,0] op_sel_hi:[1,1]
    v_pk_fma_f32 v[218:219], v[44:45], v[156:157], v[18:19] op_sel:[0,0,0] op_sel_hi:[1,1,0]
    v_exp_f32_e64 v216, v216 clamp
    v_exp_f32_e64 v217, v217 clamp
    v_max_f32 v216, v216, v218
    v_max_f32 v217, v217, v219
    v_pk_add_f32 v[216:217], v[216:217], v[18:19] op_sel:[0,1] op_sel_hi:[1,1]
    v_cvt_pk_bf16_f32 v198, v216, v217
    v_pk_mul_f32 v[220:221], v[46:47], v[166:167] op_sel:[0,0] op_sel_hi:[1,1]
    v_pk_fma_f32 v[222:223], v[46:47], v[158:159], v[18:19] op_sel:[0,0,0] op_sel_hi:[1,1,0]
    v_exp_f32_e64 v220, v220 clamp
    s_add_u32 s90, s90, 4096
    buffer_load_dwordx4 v[224:227], v1, s[24:27], s90 offen offset:0
    v_exp_f32_e64 v221, v221 clamp
    v_max_f32 v220, v220, v222
    v_max_f32 v221, v221, v223
    v_pk_add_f32 v[220:221], v[220:221], v[18:19] op_sel:[0,1] op_sel_hi:[1,1]
    v_cvt_pk_bf16_f32 v199, v220, v221
    ds_write_b128 v26, v[196:199] offset:0
    v_pk_mul_f32 v[216:217], v[48:49], v[160:161] op_sel:[0,0] op_sel_hi:[1,1]
    v_pk_fma_f32 v[218:219], v[48:49], v[152:153], v[18:19] op_sel:[0,0,0] op_sel_hi:[1,1,0]
    v_exp_f32_e64 v216, v216 clamp
    v_exp_f32_e64 v217, v217 clamp
    v_max_f32 v216, v216, v218
    v_max_f32 v217, v217, v219
    v_pk_add_f32 v[216:217], v[216:217], v[18:19] op_sel:[0,1] op_sel_hi:[1,1]
    v_cvt_pk_bf16_f32 v200, v216, v217
    v_pk_mul_f32 v[220:221], v[50:51], v[162:163] op_sel:[0,0] op_sel_hi:[1,1]
    v_pk_fma_f32 v[222:223], v[50:51], v[154:155], v[18:19] op_sel:[0,0,0] op_sel_hi:[1,1,0]
    v_exp_f32_e64 v220, v220 clamp
    v_exp_f32_e64 v221, v221 clamp
    v_max_f32 v220, v220, v222
    v_max_f32 v221, v221, v223
    v_pk_add_f32 v[220:221], v[220:221], v[18:19] op_sel:[0,1] op_sel_hi:[1,1]
    v_cvt_pk_bf16_f32 v201, v220, v221
    v_pk_mul_f32 v[216:217], v[52:53], v[164:165] op_sel:[0,0] op_sel_hi:[1,1]
    v_pk_fma_f32 v[218:219], v[52:53], v[156:157], v[18:19] op_sel:[0,0,0] op_sel_hi:[1,1,0]
    buffer_load_dwordx4 v[224:227], v1, s[24:27], s90 offen offset:1024
    v_exp_f32_e64 v216, v216 clamp
    v_exp_f32_e64 v217, v217 clamp
    v_max_f32 v216, v216, v218
    v_max_f32 v217, v217, v219
    v_pk_add_f32 v[216:217], v[216:217], v[18:19] op_sel:[0,1] op_sel_hi:[1,1]
    v_cvt_pk_bf16_f32 v202, v216, v217
    v_pk_mul_f32 v[220:221], v[54:55], v[166:167] op_sel:[0,0] op_sel_hi:[1,1]
    v_pk_fma_f32 v[222:223], v[54:55], v[158:159], v[18:19] op_sel:[0,0,0] op_sel_hi:[1,1,0]
    v_exp_f32_e64 v220, v220 clamp
    v_exp_f32_e64 v221, v221 clamp
    v_max_f32 v220, v220, v222
    v_max_f32 v221, v221, v223
    v_pk_add_f32 v[220:221], v[220:221], v[18:19] op_sel:[0,1] op_sel_hi:[1,1]
    v_cvt_pk_bf16_f32 v203, v220, v221
    ds_write_b128 v26, v[200:203] offset:4096
    v_pk_mul_f32 v[216:217], v[56:57], v[160:161] op_sel:[0,0] op_sel_hi:[1,1]
    v_pk_fma_f32 v[218:219], v[56:57], v[152:153], v[18:19] op_sel:[0,0,0] op_sel_hi:[1,1,0]
    v_exp_f32_e64 v216, v216 clamp
    v_exp_f32_e64 v217, v217 clamp
    v_max_f32 v216, v216, v218
    v_max_f32 v217, v217, v219
    v_pk_add_f32 v[216:217], v[216:217], v[18:19] op_sel:[0,1] op_sel_hi:[1,1]
    v_pk_mul_f32 v[218:219], v[56:57], v[152:153] op_sel:[0,0] op_sel_hi:[1,1]
    v_cndmask_b32 v216, v218, v216, s[66:67]
    v_cndmask_b32 v217, v219, v217, s[66:67]
    v_cvt_pk_bf16_f32 v204, v216, v217
    v_pk_mul_f32 v[220:221], v[58:59], v[162:163] op_sel:[0,0] op_sel_hi:[1,1]
    v_pk_fma_f32 v[222:223], v[58:59], v[154:155], v[18:19] op_sel:[0,0,0] op_sel_hi:[1,1,0]
    v_exp_f32_e64 v220, v220 clamp
    v_exp_f32_e64 v221, v221 clamp
    v_max_f32 v220, v220, v222
    v_max_f32 v221, v221, v223
    v_pk_add_f32 v[220:221], v[220:221], v[18:19] op_sel:[0,1] op_sel_hi:[1,1]
    v_pk_mul_f32 v[222:223], v[58:59], v[154:155] op_sel:[0,0] op_sel_hi:[1,1]
    v_cndmask_b32 v220, v222, v220, s[66:67]
    v_cndmask_b32 v221, v223, v221, s[66:67]
    v_cvt_pk_bf16_f32 v205, v220, v221
    v_pk_mul_f32 v[216:217], v[60:61], v[164:165] op_sel:[0,0] op_sel_hi:[1,1]
    v_pk_fma_f32 v[218:219], v[60:61], v[156:157], v[18:19] op_sel:[0,0,0] op_sel_hi:[1,1,0]
    v_exp_f32_e64 v216, v216 clamp
    v_exp_f32_e64 v217, v217 clamp
    v_max_f32 v216, v216, v218
    v_max_f32 v217, v217, v219
    v_pk_add_f32 v[216:217], v[216:217], v[18:19] op_sel:[0,1] op_sel_hi:[1,1]
    v_pk_mul_f32 v[218:219], v[60:61], v[156:157] op_sel:[0,0] op_sel_hi:[1,1]
    v_cndmask_b32 v216, v218, v216, s[66:67]
    v_cndmask_b32 v217, v219, v217, s[66:67]
    v_cvt_pk_bf16_f32 v206, v216, v217
    v_pk_mul_f32 v[220:221], v[62:63], v[166:167] op_sel:[0,0] op_sel_hi:[1,1]
    v_pk_fma_f32 v[222:223], v[62:63], v[158:159], v[18:19] op_sel:[0,0,0] op_sel_hi:[1,1,0]
    v_exp_f32_e64 v220, v220 clamp
    v_exp_f32_e64 v221, v221 clamp
    v_max_f32 v220, v220, v222
    v_max_f32 v221, v221, v223
    v_pk_add_f32 v[220:221], v[220:221], v[18:19] op_sel:[0,1] op_sel_hi:[1,1]
    v_pk_mul_f32 v[222:223], v[62:63], v[158:159] op_sel:[0,0] op_sel_hi:[1,1]
    v_cndmask_b32 v220, v222, v220, s[66:67]
    v_cndmask_b32 v221, v223, v221, s[66:67]
    v_cvt_pk_bf16_f32 v207, v220, v221
    ds_write_b128 v26, v[204:207] offset:8192
    v_mov_b32 v192, 0x3f803f80
    v_mov_b32 v193, 0x3f803f80
    v_mov_b32 v194, 0x3f803f80
    v_mov_b32 v195, 0x3f803f80
    s_waitcnt vmcnt(10)
    v_xor_b32 v24, s83, v141
    v_xor_b32 v25, s83, v142
    v_max_u32 v25, v24, v25
    v_cmp_gt_u32 vcc, 16, v25
    s_cmp_eq_u64 vcc, exec
    s_cbranch_scc1 Lfaok_10
    s_mov_b64 exec, -1
    s_mov_b32 s82, 0
Lpoll_11:
    buffer_load_dword v24, v89, s[4:7], s93 offen sc1
    s_add_u32 s82, s82, 1
    s_waitcnt vmcnt(0)
    v_xor_b32 v24, s83, v24
    v_cmp_gt_u32 vcc, 16, v24
    s_cmp_eq_u64 vcc, exec
    s_cbranch_scc1 Lpdone_12
    s_cmp_lt_u32 s82, 200000
    s_cbranch_scc1 Lpoll_11
    s_branch LEND
Lpdone_12:
    s_mov_b64 exec, -1
    s_mov_b32 exec_lo, -1
    s_mov_b32 exec_hi, 0
    s_mov_b32 s82, 0
Lpoll_13:
    buffer_load_dword v24, v88, s[4:7], s93 offen sc1
    s_add_u32 s82, s82, 1
    s_waitcnt vmcnt(0)
    v_xor_b32 v24, s83, v24
    v_cmp_gt_u32 vcc, 16, v24
    s_cmp_eq_u64 vcc, exec
    s_cbranch_scc1 Lpdone_14
    s_cmp_lt_u32 s82, 200000
    s_cbranch_scc1 Lpoll_13
    s_branch LEND
Lpdone_14:
    s_mov_b64 exec, -1
Lfaok_10:
    v_cmp_ne_u32 vcc, s59, v24
    s_mov_b32 s47, vcc_lo
    s_waitcnt lgkmcnt(0)
    s_barrier
    ds_read_b128 v[40:43], v27 offset:0
    ds_read_b128 v[44:47], v28 offset:0
    ds_read_b128 v[48:51], v29 offset:0
    ds_read_b128 v[52:55], v27 offset:1024
    ds_read_b128 v[56:59], v28 offset:1024
    ds_read_b128 v[60:63], v29 offset:1024
    ds_read_b128 v[64:67], v27 offset:2048
    ds_read_b128 v[68:71], v28 offset:2048
    ds_read_b128 v[72:75], v29 offset:2048
    ds_read_b128 v[76:79], v27 offset:3072
    ds_read_b128 v[80:83], v28 offset:3072
    ds_read_b128 v[84:87], v29 offset:3072
    s_waitcnt lgkmcnt(9)
    v_mfma_f32_16x16x32_bf16 v[200:203], v[40:43], v[44:47], 0
    v_mfma_f32_16x16x32_bf16 v[204:207], v[40:43], v[48:51], 0
    v_mfma_f32_16x16x32_bf16 v[208:211], v[40:43], v[192:195], 0
    s_waitcnt lgkmcnt(6)
    v_mfma_f32_16x16x32_bf16 v[200:203], v[52:55], v[56:59], v[200:203]
    v_mfma_f32_16x16x32_bf16 v[204:207], v[52:55], v[60:63], v[204:207]
    v_mfma_f32_16x16x32_bf16 v[208:211], v[52:55], v[192:195], v[208:211]
    s_waitcnt lgkmcnt(3)
    v_mfma_f32_16x16x32_bf16 v[200:203], v[64:67], v[68:71], v[200:203]
    v_mfma_f32_16x16x32_bf16 v[204:207], v[64:67], v[72:75], v[204:207]
    v_mfma_f32_16x16x32_bf16 v[208:211], v[64:67], v[192:195], v[208:211]
    s_waitcnt lgkmcnt(0)
    v_mfma_f32_16x16x32_bf16 v[200:203], v[76:79], v[80:83], v[200:203]
    v_mfma_f32_16x16x32_bf16 v[204:207], v[76:79], v[84:87], v[204:207]
    v_mfma_f32_16x16x32_bf16 v[208:211], v[76:79], v[192:195], v[208:211]
    s_nop 5
    v_cvt_pk_bf16_f32 v216, v200, v201
    v_cvt_pk_bf16_f32 v217, v202, v203
    buffer_store_dwordx2 v[216:217], v33, s[4:7], s74 offen sc1
    v_cvt_pk_bf16_f32 v218, v204, v205
    v_cvt_pk_bf16_f32 v219, v206, v207
    buffer_store_dwordx2 v[218:219], v34, s[4:7], s74 offen sc1
    v_cvt_pk_bf16_f32 v220, v208, v209
    v_cvt_pk_bf16_f32 v221, v210, v211
    buffer_store_dwordx2 v[220:221], v35, s[4:7], s74 offen sc1
    buffer_store_dwordx4 v[104:107], v1, s[4:7], s75 offen sc1
    buffer_store_dwordx4 v[108:111], v1, s[4:7], s78 offen sc1
    s_cmp_lt_u32 s86, 60
    s_cselect_b32 s87, s87, 0x40000000
    s_cselect_b32 s61, s86, 0
    s_mul_i32 s62, s61, 43
    s_lshr_b32 s62, s62, 7
    s_mul_i32 s63, s62, 3
    s_sub_u32 s61, s61, s63
    s_mul_i32 s63, s62, 2560
    s_lshl_b32 s60, s61, 5
    s_add_u32 s63, s63, s60
    s_add_u32 s63, s63, 20480
    v_add_u32 v24, s63, v139
    s_lshl_b32 s63, s62, 11
    s_lshl_b32 s60, s61, 10
    s_add_u32 s63, s63, s60
    s_add_u32 s63, s63, 102400
    s_lshl_b32 s62, s62, 9
    s_add_u32 s62, s62, 143360
    v_lshlrev_b32 v25, 7, v22
    v_lshl_add_u32 v25, v23, 4, v25
    v_cndmask_b32 v25, v36, v25, s[66:67]
    s_cmp_eq_u32 s61, 2
    s_cselect_b32 s63, s62, s63
    s_cselect_b64 vcc, -1, 0
    s_add_u32 s87, s87, s63
    v_cndmask_b32 v25, v1, v25, vcc
    s_waitcnt vmcnt(9)
    s_barrier
    ds_read_b64_tr_b16 v[72:73], v24 offset:0
    ds_read_b64_tr_b16 v[74:75], v24 offset:80
    s_waitcnt lgkmcnt(0)
    buffer_store_dwordx4 v[72:75], v25, s[4:7], s87 offen sc1
    ds_read_b64_tr_b16 v[104:105], v139 offset:20480
    ds_read_b64_tr_b16 v[106:107], v139 offset:20560
    ds_read_b64_tr_b16 v[108:109], v139 offset:20512
    ds_read_b64_tr_b16 v[110:111], v139 offset:20592
    ds_read_b64_tr_b16 v[112:113], v139 offset:20544
    ds_read_b64_tr_b16 v[114:115], v139 offset:20624
    ds_read_b64_tr_b16 v[116:117], v139 offset:23040
    ds_read_b64_tr_b16 v[118:119], v139 offset:23120
    ds_read_b64_tr_b16 v[120:121], v139 offset:23072
    ds_read_b64_tr_b16 v[122:123], v139 offset:23152
    ds_read_b64_tr_b16 v[124:125], v139 offset:23104
    ds_read_b64_tr_b16 v[126:127], v139 offset:23184
    ds_read_b64_tr_b16 v[128:129], v139 offset:25600
    ds_read_b64_tr_b16 v[130:131], v139 offset:25680
    s_waitcnt lgkmcnt(12)
    v_mfma_f32_16x16x32_bf16 v[80:83], v[104:107], a[0:3], 0
    ds_read_b64_tr_b16 v[132:133], v139 offset:25632
    s_add_u32 s80, s95, 0
    s_add_u32 m0, s81, 73728
    s_nop 0
    buffer_load_dwordx4 v1, s[4:7], s80 offen sc1 lds
    v_mfma_f32_16x16x32_bf16 v[84:87], v[104:107], a[4:7], 0
    v_mfma_f32_16x16x32_bf16 v[180:183], v[104:107], v[168:171], 0
    ds_read_b64_tr_b16 v[134:135], v139 offset:25712
    s_waitcnt lgkmcnt(12)
    v_mfma_f32_16x16x32_bf16 v[88:91], v[108:111], a[0:3], 0
    ds_read_b64_tr_b16 v[104:105], v139 offset:25664
    v_mfma_f32_16x16x32_bf16 v[92:95], v[108:111], a[4:7], 0
    v_mfma_f32_16x16x32_bf16 v[184:187], v[108:111], v[168:171], 0
    ds_read_b64_tr_b16 v[106:107], v139 offset:25744
    s_waitcnt lgkmcnt(12)
    v_mfma_f32_16x16x32_bf16 v[96:99], v[112:115], a[0:3], 0
    ds_read_b64_tr_b16 v[108:109], v139 offset:28160
    s_add_u32 s80, s95, 4096
    s_add_u32 m0, s81, 77824
    s_nop 0
    buffer_load_dwordx4 v1, s[4:7], s80 offen sc1 lds
    v_mfma_f32_16x16x32_bf16 v[100:103], v[112:115], a[4:7], 0
    v_lshrrev_b32 v26, 2, v23
    v_and_b32 v27, 3, v23
    v_mad_u32_u24 v74, v26, 5, v27
    v_mfma_f32_16x16x32_bf16 v[188:191], v[112:115], v[168:171], 0
    ds_read_b64_tr_b16 v[110:111], v139 offset:28240
    v_mad_u32_u24 v75, v26, 5, 4
    v_cmp_eq_u32 vcc, 0, v27
    s_waitcnt lgkmcnt(12)
    v_mfma_f32_16x16x32_bf16 v[80:83], v[116:119], a[8:11], v[80:83]
    ds_read_b64_tr_b16 v[112:113], v139 offset:28192
    v_mov_b32 v27, 161312
    v_cmp_eq_u32 s[68:69], 0, v22
    v_cndmask_b32 v75, 20, v75, vcc
    v_mfma_f32_16x16x32_bf16 v[84:87], v[116:119], a[12:15], v[84:87]
    v_cmp_gt_u32 s[72:73], 2, v22
    v_mul_u32_u24 v26, 80, v74
    v_add_u32 v26, 157952, v26
    v_lshl_add_u32 v28, v22, 4, v26
    v_mfma_f32_16x16x32_bf16 v[180:183], v[116:119], v[168:171], v[180:183]
    ds_read_b64_tr_b16 v[114:115], v139 offset:28272
    v_add_u32 v26, 64, v26
    v_cndmask_b32 v29, v27, v26, s[68:69]
    s_waitcnt lgkmcnt(12)
    v_mfma_f32_16x16x32_bf16 v[88:91], v[120:123], a[8:11], v[88:91]
    ds_read_b64_tr_b16 v[116:117], v139 offset:28224
    v_add_u32 v26, 1664, v28
    v_cndmask_b32 v30, v26, v27, s[68:69]
    v_add_u32 v26, 64, v26
    v_mfma_f32_16x16x32_bf16 v[92:95], v[120:123], a[12:15], v[92:95]
    v_cndmask_b32 v31, v27, v26, s[72:73]
    v_mul_u32_u24 v26, 80, v75
    v_add_u32 v26, 157952, v26
    v_lshl_add_u32 v32, v22, 4, v26
    v_mfma_f32_16x16x32_bf16 v[184:187], v[120:123], v[168:171], v[184:187]
    ds_read_b64_tr_b16 v[118:119], v139 offset:28304
    v_add_u32 v26, 64, v26
    v_cndmask_b32 v33, v27, v26, s[68:69]
    s_waitcnt lgkmcnt(12)
    v_mfma_f32_16x16x32_bf16 v[96:99], v[124:127], a[8:11], v[96:99]
    ds_read_b64_tr_b16 v[120:121], v139 offset:30720
    s_add_u32 s80, s95, 8192
    s_add_u32 m0, s81, 81920
    s_nop 0
    buffer_load_dwordx4 v1, s[4:7], s80 offen sc1 lds
    v_mfma_f32_16x16x32_bf16 v[100:103], v[124:127], a[12:15], v[100:103]
    v_add_u32 v26, 1664, v32
    v_cndmask_b32 v34, v26, v27, s[68:69]
    v_add_u32 v26, 64, v26
    v_mfma_f32_16x16x32_bf16 v[188:191], v[124:127], v[168:171], v[188:191]
    ds_read_b64_tr_b16 v[122:123], v139 offset:30800
    v_cndmask_b32 v35, v27, v26, s[72:73]
    s_mul_i32 s60, s54, 5
    s_waitcnt lgkmcnt(12)
    v_mfma_f32_16x16x32_bf16 v[80:83], v[128:131], a[16:19], v[80:83]
    ds_read_b64_tr_b16 v[124:125], v139 offset:30752
    v_add_u32 v26, s60, v22
    v_lshlrev_b32 v26, 8, v26
    v_lshl_add_u32 v26, v23, 4, v26
    v_mfma_f32_16x16x32_bf16 v[84:87], v[128:131], a[20:23], v[84:87]
    s_add_u32 s60, s60, 4
    s_lshl_b32 s60, s60, 8
    v_lshl_add_u32 v27, v23, 4, s60
    v_lshl_add_u32 v27, v22, 2, v27
    v_mfma_f32_16x16x32_bf16 v[180:183], v[128:131], v[168:171], v[180:183]
    ds_read_b64_tr_b16 v[126:127], v139 offset:30832
    s_mul_i32 s62, s57, 24576
    s_add_u32 s62, s62, 14901248
    s_waitcnt lgkmcnt(12)
    v_mfma_f32_16x16x32_bf16 v[88:91], v[132:135], a[16:19], v[88:91]
    ds_read_b64_tr_b16 v[128:129], v139 offset:30784
    s_add_u32 s80, s95, 12288
    s_add_u32 m0, s81, 86016
    s_nop 0
    buffer_load_dwordx4 v1, s[4:7], s80 offen sc1 lds
    v_mfma_f32_16x16x32_bf16 v[92:95], v[132:135], a[20:23], v[92:95]
    s_lshl_b32 s63, s45, 1
    s_add_u32 s63, s63, s53
    s_lshl_b32 s63, s63, 2
    v_mfma_f32_16x16x32_bf16 v[184:187], v[132:135], v[168:171], v[184:187]
    ds_read_b64_tr_b16 v[130:131], v139 offset:30864
    s_add_u32 s63, s63, s44
    s_lshl_b32 s63, s63, 4
    s_waitcnt lgkmcnt(12)
    v_mfma_f32_16x16x32_bf16 v[96:99], v[104:107], a[16:19], v[96:99]
    ds_read_b64_tr_b16 v[132:133], v139 offset:33280
    s_add_u32 s63, s63, s54
    s_lshl_b32 s63, s63, 2
    s_add_u32 s63, s63, 0
    v_mfma_f32_16x16x32_bf16 v[100:103], v[104:107], a[20:23], v[100:103]
    v_mfma_f32_16x16x32_bf16 v[188:191], v[104:107], v[168:171], v[188:191]
    ds_read_b64_tr_b16 v[134:135], v139 offset:33360
    s_waitcnt lgkmcnt(12)
    v_mfma_f32_16x16x32_bf16 v[80:83], v[108:111], a[24:27], v[80:83]
    ds_read_b64_tr_b16 v[104:105], v139 offset:33312
    v_mfma_f32_16x16x32_bf16 v[84:87], v[108:111], a[28:31], v[84:87]
    v_mfma_f32_16x16x32_bf16 v[180:183], v[108:111], v[168:171], v[180:183]
    ds_read_b64_tr_b16 v[106:107], v139 offset:33392
    s_waitcnt lgkmcnt(12)
    v_mfma_f32_16x16x32_bf16 v[88:91], v[112:115], a[24:27], v[88:91]
    ds_read_b64_tr_b16 v[108:109], v139 offset:33344
    s_add_u32 s80, s95, 16384
    s_add_u32 m0, s81, 90112
    s_nop 0
    buffer_load_dwordx4 v1, s[4:7], s80 offen sc1 lds
    v_mfma_f32_16x16x32_bf16 v[92:95], v[112:115], a[28:31], v[92:95]
    v_mfma_f32_16x16x32_bf16 v[184:187], v[112:115], v[168:171], v[184:187]
    ds_read_b64_tr_b16 v[110:111], v139 offset:33424
    s_waitcnt lgkmcnt(12)
    v_mfma_f32_16x16x32_bf16 v[96:99], v[116:119], a[24:27], v[96:99]
    ds_read_b64_tr_b16 v[112:113], v139 offset:35840
    v_mfma_f32_16x16x32_bf16 v[100:103], v[116:119], a[28:31], v[100:103]
    v_mfma_f32_16x16x32_bf16 v[188:191], v[116:119], v[168:171], v[188:191]
    ds_read_b64_tr_b16 v[114:115], v139 offset:35920
    s_waitcnt lgkmcnt(12)
    v_mfma_f32_16x16x32_bf16 v[80:83], v[120:123], a[32:35], v[80:83]
    ds_read_b64_tr_b16 v[116:117], v139 offset:35872
    s_add_u32 s80, s95, 20480
    s_add_u32 m0, s81, 94208
    s_nop 0
    buffer_load_dwordx4 v1, s[4:7], s80 offen sc1 lds
    v_mfma_f32_16x16x32_bf16 v[84:87], v[120:123], a[36:39], v[84:87]
    v_mfma_f32_16x16x32_bf16 v[180:183], v[120:123], v[168:171], v[180:183]
    ds_read_b64_tr_b16 v[118:119], v139 offset:35952
    s_waitcnt lgkmcnt(12)
    v_mfma_f32_16x16x32_bf16 v[88:91], v[124:127], a[32:35], v[88:91]
    ds_read_b64_tr_b16 v[120:121], v139 offset:35904
    v_mfma_f32_16x16x32_bf16 v[92:95], v[124:127], a[36:39], v[92:95]
    v_mfma_f32_16x16x32_bf16 v[184:187], v[124:127], v[168:171], v[184:187]
    ds_read_b64_tr_b16 v[122:123], v139 offset:35984
    s_waitcnt lgkmcnt(12)
    v_mfma_f32_16x16x32_bf16 v[96:99], v[128:131], a[32:35], v[96:99]
    ds_read_b64_tr_b16 v[124:125], v139 offset:38400
    v_mfma_f32_16x16x32_bf16 v[100:103], v[128:131], a[36:39], v[100:103]
    v_mfma_f32_16x16x32_bf16 v[188:191], v[128:131], v[168:171], v[188:191]
    ds_read_b64_tr_b16 v[126:127], v139 offset:38480
    s_waitcnt lgkmcnt(12)
    v_mfma_f32_16x16x32_bf16 v[80:83], v[132:135], a[40:43], v[80:83]
    ds_read_b64_tr_b16 v[128:129], v139 offset:38432
    s_add_u32 s80, s95, 24576
    s_add_u32 m0, s81, 98304
    s_nop 0
    buffer_load_dwordx4 v1, s[4:7], s80 offen sc1 lds
    v_mfma_f32_16x16x32_bf16 v[84:87], v[132:135], a[44:47], v[84:87]
    v_mfma_f32_16x16x32_bf16 v[180:183], v[132:135], v[168:171], v[180:183]
    ds_read_b64_tr_b16 v[130:131], v139 offset:38512
    s_waitcnt lgkmcnt(12)
    v_mfma_f32_16x16x32_bf16 v[88:91], v[104:107], a[40:43], v[88:91]
    ds_read_b64_tr_b16 v[132:133], v139 offset:38464
    v_mfma_f32_16x16x32_bf16 v[92:95], v[104:107], a[44:47], v[92:95]
    v_mfma_f32_16x16x32_bf16 v[184:187], v[104:107], v[168:171], v[184:187]
    ds_read_b64_tr_b16 v[134:135], v139 offset:38544
    s_waitcnt lgkmcnt(12)
    v_mfma_f32_16x16x32_bf16 v[96:99], v[108:111], a[40:43], v[96:99]
    ds_read_b64_tr_b16 v[104:105], v139 offset:40960
    s_add_u32 s80, s95, 28672
    s_add_u32 m0, s81, 102400
    s_nop 0
    buffer_load_dwordx4 v1, s[4:7], s80 offen sc1 lds
    v_mfma_f32_16x16x32_bf16 v[100:103], v[108:111], a[44:47], v[100:103]
    v_mfma_f32_16x16x32_bf16 v[188:191], v[108:111], v[168:171], v[188:191]
    ds_read_b64_tr_b16 v[106:107], v139 offset:41040
    s_waitcnt lgkmcnt(12)
    v_mfma_f32_16x16x32_bf16 v[80:83], v[112:115], a[48:51], v[80:83]
    ds_read_b64_tr_b16 v[108:109], v139 offset:40992
    v_mfma_f32_16x16x32_bf16 v[84:87], v[112:115], a[52:55], v[84:87]
    v_mfma_f32_16x16x32_bf16 v[180:183], v[112:115], v[168:171], v[180:183]
    ds_read_b64_tr_b16 v[110:111], v139 offset:41072
    s_waitcnt lgkmcnt(12)
    v_mfma_f32_16x16x32_bf16 v[88:91], v[116:119], a[48:51], v[88:91]
    ds_read_b64_tr_b16 v[112:113], v139 offset:41024
    v_mfma_f32_16x16x32_bf16 v[92:95], v[116:119], a[52:55], v[92:95]
    v_mfma_f32_16x16x32_bf16 v[184:187], v[116:119], v[168:171], v[184:187]
    ds_read_b64_tr_b16 v[114:115], v139 offset:41104
    s_waitcnt lgkmcnt(12)
    v_mfma_f32_16x16x32_bf16 v[96:99], v[120:123], a[48:51], v[96:99]
    ds_read_b64_tr_b16 v[116:117], v139 offset:43520
    s_add_u32 s80, s95, 32768
    s_add_u32 m0, s81, 106496
    s_nop 0
    buffer_load_dwordx4 v1, s[4:7], s80 offen sc1 lds
    v_mfma_f32_16x16x32_bf16 v[100:103], v[120:123], a[52:55], v[100:103]
    v_mfma_f32_16x16x32_bf16 v[188:191], v[120:123], v[168:171], v[188:191]
    ds_read_b64_tr_b16 v[118:119], v139 offset:43600
    s_waitcnt lgkmcnt(12)
    v_mfma_f32_16x16x32_bf16 v[80:83], v[124:127], a[56:59], v[80:83]
    ds_read_b64_tr_b16 v[120:121], v139 offset:43552
    v_mfma_f32_16x16x32_bf16 v[84:87], v[124:127], a[60:63], v[84:87]
    v_mfma_f32_16x16x32_bf16 v[180:183], v[124:127], v[168:171], v[180:183]
    ds_read_b64_tr_b16 v[122:123], v139 offset:43632
    s_waitcnt lgkmcnt(12)
    v_mfma_f32_16x16x32_bf16 v[88:91], v[128:131], a[56:59], v[88:91]
    ds_read_b64_tr_b16 v[124:125], v139 offset:43584
    s_add_u32 s80, s95, 36864
    s_add_u32 m0, s81, 110592
    s_nop 0
    buffer_load_dwordx4 v1, s[4:7], s80 offen sc1 lds
    v_mfma_f32_16x16x32_bf16 v[92:95], v[128:131], a[60:63], v[92:95]
    s_mul_i32 s80, s58, 20480
    s_mul_i32 s93, s56, 160
    s_add_u32 s80, s80, s93
    v_mul_u32_u24 v24, 1280, v23
    v_lshl_add_u32 v25, v22, 3, v24
    v_lshl_add_u32 v24, v22, 4, v24
    buffer_load_dwordx4 v[4:7], v24, s[8:11], s80 offen
    buffer_load_dwordx4 v[8:11], v24, s[8:11], s80 offen offset:64
    buffer_load_dwordx2 v[12:13], v25, s[8:11], s80 offen offset:128
    v_mfma_f32_16x16x32_bf16 v[184:187], v[128:131], v[168:171], v[184:187]
    ds_read_b64_tr_b16 v[126:127], v139 offset:43664
    s_waitcnt lgkmcnt(12)
    v_mfma_f32_16x16x32_bf16 v[96:99], v[132:135], a[56:59], v[96:99]
    ds_read_b64_tr_b16 v[128:129], v139 offset:46080
    v_mfma_f32_16x16x32_bf16 v[100:103], v[132:135], a[60:63], v[100:103]
    v_mfma_f32_16x16x32_bf16 v[188:191], v[132:135], v[168:171], v[188:191]
    ds_read_b64_tr_b16 v[130:131], v139 offset:46160
    s_waitcnt lgkmcnt(12)
    v_mfma_f32_16x16x32_bf16 v[80:83], v[104:107], a[64:67], v[80:83]
    ds_read_b64_tr_b16 v[132:133], v139 offset:46112
    v_mfma_f32_16x16x32_bf16 v[84:87], v[104:107], a[68:71], v[84:87]
    v_mfma_f32_16x16x32_bf16 v[180:183], v[104:107], v[168:171], v[180:183]
    ds_read_b64_tr_b16 v[134:135], v139 offset:46192
    s_waitcnt lgkmcnt(12)
    v_mfma_f32_16x16x32_bf16 v[88:91], v[108:111], a[64:67], v[88:91]
    ds_read_b64_tr_b16 v[104:105], v139 offset:46144
    s_add_u32 s80, s95, 40960
    s_add_u32 m0, s81, 114688
    s_nop 0
    buffer_load_dwordx4 v1, s[4:7], s80 offen sc1 lds
    v_mfma_f32_16x16x32_bf16 v[92:95], v[108:111], a[68:71], v[92:95]
    v_mfma_f32_16x16x32_bf16 v[184:187], v[108:111], v[168:171], v[184:187]
    ds_read_b64_tr_b16 v[106:107], v139 offset:46224
    s_waitcnt lgkmcnt(12)
    v_mfma_f32_16x16x32_bf16 v[96:99], v[112:115], a[64:67], v[96:99]
    ds_read_b64_tr_b16 v[108:109], v139 offset:48640
    v_mfma_f32_16x16x32_bf16 v[100:103], v[112:115], a[68:71], v[100:103]
    v_mfma_f32_16x16x32_bf16 v[188:191], v[112:115], v[168:171], v[188:191]
    ds_read_b64_tr_b16 v[110:111], v139 offset:48720
    s_waitcnt lgkmcnt(12)
    v_mfma_f32_16x16x32_bf16 v[80:83], v[116:119], a[72:75], v[80:83]
    ds_read_b64_tr_b16 v[112:113], v139 offset:48672
    s_add_u32 s80, s95, 45056
    s_add_u32 m0, s81, 118784
    s_nop 0
    buffer_load_dwordx4 v1, s[4:7], s80 offen sc1 lds
    v_mfma_f32_16x16x32_bf16 v[84:87], v[116:119], a[76:79], v[84:87]
    v_mfma_f32_16x16x32_bf16 v[180:183], v[116:119], v[168:171], v[180:183]
    ds_read_b64_tr_b16 v[114:115], v139 offset:48752
    s_waitcnt lgkmcnt(12)
    v_mfma_f32_16x16x32_bf16 v[88:91], v[120:123], a[72:75], v[88:91]
    ds_read_b64_tr_b16 v[116:117], v139 offset:48704
    s_mov_b32 exec_lo, 0x01010101
    s_mov_b32 exec_hi, 0x01010101
    s_add_u32 s80, s62, 0
    buffer_load_dword v73, v26, s[4:7], s80 offen sc1
    buffer_load_dword v73, v27, s[4:7], s80 offen sc1
    s_add_u32 s80, s62, 24576
    buffer_load_dword v73, v26, s[4:7], s80 offen sc1
    buffer_load_dword v73, v27, s[4:7], s80 offen sc1
    s_mov_b64 exec, -1
    v_mfma_f32_16x16x32_bf16 v[92:95], v[120:123], a[76:79], v[92:95]
    v_mfma_f32_16x16x32_bf16 v[184:187], v[120:123], v[168:171], v[184:187]
    ds_read_b64_tr_b16 v[118:119], v139 offset:48784
    s_waitcnt lgkmcnt(12)
    v_mfma_f32_16x16x32_bf16 v[96:99], v[124:127], a[72:75], v[96:99]
    ds_read_b64_tr_b16 v[120:121], v139 offset:51200
    v_mfma_f32_16x16x32_bf16 v[100:103], v[124:127], a[76:79], v[100:103]
    v_mfma_f32_16x16x32_bf16 v[188:191], v[124:127], v[168:171], v[188:191]
    ds_read_b64_tr_b16 v[122:123], v139 offset:51280
    s_waitcnt lgkmcnt(12)
    v_mfma_f32_16x16x32_bf16 v[80:83], v[128:131], a[80:83], v[80:83]
    ds_read_b64_tr_b16 v[124:125], v139 offset:51232
    v_mfma_f32_16x16x32_bf16 v[84:87], v[128:131], a[84:87], v[84:87]
    v_mfma_f32_16x16x32_bf16 v[180:183], v[128:131], v[168:171], v[180:183]
    ds_read_b64_tr_b16 v[126:127], v139 offset:51312
    s_waitcnt lgkmcnt(12)
    v_mfma_f32_16x16x32_bf16 v[88:91], v[132:135], a[80:83], v[88:91]
    ds_read_b64_tr_b16 v[128:129], v139 offset:51264
    v_mfma_f32_16x16x32_bf16 v[92:95], v[132:135], a[84:87], v[92:95]
    v_mfma_f32_16x16x32_bf16 v[184:187], v[132:135], v[168:171], v[184:187]
    ds_read_b64_tr_b16 v[130:131], v139 offset:51344
    s_waitcnt lgkmcnt(12)
    v_mfma_f32_16x16x32_bf16 v[96:99], v[104:107], a[80:83], v[96:99]
    ds_read_b64_tr_b16 v[132:133], v139 offset:53760
    v_mfma_f32_16x16x32_bf16 v[100:103], v[104:107], a[84:87], v[100:103]
    v_mfma_f32_16x16x32_bf16 v[188:191], v[104:107], v[168:171], v[188:191]
    ds_read_b64_tr_b16 v[134:135], v139 offset:53840
    s_waitcnt lgkmcnt(12)
    v_mfma_f32_16x16x32_bf16 v[80:83], v[108:111], a[88:91], v[80:83]
    ds_read_b64_tr_b16 v[104:105], v139 offset:53792
    v_mfma_f32_16x16x32_bf16 v[84:87], v[108:111], a[92:95], v[84:87]
    v_mfma_f32_16x16x32_bf16 v[180:183], v[108:111], v[168:171], v[180:183]
    ds_read_b64_tr_b16 v[106:107], v139 offset:53872
    s_waitcnt lgkmcnt(12)
    v_mfma_f32_16x16x32_bf16 v[88:91], v[112:115], a[88:91], v[88:91]
    ds_read_b64_tr_b16 v[108:109], v139 offset:53824
    v_mfma_f32_16x16x32_bf16 v[92:95], v[112:115], a[92:95], v[92:95]
    v_mfma_f32_16x16x32_bf16 v[184:187], v[112:115], v[168:171], v[184:187]
    ds_read_b64_tr_b16 v[110:111], v139 offset:53904
    s_waitcnt lgkmcnt(12)
    v_mfma_f32_16x16x32_bf16 v[96:99], v[116:119], a[88:91], v[96:99]
    ds_read_b64_tr_b16 v[112:113], v139 offset:56320
    v_mfma_f32_16x16x32_bf16 v[100:103], v[116:119], a[92:95], v[100:103]
    v_mfma_f32_16x16x32_bf16 v[188:191], v[116:119], v[168:171], v[188:191]
    ds_read_b64_tr_b16 v[114:115], v139 offset:56400
    s_waitcnt lgkmcnt(12)
    v_mfma_f32_16x16x32_bf16 v[80:83], v[120:123], a[96:99], v[80:83]
    ds_read_b64_tr_b16 v[116:117], v139 offset:56352
    s_add_u32 s80, s71, 0
    buffer_load_dwordx4 v[192:195], v37, s[4:7], s80 offen sc1
    v_mfma_f32_16x16x32_bf16 v[84:87], v[120:123], a[100:103], v[84:87]
    v_mfma_f32_16x16x32_bf16 v[180:183], v[120:123], v[168:171], v[180:183]
    ds_read_b64_tr_b16 v[118:119], v139 offset:56432
    s_waitcnt lgkmcnt(12)
    v_mfma_f32_16x16x32_bf16 v[88:91], v[124:127], a[96:99], v[88:91]
    ds_read_b64_tr_b16 v[120:121], v139 offset:56384
    v_mfma_f32_16x16x32_bf16 v[92:95], v[124:127], a[100:103], v[92:95]
    v_mfma_f32_16x16x32_bf16 v[184:187], v[124:127], v[168:171], v[184:187]
    ds_read_b64_tr_b16 v[122:123], v139 offset:56464
    s_waitcnt lgkmcnt(12)
    v_mfma_f32_16x16x32_bf16 v[96:99], v[128:131], a[96:99], v[96:99]
    ds_read_b64_tr_b16 v[124:125], v139 offset:58880
    s_add_u32 s80, s71, 3584
    buffer_load_dwordx4 v[196:199], v37, s[4:7], s80 offen sc1
    v_mfma_f32_16x16x32_bf16 v[100:103], v[128:131], a[100:103], v[100:103]
    v_mfma_f32_16x16x32_bf16 v[188:191], v[128:131], v[168:171], v[188:191]
    ds_read_b64_tr_b16 v[126:127], v139 offset:58960
    s_waitcnt lgkmcnt(12)
    v_mfma_f32_16x16x32_bf16 v[80:83], v[132:135], a[104:107], v[80:83]
    ds_read_b64_tr_b16 v[128:129], v139 offset:58912
    v_mfma_f32_16x16x32_bf16 v[84:87], v[132:135], a[108:111], v[84:87]
    v_mfma_f32_16x16x32_bf16 v[180:183], v[132:135], v[168:171], v[180:183]
    ds_read_b64_tr_b16 v[130:131], v139 offset:58992
    s_waitcnt lgkmcnt(12)
    v_mfma_f32_16x16x32_bf16 v[88:91], v[104:107], a[104:107], v[88:91]
    ds_read_b64_tr_b16 v[132:133], v139 offset:58944
    s_add_u32 s80, s71, 7168
    buffer_load_dwordx4 v[200:203], v37, s[4:7], s80 offen sc1
    v_mfma_f32_16x16x32_bf16 v[92:95], v[104:107], a[108:111], v[92:95]
    v_mfma_f32_16x16x32_bf16 v[184:187], v[104:107], v[168:171], v[184:187]
    ds_read_b64_tr_b16 v[134:135], v139 offset:59024
    s_waitcnt lgkmcnt(12)
    v_mfma_f32_16x16x32_bf16 v[96:99], v[108:111], a[104:107], v[96:99]
    ds_read_b64_tr_b16 v[104:105], v139 offset:61440
    v_mfma_f32_16x16x32_bf16 v[100:103], v[108:111], a[108:111], v[100:103]
    v_mfma_f32_16x16x32_bf16 v[188:191], v[108:111], v[168:171], v[188:191]
    ds_read_b64_tr_b16 v[106:107], v139 offset:61520
    s_waitcnt lgkmcnt(12)
    v_mfma_f32_16x16x32_bf16 v[80:83], v[112:115], a[112:115], v[80:83]
    ds_read_b64_tr_b16 v[108:109], v139 offset:61472
    s_add_u32 s80, s71, 10752
    buffer_load_dwordx4 v[204:207], v37, s[4:7], s80 offen sc1
    v_mfma_f32_16x16x32_bf16 v[84:87], v[112:115], a[116:119], v[84:87]
    v_mfma_f32_16x16x32_bf16 v[180:183], v[112:115], v[168:171], v[180:183]
    ds_read_b64_tr_b16 v[110:111], v139 offset:61552
    s_waitcnt lgkmcnt(12)
    v_mfma_f32_16x16x32_bf16 v[88:91], v[116:119], a[112:115], v[88:91]
    ds_read_b64_tr_b16 v[112:113], v139 offset:61504
    v_mfma_f32_16x16x32_bf16 v[92:95], v[116:119], a[116:119], v[92:95]
    v_mfma_f32_16x16x32_bf16 v[184:187], v[116:119], v[168:171], v[184:187]
    ds_read_b64_tr_b16 v[114:115], v139 offset:61584
    s_waitcnt lgkmcnt(12)
    v_mfma_f32_16x16x32_bf16 v[96:99], v[120:123], a[112:115], v[96:99]
    ds_read_b64_tr_b16 v[116:117], v139 offset:64000
    s_add_u32 s80, s71, 14336
    buffer_load_dwordx4 v[208:211], v37, s[4:7], s80 offen sc1
    v_mfma_f32_16x16x32_bf16 v[100:103], v[120:123], a[116:119], v[100:103]
    v_mfma_f32_16x16x32_bf16 v[188:191], v[120:123], v[168:171], v[188:191]
    ds_read_b64_tr_b16 v[118:119], v139 offset:64080
    s_waitcnt lgkmcnt(12)
    v_mfma_f32_16x16x32_bf16 v[80:83], v[124:127], a[120:123], v[80:83]
    ds_read_b64_tr_b16 v[120:121], v139 offset:64032
    v_mfma_f32_16x16x32_bf16 v[84:87], v[124:127], a[124:127], v[84:87]
    v_mfma_f32_16x16x32_bf16 v[180:183], v[124:127], v[168:171], v[180:183]
    ds_read_b64_tr_b16 v[122:123], v139 offset:64112
    s_waitcnt lgkmcnt(12)
    v_mfma_f32_16x16x32_bf16 v[88:91], v[128:131], a[120:123], v[88:91]
    ds_read_b64_tr_b16 v[124:125], v139 offset:64064
    s_add_u32 s80, s71, 17920
    buffer_load_dwordx4 v[212:215], v37, s[4:7], s80 offen sc1
    v_mfma_f32_16x16x32_bf16 v[92:95], v[128:131], a[124:127], v[92:95]
    v_mfma_f32_16x16x32_bf16 v[184:187], v[128:131], v[168:171], v[184:187]
    ds_read_b64_tr_b16 v[126:127], v139 offset:64144
    s_waitcnt lgkmcnt(12)
    v_mfma_f32_16x16x32_bf16 v[96:99], v[132:135], a[120:123], v[96:99]
    ds_read_b64_tr_b16 v[128:129], v140 offset:1024
    v_mfma_f32_16x16x32_bf16 v[100:103], v[132:135], a[124:127], v[100:103]
    v_mfma_f32_16x16x32_bf16 v[188:191], v[132:135], v[168:171], v[188:191]
    ds_read_b64_tr_b16 v[130:131], v140 offset:1104
    s_waitcnt lgkmcnt(12)
    v_mfma_f32_16x16x32_bf16 v[80:83], v[104:107], a[128:131], v[80:83]
    ds_read_b64_tr_b16 v[132:133], v140 offset:1056
    s_add_u32 s80, s71, 21504
    buffer_load_dwordx4 v[216:219], v37, s[4:7], s80 offen sc1
    v_mfma_f32_16x16x32_bf16 v[84:87], v[104:107], a[132:135], v[84:87]
    v_mfma_f32_16x16x32_bf16 v[180:183], v[104:107], v[168:171], v[180:183]
    ds_read_b64_tr_b16 v[134:135], v140 offset:1136
    s_waitcnt lgkmcnt(12)
    v_mfma_f32_16x16x32_bf16 v[88:91], v[108:111], a[128:131], v[88:91]
    ds_read_b64_tr_b16 v[104:105], v140 offset:1088
    v_mfma_f32_16x16x32_bf16 v[92:95], v[108:111], a[132:135], v[92:95]
    v_mfma_f32_16x16x32_bf16 v[184:187], v[108:111], v[168:171], v[184:187]
    ds_read_b64_tr_b16 v[106:107], v140 offset:1168
    s_waitcnt lgkmcnt(12)
    v_mfma_f32_16x16x32_bf16 v[96:99], v[112:115], a[128:131], v[96:99]
    ds_read_b64_tr_b16 v[108:109], v140 offset:3584
    s_add_u32 s80, s71, 25088
    buffer_load_dwordx4 v[220:223], v37, s[4:7], s80 offen sc1
    v_mfma_f32_16x16x32_bf16 v[100:103], v[112:115], a[132:135], v[100:103]
    v_mfma_f32_16x16x32_bf16 v[188:191], v[112:115], v[168:171], v[188:191]
    ds_read_b64_tr_b16 v[110:111], v140 offset:3664
    s_waitcnt lgkmcnt(12)
    v_mfma_f32_16x16x32_bf16 v[80:83], v[116:119], a[136:139], v[80:83]
    ds_read_b64_tr_b16 v[112:113], v140 offset:3616
    v_mfma_f32_16x16x32_bf16 v[84:87], v[116:119], a[140:143], v[84:87]
    v_mfma_f32_16x16x32_bf16 v[180:183], v[116:119], v[168:171], v[180:183]
    ds_read_b64_tr_b16 v[114:115], v140 offset:3696
    s_waitcnt lgkmcnt(12)
    v_mfma_f32_16x16x32_bf16 v[88:91], v[120:123], a[136:139], v[88:91]
    ds_read_b64_tr_b16 v[116:117], v140 offset:3648
    v_mfma_f32_16x16x32_bf16 v[92:95], v[120:123], a[140:143], v[92:95]
    v_mfma_f32_16x16x32_bf16 v[184:187], v[120:123], v[168:171], v[184:187]
    ds_read_b64_tr_b16 v[118:119], v140 offset:3728
    s_waitcnt lgkmcnt(12)
    v_mfma_f32_16x16x32_bf16 v[96:99], v[124:127], a[136:139], v[96:99]
    v_mfma_f32_16x16x32_bf16 v[100:103], v[124:127], a[140:143], v[100:103]
    v_mfma_f32_16x16x32_bf16 v[188:191], v[124:127], v[168:171], v[188:191]
    s_waitcnt lgkmcnt(10)
    v_mfma_f32_16x16x32_bf16 v[80:83], v[128:131], a[144:147], v[80:83]
    v_mfma_f32_16x16x32_bf16 v[84:87], v[128:131], a[148:151], v[84:87]
    v_mfma_f32_16x16x32_bf16 v[180:183], v[128:131], v[168:171], v[180:183]
    s_waitcnt lgkmcnt(8)
    v_mfma_f32_16x16x32_bf16 v[88:91], v[132:135], a[144:147], v[88:91]
    v_mfma_f32_16x16x32_bf16 v[92:95], v[132:135], a[148:151], v[92:95]
    v_mfma_f32_16x16x32_bf16 v[184:187], v[132:135], v[168:171], v[184:187]
    s_waitcnt lgkmcnt(6)
    v_mfma_f32_16x16x32_bf16 v[96:99], v[104:107], a[144:147], v[96:99]
    v_mfma_f32_16x16x32_bf16 v[100:103], v[104:107], a[148:151], v[100:103]
    v_mfma_f32_16x16x32_bf16 v[188:191], v[104:107], v[168:171], v[188:191]
    s_waitcnt lgkmcnt(4)
    v_mfma_f32_16x16x32_bf16 v[80:83], v[108:111], a[152:155], v[80:83]
    v_mfma_f32_16x16x32_bf16 v[84:87], v[108:111], a[156:159], v[84:87]
    v_mfma_f32_16x16x32_bf16 v[180:183], v[108:111], v[168:171], v[180:183]
    s_waitcnt lgkmcnt(2)
    v_mfma_f32_16x16x32_bf16 v[88:91], v[112:115], a[152:155], v[88:91]
    v_mfma_f32_16x16x32_bf16 v[92:95], v[112:115], a[156:159], v[92:95]
    v_mfma_f32_16x16x32_bf16 v[184:187], v[112:115], v[168:171], v[184:187]
    s_waitcnt lgkmcnt(0)
    v_mfma_f32_16x16x32_bf16 v[96:99], v[116:119], a[152:155], v[96:99]
    v_mfma_f32_16x16x32_bf16 v[100:103], v[116:119], a[156:159], v[100:103]
    v_mfma_f32_16x16x32_bf16 v[188:191], v[116:119], v[168:171], v[188:191]
    ds_write_b128 v38, v[180:183] offset:0
    s_nop 2
    ds_write_b128 v38, v[184:187] offset:64
    s_nop 2
    ds_write_b128 v38, v[188:191] offset:128
    v_pk_fma_f32 v[80:81], v[180:181], v[174:175], v[80:81] op_sel:[0,0,0] op_sel_hi:[1,0,1]
    v_pk_fma_f32 v[82:83], v[182:183], v[174:175], v[82:83] op_sel:[0,0,0] op_sel_hi:[1,0,1]
    v_pk_fma_f32 v[88:89], v[184:185], v[174:175], v[88:89] op_sel:[0,0,0] op_sel_hi:[1,0,1]
    v_pk_fma_f32 v[90:91], v[186:187], v[174:175], v[90:91] op_sel:[0,0,0] op_sel_hi:[1,0,1]
    v_pk_fma_f32 v[96:97], v[188:189], v[174:175], v[96:97] op_sel:[0,0,0] op_sel_hi:[1,0,1]
    v_pk_fma_f32 v[98:99], v[190:191], v[174:175], v[98:99] op_sel:[0,0,0] op_sel_hi:[1,0,1]
    v_pk_fma_f32 v[84:85], v[180:181], v[174:175], v[84:85] op_sel:[0,1,0] op_sel_hi:[1,1,1]
    v_pk_fma_f32 v[86:87], v[182:183], v[174:175], v[86:87] op_sel:[0,1,0] op_sel_hi:[1,1,1]
    v_pk_fma_f32 v[92:93], v[184:185], v[174:175], v[92:93] op_sel:[0,1,0] op_sel_hi:[1,1,1]
    v_pk_fma_f32 v[94:95], v[186:187], v[174:175], v[94:95] op_sel:[0,1,0] op_sel_hi:[1,1,1]
    v_pk_fma_f32 v[100:101], v[188:189], v[174:175], v[100:101] op_sel:[0,1,0] op_sel_hi:[1,1,1]
    s_add_u32 s80, s95, 49152
    s_add_u32 m0, s81, 122880
    s_nop 0
    buffer_load_dwordx4 v1, s[4:7], s80 offen sc1 lds
    v_pk_fma_f32 v[102:103], v[190:191], v[174:175], v[102:103] op_sel:[0,1,0] op_sel_hi:[1,1,1]
    v_pk_mul_f32 v[156:157], v[80:81], v[178:179] op_sel:[0,0] op_sel_hi:[1,0]
    v_pk_fma_f32 v[158:159], v[80:81], v[176:177], v[18:19] op_sel:[0,0,0] op_sel_hi:[1,0,0]
    v_exp_f32_e64 v156, v156 clamp
    v_exp_f32_e64 v157, v157 clamp
    v_max_f32 v156, v156, v158
    v_max_f32 v157, v157, v159
    v_pk_add_f32 v[156:157], v[156:157], v[18:19] op_sel:[0,1] op_sel_hi:[1,1]
    v_cvt_pk_bf16_f32 v144, v156, v157
    v_pk_mul_f32 v[160:161], v[82:83], v[178:179] op_sel:[0,0] op_sel_hi:[1,0]
    v_pk_fma_f32 v[162:163], v[82:83], v[176:177], v[18:19] op_sel:[0,0,0] op_sel_hi:[1,0,0]
    v_exp_f32_e64 v160, v160 clamp
    v_exp_f32_e64 v161, v161 clamp
    v_max_f32 v160, v160, v162
    v_max_f32 v161, v161, v163
    v_pk_add_f32 v[160:161], v[160:161], v[18:19] op_sel:[0,1] op_sel_hi:[1,1]
    v_cvt_pk_bf16_f32 v145, v160, v161
    v_pk_mul_f32 v[156:157], v[88:89], v[178:179] op_sel:[0,0] op_sel_hi:[1,0]
    s_add_u32 s80, s95, 53248
    s_add_u32 m0, s81, 126976
    s_nop 0
    buffer_load_dwordx4 v1, s[4:7], s80 offen sc1 lds
    v_pk_fma_f32 v[158:159], v[88:89], v[176:177], v[18:19] op_sel:[0,0,0] op_sel_hi:[1,0,0]
    v_exp_f32_e64 v156, v156 clamp
    v_exp_f32_e64 v157, v157 clamp
    v_max_f32 v156, v156, v158
    v_max_f32 v157, v157, v159
    v_pk_add_f32 v[156:157], v[156:157], v[18:19] op_sel:[0,1] op_sel_hi:[1,1]
    v_cvt_pk_bf16_f32 v146, v156, v157
    v_pk_mul_f32 v[160:161], v[90:91], v[178:179] op_sel:[0,0] op_sel_hi:[1,0]
    v_pk_fma_f32 v[162:163], v[90:91], v[176:177], v[18:19] op_sel:[0,0,0] op_sel_hi:[1,0,0]
    v_exp_f32_e64 v160, v160 clamp
    v_exp_f32_e64 v161, v161 clamp
    v_max_f32 v160, v160, v162
    v_max_f32 v161, v161, v163
    v_pk_add_f32 v[160:161], v[160:161], v[18:19] op_sel:[0,1] op_sel_hi:[1,1]
    v_cvt_pk_bf16_f32 v147, v160, v161
    v_pk_mul_f32 v[156:157], v[96:97], v[178:179] op_sel:[0,0] op_sel_hi:[1,0]
    v_pk_fma_f32 v[158:159], v[96:97], v[176:177], v[18:19] op_sel:[0,0,0] op_sel_hi:[1,0,0]
    v_exp_f32_e64 v156, v156 clamp
    s_add_u32 s80, s95, 57344
    s_add_u32 m0, s81, 131072
    s_nop 0
    buffer_load_dwordx4 v1, s[4:7], s80 offen sc1 lds
    v_exp_f32_e64 v157, v157 clamp
    v_max_f32 v156, v156, v158
    v_max_f32 v157, v157, v159
    v_pk_add_f32 v[156:157], v[156:157], v[18:19] op_sel:[0,1] op_sel_hi:[1,1]
    v_cvt_pk_bf16_f32 v148, v156, v157
    v_pk_mul_f32 v[160:161], v[98:99], v[178:179] op_sel:[0,0] op_sel_hi:[1,0]
    v_pk_fma_f32 v[162:163], v[98:99], v[176:177], v[18:19] op_sel:[0,0,0] op_sel_hi:[1,0,0]
    v_exp_f32_e64 v160, v160 clamp
    v_exp_f32_e64 v161, v161 clamp
    v_max_f32 v160, v160, v162
    v_max_f32 v161, v161, v163
    v_pk_add_f32 v[160:161], v[160:161], v[18:19] op_sel:[0,1] op_sel_hi:[1,1]
    v_cvt_pk_bf16_f32 v149, v160, v161
    v_pk_mul_f32 v[156:157], v[84:85], v[178:179] op_sel:[0,1] op_sel_hi:[1,1]
    v_pk_fma_f32 v[158:159], v[84:85], v[176:177], v[18:19] op_sel:[0,1,0] op_sel_hi:[1,1,0]
    v_exp_f32_e64 v156, v156 clamp
    v_exp_f32_e64 v157, v157 clamp
    s_add_u32 s80, s95, 61440
    s_add_u32 m0, s81, 135168
    s_nop 0
    buffer_load_dwordx4 v1, s[4:7], s80 offen sc1 lds
    v_max_f32 v156, v156, v158
    v_max_f32 v157, v157, v159
    v_pk_add_f32 v[156:157], v[156:157], v[18:19] op_sel:[0,1] op_sel_hi:[1,1]
    v_cvt_pk_bf16_f32 v150, v156, v157
    v_pk_mul_f32 v[160:161], v[86:87], v[178:179] op_sel:[0,1] op_sel_hi:[1,1]
    v_pk_fma_f32 v[162:163], v[86:87], v[176:177], v[18:19] op_sel:[0,1,0] op_sel_hi:[1,1,0]
    v_exp_f32_e64 v160, v160 clamp
    v_exp_f32_e64 v161, v161 clamp
    v_max_f32 v160, v160, v162
    v_max_f32 v161, v161, v163
    v_pk_add_f32 v[160:161], v[160:161], v[18:19] op_sel:[0,1] op_sel_hi:[1,1]
    v_cvt_pk_bf16_f32 v151, v160, v161
    v_pk_mul_f32 v[156:157], v[92:93], v[178:179] op_sel:[0,1] op_sel_hi:[1,1]
    v_pk_fma_f32 v[158:159], v[92:93], v[176:177], v[18:19] op_sel:[0,1,0] op_sel_hi:[1,1,0]
    v_exp_f32_e64 v156, v156 clamp
    v_exp_f32_e64 v157, v157 clamp
    v_max_f32 v156, v156, v158
    v_max_f32 v157, v157, v159
    s_add_u32 s80, s95, 65536
    s_add_u32 m0, s81, 139264
    s_nop 0
    buffer_load_dwordx4 v1, s[4:7], s80 offen sc1 lds
    v_pk_add_f32 v[156:157], v[156:157], v[18:19] op_sel:[0,1] op_sel_hi:[1,1]
    v_cvt_pk_bf16_f32 v152, v156, v157
    v_pk_mul_f32 v[160:161], v[94:95], v[178:179] op_sel:[0,1] op_sel_hi:[1,1]
    v_pk_fma_f32 v[162:163], v[94:95], v[176:177], v[18:19] op_sel:[0,1,0] op_sel_hi:[1,1,0]
    v_exp_f32_e64 v160, v160 clamp
    v_exp_f32_e64 v161, v161 clamp
    v_max_f32 v160, v160, v162
    v_max_f32 v161, v161, v163
    v_pk_add_f32 v[160:161], v[160:161], v[18:19] op_sel:[0,1] op_sel_hi:[1,1]
    v_cvt_pk_bf16_f32 v153, v160, v161
    v_pk_mul_f32 v[156:157], v[100:101], v[178:179] op_sel:[0,1] op_sel_hi:[1,1]
    v_pk_fma_f32 v[158:159], v[100:101], v[176:177], v[18:19] op_sel:[0,1,0] op_sel_hi:[1,1,0]
    v_exp_f32_e64 v156, v156 clamp
    v_exp_f32_e64 v157, v157 clamp
    v_max_f32 v156, v156, v158
    v_max_f32 v157, v157, v159
    v_pk_add_f32 v[156:157], v[156:157], v[18:19] op_sel:[0,1] op_sel_hi:[1,1]
    v_cvt_pk_bf16_f32 v154, v156, v157
    s_add_u32 s80, s95, 69632
    s_add_u32 m0, s81, 143360
    s_nop 0
    buffer_load_dwordx4 v1, s[4:7], s80 offen sc1 lds
    v_pk_mul_f32 v[160:161], v[102:103], v[178:179] op_sel:[0,1] op_sel_hi:[1,1]
    v_pk_fma_f32 v[162:163], v[102:103], v[176:177], v[18:19] op_sel:[0,1,0] op_sel_hi:[1,1,0]
    v_exp_f32_e64 v160, v160 clamp
    v_exp_f32_e64 v161, v161 clamp
    v_max_f32 v160, v160, v162
    v_max_f32 v161, v161, v163
    v_pk_add_f32 v[160:161], v[160:161], v[18:19] op_sel:[0,1] op_sel_hi:[1,1]
    v_cvt_pk_bf16_f32 v155, v160, v161
    v_cndmask_b32 v148, 0, v148, s[72:73]
    v_cndmask_b32 v149, 0, v149, s[72:73]
    v_cndmask_b32 v154, 0, v154, s[72:73]
    v_cndmask_b32 v155, 0, v155, s[72:73]
    s_mov_b32 s82, 0
    s_waitcnt vmcnt(6)
Lchk_15:
    v_max_u32 v77, v192, v193
    v_max3_u32 v77, v194, v195, v77
    v_max3_u32 v77, v196, v197, v77
    v_max3_u32 v77, v198, v199, v77
    v_max3_u32 v77, v200, v201, v77
    v_max3_u32 v77, v202, v203, v77
    v_max3_u32 v77, v204, v205, v77
    v_max3_u32 v77, v206, v207, v77
    v_max3_u32 v77, v208, v209, v77
    v_max3_u32 v77, v210, v211, v77
    v_max3_u32 v77, v212, v213, v77
    v_max3_u32 v77, v214, v215, v77
    v_max3_u32 v77, v216, v217, v77
    v_max3_u32 v77, v218, v219, v77
    v_max3_u32 v77, v220, v221, v77
    v_max3_u32 v77, v222, v223, v77
    v_cmp_eq_u32 vcc, -1, v77
    s_add_u32 s82, s82, 1
    s_cmp_eq_u64 vcc, 0
    s_cbranch_scc1 Lok_16
    s_cmp_ge_u32 s82, 200000
    s_cbranch_scc1 LEND
    s_add_u32 s80, s71, 0
    buffer_load_dwordx4 v[192:195], v37, s[4:7], s80 offen sc1
    s_add_u32 s80, s71, 3584
    buffer_load_dwordx4 v[196:199], v37, s[4:7], s80 offen sc1
    s_add_u32 s80, s71, 7168
    buffer_load_dwordx4 v[200:203], v37, s[4:7], s80 offen sc1
    s_add_u32 s80, s71, 10752
    buffer_load_dwordx4 v[204:207], v37, s[4:7], s80 offen sc1
    s_add_u32 s80, s71, 14336
    buffer_load_dwordx4 v[208:211], v37, s[4:7], s80 offen sc1
    s_add_u32 s80, s71, 17920
    buffer_load_dwordx4 v[212:215], v37, s[4:7], s80 offen sc1
    s_add_u32 s80, s71, 21504
    buffer_load_dwordx4 v[216:219], v37, s[4:7], s80 offen sc1
    s_add_u32 s80, s71, 25088
    buffer_load_dwordx4 v[220:223], v37, s[4:7], s80 offen sc1
    s_waitcnt vmcnt(0)
    s_branch Lchk_15
Lok_16:
    v_lshlrev_b32 v76, 2, v0
    v_cmp_gt_u32 vcc, 96, v0
    s_mov_b64 s[84:85], vcc
    s_mul_i32 s86, s54, 7680
    s_add_u32 s86, s86, 1474560
    s_add_u32 s87, s86, 3840
    v_cndmask_b32 v78, v36, v76, s[84:85]
    buffer_load_dword v228, v78, s[4:7], s86 offen offset:0 sc1
    buffer_load_dword v229, v78, s[4:7], s86 offen offset:384 sc1
    buffer_load_dword v230, v78, s[4:7], s86 offen offset:768 sc1
    buffer_load_dword v231, v78, s[4:7], s86 offen offset:1152 sc1
    buffer_load_dword v232, v78, s[4:7], s86 offen offset:1536 sc1
    buffer_load_dword v233, v78, s[4:7], s86 offen offset:1920 sc1
    buffer_load_dword v234, v78, s[4:7], s86 offen offset:2304 sc1
    buffer_load_dword v235, v78, s[4:7], s86 offen offset:2688 sc1
    buffer_load_dword v236, v78, s[4:7], s86 offen offset:3072 sc1
    buffer_load_dword v237, v78, s[4:7], s86 offen offset:3456 sc1
    buffer_load_dword v238, v78, s[4:7], s87 offen offset:0 sc1
    buffer_load_dword v239, v78, s[4:7], s87 offen offset:384 sc1
    buffer_load_dword v240, v78, s[4:7], s87 offen offset:768 sc1
    buffer_load_dword v241, v78, s[4:7], s87 offen offset:1152 sc1
    buffer_load_dword v242, v78, s[4:7], s87 offen offset:1536 sc1
    buffer_load_dword v243, v78, s[4:7], s87 offen offset:1920 sc1
    buffer_load_dword v244, v78, s[4:7], s87 offen offset:2304 sc1
    buffer_load_dword v245, v78, s[4:7], s87 offen offset:2688 sc1
    buffer_load_dword v246, v78, s[4:7], s87 offen offset:3072 sc1
    buffer_load_dword v247, v78, s[4:7], s87 offen offset:3456 sc1
    v_mov_b32 v48, 0x3f80
    v_mov_b32 v49, 0x3f800000
    v_lshlrev_b32 v40, 16, v192
    v_and_b32 v41, 0xffff0000, v192
    v_lshlrev_b32 v42, 16, v193
    v_and_b32 v43, 0xffff0000, v193
    v_lshlrev_b32 v44, 16, v194
    v_and_b32 v45, 0xffff0000, v194
    v_lshlrev_b32 v46, 16, v195
    v_and_b32 v47, 0xffff0000, v195
    v_dot2c_f32_bf16 v40, v196, v48
    v_dot2c_f32_bf16 v41, v196, v49
    v_dot2c_f32_bf16 v42, v197, v48
    v_dot2c_f32_bf16 v43, v197, v49
    v_dot2c_f32_bf16 v44, v198, v48
    v_dot2c_f32_bf16 v45, v198, v49
    v_dot2c_f32_bf16 v46, v199, v48
    v_dot2c_f32_bf16 v47, v199, v49
    v_dot2c_f32_bf16 v40, v200, v48
    v_dot2c_f32_bf16 v41, v200, v49
    v_dot2c_f32_bf16 v42, v201, v48
    v_dot2c_f32_bf16 v43, v201, v49
    v_dot2c_f32_bf16 v44, v202, v48
    v_dot2c_f32_bf16 v45, v202, v49
    v_dot2c_f32_bf16 v46, v203, v48
    v_dot2c_f32_bf16 v47, v203, v49
    v_dot2c_f32_bf16 v40, v204, v48
    v_dot2c_f32_bf16 v41, v204, v49
    v_dot2c_f32_bf16 v42, v205, v48
    v_dot2c_f32_bf16 v43, v205, v49
    v_dot2c_f32_bf16 v44, v206, v48
    v_dot2c_f32_bf16 v45, v206, v49
    v_dot2c_f32_bf16 v46, v207, v48
    v_dot2c_f32_bf16 v47, v207, v49
    v_dot2c_f32_bf16 v40, v208, v48
    v_dot2c_f32_bf16 v41, v208, v49
    v_dot2c_f32_bf16 v42, v209, v48
    v_dot2c_f32_bf16 v43, v209, v49
    v_dot2c_f32_bf16 v44, v210, v48
    v_dot2c_f32_bf16 v45, v210, v49
    v_dot2c_f32_bf16 v46, v211, v48
    v_dot2c_f32_bf16 v47, v211, v49
    v_dot2c_f32_bf16 v40, v212, v48
    v_dot2c_f32_bf16 v41, v212, v49
    v_dot2c_f32_bf16 v42, v213, v48
    v_dot2c_f32_bf16 v43, v213, v49
    v_dot2c_f32_bf16 v44, v214, v48
    v_dot2c_f32_bf16 v45, v214, v49
    v_dot2c_f32_bf16 v46, v215, v48
    v_dot2c_f32_bf16 v47, v215, v49
    v_dot2c_f32_bf16 v40, v216, v48
    v_dot2c_f32_bf16 v41, v216, v49
    v_dot2c_f32_bf16 v42, v217, v48
    v_dot2c_f32_bf16 v43, v217, v49
    v_dot2c_f32_bf16 v44, v218, v48
    v_dot2c_f32_bf16 v45, v218, v49
    v_dot2c_f32_bf16 v46, v219, v48
    v_dot2c_f32_bf16 v47, v219, v49
    v_dot2c_f32_bf16 v40, v220, v48
    v_dot2c_f32_bf16 v41, v220, v49
    v_dot2c_f32_bf16 v42, v221, v48
    v_dot2c_f32_bf16 v43, v221, v49
    v_dot2c_f32_bf16 v44, v222, v48
    v_dot2c_f32_bf16 v45, v222, v49
    v_dot2c_f32_bf16 v46, v223, v48
    v_dot2c_f32_bf16 v47, v223, v49
    v_permlane32_swap_b32 v40, v44
    v_permlane32_swap_b32 v41, v45
    v_permlane32_swap_b32 v42, v46
    v_permlane32_swap_b32 v43, v47
    v_pk_add_f32 v[40:41], v[40:41], v[44:45] op_sel:[0,0] op_sel_hi:[1,1]
    v_pk_add_f32 v[42:43], v[42:43], v[46:47] op_sel:[0,0] op_sel_hi:[1,1]
    s_mov_b32 exec_lo, 0x7ffffff
    s_mov_b32 exec_hi, 0x7ffffff
    ds_write_b128 v39, v[40:43]
    s_mov_b64 exec, -1
    s_waitcnt lgkmcnt(0)
    s_barrier
    v_mov_b32 v24, s50
    v_mov_b32 v25, 0
    s_mov_b64 exec, 1
    buffer_store_dword v24, v25, s[4:7], s92 offen sc1
    s_mov_b64 exec, -1
    ds_read_b128 v[96:99], v32
    ds_read_b128 v[100:103], v33
    ds_read_b128 v[104:107], v34
    ds_read_b128 v[108:111], v35
    ds_read_b128 v[80:83], v28
    ds_read_b128 v[84:87], v29
    ds_read_b128 v[88:91], v30
    ds_read_b128 v[92:95], v31
    s_waitcnt lgkmcnt(4)
    v_cvt_pk_bf16_f32 v120, v96, v97
    v_cvt_pk_bf16_f32 v121, v98, v99
    v_cvt_pk_bf16_f32 v122, v100, v101
    v_cvt_pk_bf16_f32 v123, v102, v103
    v_cvt_pk_bf16_f32 v124, v104, v105
    v_cvt_pk_bf16_f32 v125, v106, v107
    v_cvt_pk_bf16_f32 v126, v108, v109
    v_cvt_pk_bf16_f32 v127, v110, v111
    v_mfma_f32_16x16x32_bf16 v[196:199], v[120:123], v[144:147], 0
    s_nop 0
    v_mfma_f32_16x16x32_bf16 v[204:207], v[124:127], v[146:149], 0
    v_mfma_f32_16x16x32_bf16 v[212:215], v[120:123], v[150:153], 0
    v_mfma_f32_16x16x32_bf16 v[220:223], v[124:127], v[152:155], 0
    s_waitcnt lgkmcnt(0)
    v_cvt_pk_bf16_f32 v112, v80, v81
    v_cvt_pk_bf16_f32 v113, v82, v83
    v_cvt_pk_bf16_f32 v114, v84, v85
    v_cvt_pk_bf16_f32 v115, v86, v87
    v_cvt_pk_bf16_f32 v116, v88, v89
    v_cvt_pk_bf16_f32 v117, v90, v91
    v_cvt_pk_bf16_f32 v118, v92, v93
    v_cvt_pk_bf16_f32 v119, v94, v95
    v_mfma_f32_16x16x32_bf16 v[192:195], v[112:115], v[144:147], 0
    s_nop 0
    v_mfma_f32_16x16x32_bf16 v[200:203], v[116:119], v[146:149], 0
    v_mfma_f32_16x16x32_bf16 v[208:211], v[112:115], v[150:153], 0
    v_mfma_f32_16x16x32_bf16 v[216:219], v[116:119], v[152:155], 0
    v_add_f32 v197, v19, v197
    v_add_f32 v205, v19, v205
    v_add_f32 v213, v19, v213
    v_add_f32 v221, v19, v221
    v_rcp_f32 v197, v197
    v_rcp_f32 v205, v205
    v_rcp_f32 v213, v213
    v_rcp_f32 v221, v221
    v_pk_mul_f32 v[192:193], v[192:193], v[196:197] op_sel:[0,1] op_sel_hi:[1,1]
    v_pk_mul_f32 v[194:195], v[194:195], v[196:197] op_sel:[0,1] op_sel_hi:[1,1]
    v_mul_f32 v196, v196, v197
    v_pk_mul_f32 v[200:201], v[200:201], v[204:205] op_sel:[0,1] op_sel_hi:[1,1]
    v_pk_mul_f32 v[202:203], v[202:203], v[204:205] op_sel:[0,1] op_sel_hi:[1,1]
    v_mul_f32 v204, v204, v205
    v_cvt_pk_bf16_f32 v40, v192, v193
    v_cvt_pk_bf16_f32 v41, v194, v195
    v_cvt_pk_bf16_f32 v42, v196, v200
    v_cvt_pk_bf16_f32 v43, v201, v202
    v_cvt_pk_bf16_f32 v44, v203, v204
    s_add_u32 s60, s62, 0
    s_cmp_eq_u32 s47, 0
    s_cbranch_scc1 Lsfast_17
    buffer_store_dwordx4 v[40:43], v26, s[4:7], s60 offen sc1
    buffer_store_dword v44, v27, s[4:7], s60 offen sc1
    s_branch Lsdone_18
Lsfast_17:
    buffer_store_dwordx4 v[40:43], v26, s[4:7], s60 offen
    buffer_store_dword v44, v27, s[4:7], s60 offen
Lsdone_18:
    v_pk_mul_f32 v[208:209], v[208:209], v[212:213] op_sel:[0,1] op_sel_hi:[1,1]
    v_pk_mul_f32 v[210:211], v[210:211], v[212:213] op_sel:[0,1] op_sel_hi:[1,1]
    v_mul_f32 v212, v212, v213
    v_pk_mul_f32 v[216:217], v[216:217], v[220:221] op_sel:[0,1] op_sel_hi:[1,1]
    v_pk_mul_f32 v[218:219], v[218:219], v[220:221] op_sel:[0,1] op_sel_hi:[1,1]
    v_mul_f32 v220, v220, v221
    v_cvt_pk_bf16_f32 v46, v208, v209
    v_cvt_pk_bf16_f32 v47, v210, v211
    v_cvt_pk_bf16_f32 v48, v212, v216
    v_cvt_pk_bf16_f32 v49, v217, v218
    v_cvt_pk_bf16_f32 v50, v219, v220
    s_add_u32 s60, s62, 24576
    s_cmp_eq_u32 s47, 0
    s_cbranch_scc1 Lsfast_19
    buffer_store_dwordx4 v[46:49], v26, s[4:7], s60 offen sc1
    buffer_store_dword v50, v27, s[4:7], s60 offen sc1
    s_branch Lsdone_20
Lsfast_19:
    buffer_store_dwordx4 v[46:49], v26, s[4:7], s60 offen
    buffer_store_dword v50, v27, s[4:7], s60 offen
Lsdone_20:
    s_add_u32 s80, s95, 73728
    s_add_u32 m0, s81, 147456
    s_nop 0
    buffer_load_dwordx4 v1, s[4:7], s80 offen sc1 lds
    s_add_u32 s80, s95, 77824
    s_add_u32 m0, s81, 151552
    s_nop 0
    buffer_load_dwordx4 v1, s[4:7], s80 offen sc1 lds
    s_add_u32 s80, s95, 81920
    s_add_u32 m0, s81, 0
    s_nop 0
    buffer_load_dwordx4 v1, s[4:7], s80 offen sc1 lds
    s_add_u32 s80, s95, 86016
    s_add_u32 m0, s81, 4096
    s_nop 0
    buffer_load_dwordx4 v1, s[4:7], s80 offen sc1 lds
    s_add_u32 s80, s95, 90112
    s_add_u32 m0, s81, 8192
    s_nop 0
    buffer_load_dwordx4 v1, s[4:7], s80 offen sc1 lds
    s_add_u32 s80, s95, 94208
    s_add_u32 m0, s81, 12288
    s_nop 0
    buffer_load_dwordx4 v1, s[4:7], s80 offen sc1 lds
    s_waitcnt vmcnt(6)
    v_mov_b32 v24, s50
    v_mov_b32 v25, 0
    s_mov_b64 exec, 1
    s_cmp_eq_u32 s47, 0
    s_cbranch_scc1 Lsfast_21
    buffer_store_dword v24, v25, s[4:7], s63 offen sc1
    s_branch Lsdone_22
Lsfast_21:
    buffer_store_dword v24, v25, s[4:7], s63 offen
Lsdone_22:
    s_mov_b64 exec, -1
    v_add_f32 v228, v228, v238
    v_add_f32 v229, v229, v239
    v_add_f32 v230, v230, v240
    v_add_f32 v231, v231, v241
    v_add_f32 v232, v232, v242
    v_add_f32 v233, v233, v243
    v_add_f32 v234, v234, v244
    v_add_f32 v235, v235, v245
    v_add_f32 v236, v236, v246
    v_add_f32 v237, v237, v247
    v_add_f32 v228, v228, v233
    v_add_f32 v229, v229, v234
    v_add_f32 v230, v230, v235
    v_add_f32 v231, v231, v236
    v_add_f32 v232, v232, v237
    v_add_f32 v228, v228, v229
    v_add_f32 v230, v230, v231
    v_add_f32 v228, v228, v232
    v_add_f32 v228, v228, v230
    v_add_u32 v76, 157440, v76
    s_mov_b64 exec, s[84:85]
    ds_write_b32 v76, v228
    s_mov_b64 exec, -1
    s_waitcnt lgkmcnt(0)
    s_add_u32 s80, s95, 98304
    s_add_u32 m0, s81, 16384
    s_nop 0
    buffer_load_dwordx4 v1, s[4:7], s80 offen sc1 lds
    s_add_u32 s80, s96, 0
    s_add_u32 m0, s81, 20480
    s_nop 0
    buffer_load_dwordx4 v1, s[4:7], s80 offen sc1 lds
    s_add_u32 s80, s96, 4096
    s_add_u32 m0, s81, 24576
    s_nop 0
    buffer_load_dwordx4 v1, s[4:7], s80 offen sc1 lds
    s_add_u32 s80, s96, 8192
    s_add_u32 m0, s81, 28672
    s_nop 0
    buffer_load_dwordx4 v1, s[4:7], s80 offen sc1 lds
    s_add_u32 s80, s96, 12288
    s_add_u32 m0, s81, 32768
    s_nop 0
    buffer_load_dwordx4 v1, s[4:7], s80 offen sc1 lds
    s_add_u32 s80, s96, 16384
    s_add_u32 m0, s81, 36864
    s_nop 0
    buffer_load_dwordx4 v1, s[4:7], s80 offen sc1 lds
    s_add_u32 s80, s96, 20480
    s_add_u32 m0, s81, 40960
    s_nop 0
    buffer_load_dwordx4 v1, s[4:7], s80 offen sc1 lds
LP2:
    s_lshl_b32 s66, s45, 2
    s_add_u32 s66, s66, s55
    s_lshl_b32 s66, s66, 1
    s_lshr_b32 s60, s44, 1
    s_add_u32 s66, s66, s60
    s_lshl_b32 s63, s66, 6
    s_add_u32 s63, s63, 0
    v_lshlrev_b32 v26, 2, v15
    s_mul_i32 s64, s58, 24576
    s_add_u32 s64, s64, s49
    s_add_u32 s64, s64, 14901248
    v_lshlrev_b32 v40, 16, v4
    v_and_b32 v41, 0xffff0000, v4
    v_lshlrev_b32 v42, 16, v5
    v_and_b32 v43, 0xffff0000, v5
    v_lshlrev_b32 v44, 16, v6
    v_and_b32 v45, 0xffff0000, v6
    v_lshlrev_b32 v46, 16, v7
    v_and_b32 v47, 0xffff0000, v7
    v_lshlrev_b32 v48, 16, v8
    v_and_b32 v49, 0xffff0000, v8
    v_lshlrev_b32 v50, 16, v9
    v_and_b32 v51, 0xffff0000, v9
    v_lshlrev_b32 v52, 16, v10
    v_and_b32 v53, 0xffff0000, v10
    v_lshlrev_b32 v54, 16, v11
    v_and_b32 v55, 0xffff0000, v11
    v_lshlrev_b32 v56, 16, v12
    v_and_b32 v57, 0xffff0000, v12
    v_lshlrev_b32 v58, 16, v13
    v_and_b32 v59, 0xffff0000, v13
    s_lshr_b32 s67, s58, 1
    s_mul_i32 s67, s67, 40960
    v_bfe_u32 v29, v23, 2, 1
    v_lshlrev_b32 v29, 10, v29
    v_lshrrev_b32 v30, 3, v23
    v_lshl_add_u32 v29, v30, 6, v29
    v_and_b32 v30, 3, v23
    v_lshl_add_u32 v29, v30, 4, v29
    s_and_b32 s60, s44, 1
    s_lshl_b32 s60, s60, 7
    v_add_u32 v29, s60, v29
    v_and_b32 v30, 0xfc00, v20
    v_and_b32 v27, 0x300, v20
    v_lshl_add_u32 v27, v30, 1, v27
    v_add_u32 v27, v27, v29
    v_and_b32 v30, 0xfc00, v21
    v_and_b32 v28, 0x308, v21
    v_lshl_add_u32 v28, v30, 1, v28
    v_add_u32 v28, v28, v29
    s_add_u32 s67, s67, s49
    s_add_u32 s67, s67, 0
    s_lshl_b32 s68, s58, 10
    s_lshl_b32 s61, s56, 7
    s_add_u32 s68, s68, s61
    s_add_u32 s68, s68, s49
    s_add_u32 s68, s68, 7954432
    s_lshl_b32 s69, s66, 3
    s_add_u32 s69, s69, s56
    s_lshl_b32 s69, s69, 1
    s_and_b32 s60, s44, 1
    s_add_u32 s69, s69, s60
    s_lshl_b32 s69, s69, 2
    s_add_u32 s69, s69, 4096
    v_lshlrev_b32 v29, 2, v23
    s_mov_b64 exec, 0xffff
    s_mov_b32 s82, 0
Lpoll_23:
    buffer_load_dword v24, v26, s[4:7], s63 offen sc1
    s_add_u32 s82, s82, 1
    s_waitcnt vmcnt(0)
    v_cmp_eq_u32 vcc, s50, v24
    s_cmp_eq_u64 vcc, exec
    s_cbranch_scc1 Lpdone_24
    s_cmp_lt_u32 s82, 200000
    s_cbranch_scc1 Lpoll_23
    s_branch LEND
Lpdone_24:
    s_mov_b64 exec, -1
    s_add_u32 s84, s64, 0
    buffer_load_dwordx4 a[0:3], v1, s[4:7], s84 offen offset:0 sc1
    buffer_load_dwordx4 a[4:7], v1, s[4:7], s84 offen offset:1024 sc1
    buffer_load_dwordx4 a[8:11], v1, s[4:7], s84 offen offset:2048 sc1
    buffer_load_dwordx4 a[12:15], v1, s[4:7], s84 offen offset:3072 sc1
    s_add_u32 s85, s64, 4096
    buffer_load_dwordx4 a[16:19], v1, s[4:7], s85 offen offset:0 sc1
    buffer_load_dwordx4 a[20:23], v1, s[4:7], s85 offen offset:1024 sc1
    buffer_load_dwordx4 a[24:27], v1, s[4:7], s85 offen offset:2048 sc1
    buffer_load_dwordx4 a[28:31], v1, s[4:7], s85 offen offset:3072 sc1
    s_barrier
    ds_read_b128 v[104:107], v2 offset:8192
    ds_read_b128 v[108:111], v2 offset:9216
    ds_read_b128 v[112:115], v2 offset:10240
    ds_read_b128 v[116:119], v2 offset:11264
    ds_read_b128 v[120:123], v2 offset:12288
    ds_read_b128 v[124:127], v2 offset:13312
    ds_read_b128 v[128:131], v2 offset:14336
    ds_read_b128 v[132:135], v2 offset:15360
    ds_read_b128 v[136:139], v2 offset:16384
    ds_read_b128 v[140:143], v2 offset:17408
    ds_read_b128 v[144:147], v2 offset:18432
    ds_read_b128 v[148:151], v2 offset:19456
    ds_read_b128 v[152:155], v2 offset:20480
    s_waitcnt vmcnt(7) lgkmcnt(8)
    v_mfma_f32_16x16x32_bf16 v[40:43], v[104:107], a[0:3], v[40:43]
    ds_read_b128 v[156:159], v2 offset:21504
    v_mfma_f32_16x16x32_bf16 v[44:47], v[108:111], a[0:3], v[44:47]
    ds_read_b128 v[104:107], v2 offset:22528
    s_add_u32 s86, s64, 8192
    buffer_load_dwordx4 a[32:35], v1, s[4:7], s86 offen offset:0 sc1
    v_mfma_f32_16x16x32_bf16 v[48:51], v[112:115], a[0:3], v[48:51]
    ds_read_b128 v[108:111], v2 offset:23552
    v_mfma_f32_16x16x32_bf16 v[52:55], v[116:119], a[0:3], v[52:55]
    ds_read_b128 v[112:115], v2 offset:24576
    v_mfma_f32_16x16x32_bf16 v[56:59], v[120:123], a[0:3], v[56:59]
    ds_read_b128 v[116:119], v2 offset:25600
    s_waitcnt vmcnt(7) lgkmcnt(8)
    v_mfma_f32_16x16x32_bf16 v[40:43], v[124:127], a[4:7], v[40:43]
    ds_read_b128 v[120:123], v2 offset:26624
    v_mfma_f32_16x16x32_bf16 v[44:47], v[128:131], a[4:7], v[44:47]
    ds_read_b128 v[124:127], v2 offset:27648
    buffer_load_dwordx4 a[36:39], v1, s[4:7], s86 offen offset:1024 sc1
    v_mfma_f32_16x16x32_bf16 v[48:51], v[132:135], a[4:7], v[48:51]
    ds_read_b128 v[128:131], v2 offset:28672
    v_mfma_f32_16x16x32_bf16 v[52:55], v[136:139], a[4:7], v[52:55]
    ds_read_b128 v[132:135], v2 offset:29696
    v_mfma_f32_16x16x32_bf16 v[56:59], v[140:143], a[4:7], v[56:59]
    ds_read_b128 v[136:139], v2 offset:30720
    s_waitcnt vmcnt(7) lgkmcnt(8)
    v_mfma_f32_16x16x32_bf16 v[40:43], v[144:147], a[8:11], v[40:43]
    ds_read_b128 v[140:143], v2 offset:31744
    v_mfma_f32_16x16x32_bf16 v[44:47], v[148:151], a[8:11], v[44:47]
    ds_read_b128 v[144:147], v2 offset:32768
    buffer_load_dwordx4 a[40:43], v1, s[4:7], s86 offen offset:2048 sc1
    v_mfma_f32_16x16x32_bf16 v[48:51], v[152:155], a[8:11], v[48:51]
    ds_read_b128 v[148:151], v2 offset:33792
    v_mfma_f32_16x16x32_bf16 v[52:55], v[156:159], a[8:11], v[52:55]
    ds_read_b128 v[152:155], v2 offset:34816
    v_mfma_f32_16x16x32_bf16 v[56:59], v[104:107], a[8:11], v[56:59]
    ds_read_b128 v[156:159], v2 offset:35840
    s_waitcnt vmcnt(7) lgkmcnt(8)
    v_mfma_f32_16x16x32_bf16 v[40:43], v[108:111], a[12:15], v[40:43]
    ds_read_b128 v[104:107], v2 offset:36864
    v_mfma_f32_16x16x32_bf16 v[44:47], v[112:115], a[12:15], v[44:47]
    ds_read_b128 v[108:111], v2 offset:37888
    buffer_load_dwordx4 a[44:47], v1, s[4:7], s86 offen offset:3072 sc1
    v_mfma_f32_16x16x32_bf16 v[48:51], v[116:119], a[12:15], v[48:51]
    ds_read_b128 v[112:115], v2 offset:38912
    v_mfma_f32_16x16x32_bf16 v[52:55], v[120:123], a[12:15], v[52:55]
    ds_read_b128 v[116:119], v2 offset:39936
    v_mfma_f32_16x16x32_bf16 v[56:59], v[124:127], a[12:15], v[56:59]
    ds_read_b128 v[120:123], v2 offset:40960
    s_waitcnt vmcnt(7) lgkmcnt(8)
    v_mfma_f32_16x16x32_bf16 v[40:43], v[128:131], a[16:19], v[40:43]
    ds_read_b128 v[124:127], v2 offset:41984
    v_mfma_f32_16x16x32_bf16 v[44:47], v[132:135], a[16:19], v[44:47]
    ds_read_b128 v[128:131], v2 offset:43008
    s_add_u32 s87, s64, 12288
    buffer_load_dwordx4 a[48:51], v1, s[4:7], s87 offen offset:0 sc1
    v_mfma_f32_16x16x32_bf16 v[48:51], v[136:139], a[16:19], v[48:51]
    ds_read_b128 v[132:135], v2 offset:44032
    v_mfma_f32_16x16x32_bf16 v[52:55], v[140:143], a[16:19], v[52:55]
    ds_read_b128 v[136:139], v2 offset:45056
    v_mfma_f32_16x16x32_bf16 v[56:59], v[144:147], a[16:19], v[56:59]
    ds_read_b128 v[140:143], v2 offset:46080
    s_waitcnt vmcnt(7) lgkmcnt(8)
    v_mfma_f32_16x16x32_bf16 v[40:43], v[148:151], a[20:23], v[40:43]
    ds_read_b128 v[144:147], v2 offset:47104
    v_mfma_f32_16x16x32_bf16 v[44:47], v[152:155], a[20:23], v[44:47]
    ds_read_b128 v[148:151], v2 offset:48128
    buffer_load_dwordx4 a[52:55], v1, s[4:7], s87 offen offset:1024 sc1
    v_mfma_f32_16x16x32_bf16 v[48:51], v[156:159], a[20:23], v[48:51]
    ds_read_b128 v[152:155], v2 offset:49152
    v_mfma_f32_16x16x32_bf16 v[52:55], v[104:107], a[20:23], v[52:55]
    ds_read_b128 v[156:159], v2 offset:50176
    v_mfma_f32_16x16x32_bf16 v[56:59], v[108:111], a[20:23], v[56:59]
    ds_read_b128 v[104:107], v2 offset:51200
    s_waitcnt vmcnt(7) lgkmcnt(8)
    v_mfma_f32_16x16x32_bf16 v[40:43], v[112:115], a[24:27], v[40:43]
    ds_read_b128 v[108:111], v2 offset:52224
    v_mfma_f32_16x16x32_bf16 v[44:47], v[116:119], a[24:27], v[44:47]
    ds_read_b128 v[112:115], v2 offset:53248
    buffer_load_dwordx4 a[56:59], v1, s[4:7], s87 offen offset:2048 sc1
    v_mfma_f32_16x16x32_bf16 v[48:51], v[120:123], a[24:27], v[48:51]
    ds_read_b128 v[116:119], v2 offset:54272
    v_mfma_f32_16x16x32_bf16 v[52:55], v[124:127], a[24:27], v[52:55]
    ds_read_b128 v[120:123], v2 offset:55296
    v_mfma_f32_16x16x32_bf16 v[56:59], v[128:131], a[24:27], v[56:59]
    ds_read_b128 v[124:127], v2 offset:56320
    s_waitcnt vmcnt(7) lgkmcnt(8)
    v_mfma_f32_16x16x32_bf16 v[40:43], v[132:135], a[28:31], v[40:43]
    ds_read_b128 v[128:131], v2 offset:57344
    v_mfma_f32_16x16x32_bf16 v[44:47], v[136:139], a[28:31], v[44:47]
    ds_read_b128 v[132:135], v2 offset:58368
    buffer_load_dwordx4 a[60:63], v1, s[4:7], s87 offen offset:3072 sc1
    v_mfma_f32_16x16x32_bf16 v[48:51], v[140:143], a[28:31], v[48:51]
    ds_read_b128 v[136:139], v2 offset:59392
    v_mfma_f32_16x16x32_bf16 v[52:55], v[144:147], a[28:31], v[52:55]
    ds_read_b128 v[140:143], v2 offset:60416
    v_mfma_f32_16x16x32_bf16 v[56:59], v[148:151], a[28:31], v[56:59]
    ds_read_b128 v[144:147], v2 offset:61440
    s_waitcnt vmcnt(7) lgkmcnt(8)
    v_mfma_f32_16x16x32_bf16 v[40:43], v[152:155], a[32:35], v[40:43]
    ds_read_b128 v[148:151], v2 offset:62464
    v_mfma_f32_16x16x32_bf16 v[44:47], v[156:159], a[32:35], v[44:47]
    ds_read_b128 v[152:155], v2 offset:63488
    s_add_u32 s84, s64, 16384
    buffer_load_dwordx4 a[64:67], v1, s[4:7], s84 offen offset:0 sc1
    v_mfma_f32_16x16x32_bf16 v[48:51], v[104:107], a[32:35], v[48:51]
    ds_read_b128 v[156:159], v2 offset:64512
    v_mfma_f32_16x16x32_bf16 v[52:55], v[108:111], a[32:35], v[52:55]
    ds_read_b128 v[104:107], v3 offset:0
    v_mfma_f32_16x16x32_bf16 v[56:59], v[112:115], a[32:35], v[56:59]
    ds_read_b128 v[108:111], v3 offset:1024
    s_waitcnt vmcnt(7) lgkmcnt(8)
    v_mfma_f32_16x16x32_bf16 v[40:43], v[116:119], a[36:39], v[40:43]
    ds_read_b128 v[112:115], v3 offset:2048
    v_mfma_f32_16x16x32_bf16 v[44:47], v[120:123], a[36:39], v[44:47]
    ds_read_b128 v[116:119], v3 offset:3072
    buffer_load_dwordx4 a[68:71], v1, s[4:7], s84 offen offset:1024 sc1
    v_mfma_f32_16x16x32_bf16 v[48:51], v[124:127], a[36:39], v[48:51]
    ds_read_b128 v[120:123], v3 offset:4096
    v_mfma_f32_16x16x32_bf16 v[52:55], v[128:131], a[36:39], v[52:55]
    ds_read_b128 v[124:127], v3 offset:5120
    v_mfma_f32_16x16x32_bf16 v[56:59], v[132:135], a[36:39], v[56:59]
    ds_read_b128 v[128:131], v3 offset:6144
    s_waitcnt vmcnt(7) lgkmcnt(8)
    v_mfma_f32_16x16x32_bf16 v[40:43], v[136:139], a[40:43], v[40:43]
    ds_read_b128 v[132:135], v3 offset:7168
    v_mfma_f32_16x16x32_bf16 v[44:47], v[140:143], a[40:43], v[44:47]
    ds_read_b128 v[136:139], v3 offset:8192
    buffer_load_dwordx4 a[72:75], v1, s[4:7], s84 offen offset:2048 sc1
    v_mfma_f32_16x16x32_bf16 v[48:51], v[144:147], a[40:43], v[48:51]
    ds_read_b128 v[140:143], v3 offset:9216
    v_mfma_f32_16x16x32_bf16 v[52:55], v[148:151], a[40:43], v[52:55]
    ds_read_b128 v[144:147], v3 offset:10240
    v_mfma_f32_16x16x32_bf16 v[56:59], v[152:155], a[40:43], v[56:59]
    ds_read_b128 v[148:151], v3 offset:11264
    s_waitcnt vmcnt(7) lgkmcnt(8)
    v_mfma_f32_16x16x32_bf16 v[40:43], v[156:159], a[44:47], v[40:43]
    ds_read_b128 v[152:155], v3 offset:12288
    v_mfma_f32_16x16x32_bf16 v[44:47], v[104:107], a[44:47], v[44:47]
    ds_read_b128 v[156:159], v3 offset:13312
    buffer_load_dwordx4 a[76:79], v1, s[4:7], s84 offen offset:3072 sc1
    v_mfma_f32_16x16x32_bf16 v[48:51], v[108:111], a[44:47], v[48:51]
    ds_read_b128 v[104:107], v3 offset:14336
    v_mfma_f32_16x16x32_bf16 v[52:55], v[112:115], a[44:47], v[52:55]
    ds_read_b128 v[108:111], v3 offset:15360
    s_mov_b32 exec_lo, 0x01110111
    s_mov_b32 exec_hi, 0x01110111
    buffer_load_dword v31, v27, s[36:39], s67 offen sc1
    buffer_load_dword v31, v27, s[36:39], s67 offen offset:2048 sc1
    buffer_load_dword v31, v28, s[36:39], s67 offen sc1
    buffer_load_dword v31, v29, s[4:7], s68 offen sc1
    s_mov_b64 exec, -1
    v_mfma_f32_16x16x32_bf16 v[56:59], v[116:119], a[44:47], v[56:59]
    ds_read_b128 v[112:115], v3 offset:16384
    s_waitcnt vmcnt(11) lgkmcnt(8)
    v_mfma_f32_16x16x32_bf16 v[40:43], v[120:123], a[48:51], v[40:43]
    ds_read_b128 v[116:119], v3 offset:17408
    v_mfma_f32_16x16x32_bf16 v[44:47], v[124:127], a[48:51], v[44:47]
    ds_read_b128 v[120:123], v3 offset:18432
    v_mfma_f32_16x16x32_bf16 v[48:51], v[128:131], a[48:51], v[48:51]
    ds_read_b128 v[124:127], v3 offset:19456
    v_mfma_f32_16x16x32_bf16 v[52:55], v[132:135], a[48:51], v[52:55]
    ds_read_b128 v[128:131], v3 offset:20480
    v_mfma_f32_16x16x32_bf16 v[56:59], v[136:139], a[48:51], v[56:59]
    ds_read_b128 v[132:135], v3 offset:21504
    s_waitcnt vmcnt(10) lgkmcnt(8)
    v_mfma_f32_16x16x32_bf16 v[40:43], v[140:143], a[52:55], v[40:43]
    ds_read_b128 v[136:139], v3 offset:22528
    v_mfma_f32_16x16x32_bf16 v[44:47], v[144:147], a[52:55], v[44:47]
    ds_read_b128 v[140:143], v3 offset:23552
    s_add_u32 s80, s96, 24576
    s_add_u32 m0, s81, 45056
    s_nop 0
    buffer_load_dwordx4 v1, s[4:7], s80 offen sc1 lds
    v_mfma_f32_16x16x32_bf16 v[48:51], v[148:151], a[52:55], v[48:51]
    ds_read_b128 v[144:147], v1 offset:0
    v_mfma_f32_16x16x32_bf16 v[52:55], v[152:155], a[52:55], v[52:55]
    ds_read_b128 v[148:151], v1 offset:1024
    v_mfma_f32_16x16x32_bf16 v[56:59], v[156:159], a[52:55], v[56:59]
    ds_read_b128 v[152:155], v1 offset:2048
    s_waitcnt vmcnt(10) lgkmcnt(8)
    v_mfma_f32_16x16x32_bf16 v[40:43], v[104:107], a[56:59], v[40:43]
    ds_read_b128 v[156:159], v1 offset:3072
    s_add_u32 s80, s96, 28672
    s_add_u32 m0, s81, 49152
    v_mfma_f32_16x16x32_bf16 v[44:47], v[108:111], a[56:59], v[44:47]
    ds_read_b128 v[104:107], v1 offset:4096
    buffer_load_dwordx4 v1, s[4:7], s80 offen sc1 lds
    v_mfma_f32_16x16x32_bf16 v[48:51], v[112:115], a[56:59], v[48:51]
    ds_read_b128 v[108:111], v1 offset:5120
    v_mfma_f32_16x16x32_bf16 v[52:55], v[116:119], a[56:59], v[52:55]
    ds_read_b128 v[112:115], v1 offset:6144
    v_mfma_f32_16x16x32_bf16 v[56:59], v[120:123], a[56:59], v[56:59]
    ds_read_b128 v[116:119], v1 offset:7168
    s_add_u32 s80, s96, 32768
    s_add_u32 m0, s81, 53248
    s_waitcnt vmcnt(10) lgkmcnt(8)
    v_mfma_f32_16x16x32_bf16 v[40:43], v[124:127], a[60:63], v[40:43]
    ds_read_b128 v[120:123], v1 offset:8192
    buffer_load_dwordx4 v1, s[4:7], s80 offen sc1 lds
    v_mfma_f32_16x16x32_bf16 v[44:47], v[128:131], a[60:63], v[44:47]
    ds_read_b128 v[124:127], v1 offset:9216
    v_mfma_f32_16x16x32_bf16 v[48:51], v[132:135], a[60:63], v[48:51]
    ds_read_b128 v[128:131], v1 offset:10240
    v_mfma_f32_16x16x32_bf16 v[52:55], v[136:139], a[60:63], v[52:55]
    ds_read_b128 v[132:135], v1 offset:11264
    s_add_u32 s80, s96, 36864
    s_add_u32 m0, s81, 57344
    s_nop 0
    buffer_load_dwordx4 v1, s[4:7], s80 offen sc1 lds
    v_mfma_f32_16x16x32_bf16 v[56:59], v[140:143], a[60:63], v[56:59]
    ds_read_b128 v[136:139], v1 offset:12288
    s_waitcnt vmcnt(11) lgkmcnt(8)
    v_mfma_f32_16x16x32_bf16 v[40:43], v[144:147], a[64:67], v[40:43]
    ds_read_b128 v[140:143], v1 offset:13312
    v_mfma_f32_16x16x32_bf16 v[44:47], v[148:151], a[64:67], v[44:47]
    ds_read_b128 v[144:147], v1 offset:14336
    v_mfma_f32_16x16x32_bf16 v[48:51], v[152:155], a[64:67], v[48:51]
    ds_read_b128 v[148:151], v1 offset:15360
    s_add_u32 s80, s96, 40960
    s_add_u32 m0, s81, 61440
    s_nop 0
    buffer_load_dwordx4 v1, s[4:7], s80 offen sc1 lds
    v_mfma_f32_16x16x32_bf16 v[52:55], v[156:159], a[64:67], v[52:55]
    ds_read_b128 v[152:155], v1 offset:16384
    v_mfma_f32_16x16x32_bf16 v[56:59], v[104:107], a[64:67], v[56:59]
    ds_read_b128 v[156:159], v1 offset:17408
    s_waitcnt vmcnt(11) lgkmcnt(8)
    v_mfma_f32_16x16x32_bf16 v[40:43], v[108:111], a[68:71], v[40:43]
    ds_read_b128 v[104:107], v1 offset:18432
    v_mfma_f32_16x16x32_bf16 v[44:47], v[112:115], a[68:71], v[44:47]
    ds_read_b128 v[108:111], v1 offset:19456
    s_add_u32 s80, s96, 45056
    s_add_u32 m0, s81, 65536
    s_nop 0
    buffer_load_dwordx4 v1, s[4:7], s80 offen sc1 lds
    v_mfma_f32_16x16x32_bf16 v[48:51], v[116:119], a[68:71], v[48:51]
    v_mfma_f32_16x16x32_bf16 v[52:55], v[120:123], a[68:71], v[52:55]
    v_mfma_f32_16x16x32_bf16 v[56:59], v[124:127], a[68:71], v[56:59]
    s_waitcnt vmcnt(11) lgkmcnt(5)
    v_mfma_f32_16x16x32_bf16 v[40:43], v[128:131], a[72:75], v[40:43]
    s_add_u32 s80, s96, 49152
    s_add_u32 m0, s81, 69632
    s_nop 0
    buffer_load_dwordx4 v1, s[4:7], s80 offen sc1 lds
    v_mfma_f32_16x16x32_bf16 v[44:47], v[132:135], a[72:75], v[44:47]
    v_mfma_f32_16x16x32_bf16 v[48:51], v[136:139], a[72:75], v[48:51]
    v_mfma_f32_16x16x32_bf16 v[52:55], v[140:143], a[72:75], v[52:55]
    v_mfma_f32_16x16x32_bf16 v[56:59], v[144:147], a[72:75], v[56:59]
    s_waitcnt vmcnt(11) lgkmcnt(0)
    v_mfma_f32_16x16x32_bf16 v[40:43], v[148:151], a[76:79], v[40:43]
    v_mfma_f32_16x16x32_bf16 v[44:47], v[152:155], a[76:79], v[44:47]
    v_mfma_f32_16x16x32_bf16 v[48:51], v[156:159], a[76:79], v[48:51]
    v_mfma_f32_16x16x32_bf16 v[52:55], v[104:107], a[76:79], v[52:55]
    v_mfma_f32_16x16x32_bf16 v[56:59], v[108:111], a[76:79], v[56:59]
    s_cmp_eq_u32 s48, 0
    s_cbranch_scc0 Ll0_25
Ll0_25:
    s_nop 1
    v_cvt_pk_bf16_f32 v4, v40, v41
    v_cvt_pk_bf16_f32 v5, v42, v43
    v_cvt_pk_bf16_f32 v6, v44, v45
    v_cvt_pk_bf16_f32 v7, v46, v47
    v_cvt_pk_bf16_f32 v8, v48, v49
    v_cvt_pk_bf16_f32 v9, v50, v51
    v_cvt_pk_bf16_f32 v10, v52, v53
    v_cvt_pk_bf16_f32 v11, v54, v55
    v_cvt_pk_bf16_f32 v12, v56, v57
    v_cvt_pk_bf16_f32 v13, v58, v59
    s_cmp_eq_u32 s47, 0
    s_cbranch_scc1 Lsfast_26
    buffer_store_dwordx4 v[4:7], v27, s[36:39], s67 offen sc1
    buffer_store_dwordx4 v[8:11], v27, s[36:39], s67 offen offset:2048 sc1
    buffer_store_dwordx2 v[12:13], v28, s[36:39], s67 offen sc1
    s_branch Lsdone_27
Lsfast_26:
    buffer_store_dwordx4 v[4:7], v27, s[36:39], s67 offen
    buffer_store_dwordx4 v[8:11], v27, s[36:39], s67 offen offset:2048
    buffer_store_dwordx2 v[12:13], v28, s[36:39], s67 offen
Lsdone_27:
    v_pk_mul_f32 v[62:63], v[40:41], v[40:41] op_sel:[0,0] op_sel_hi:[1,1]
    v_pk_mul_f32 v[64:65], v[42:43], v[42:43] op_sel:[0,0] op_sel_hi:[1,1]
    v_pk_add_f32 v[60:61], v[40:41], v[42:43] op_sel:[0,0] op_sel_hi:[1,1]
    v_pk_add_f32 v[66:67], v[44:45], v[46:47] op_sel:[0,0] op_sel_hi:[1,1]
    v_pk_fma_f32 v[62:63], v[44:45], v[44:45], v[62:63] op_sel:[0,0,0] op_sel_hi:[1,1,1]
    v_pk_fma_f32 v[64:65], v[46:47], v[46:47], v[64:65] op_sel:[0,0,0] op_sel_hi:[1,1,1]
    v_pk_fma_f32 v[62:63], v[48:49], v[48:49], v[62:63] op_sel:[0,0,0] op_sel_hi:[1,1,1]
    v_pk_add_f32 v[60:61], v[60:61], v[48:49] op_sel:[0,0] op_sel_hi:[1,1]
    v_pk_fma_f32 v[64:65], v[50:51], v[50:51], v[64:65] op_sel:[0,0,0] op_sel_hi:[1,1,1]
    v_pk_add_f32 v[66:67], v[66:67], v[50:51] op_sel:[0,0] op_sel_hi:[1,1]
    v_pk_fma_f32 v[62:63], v[52:53], v[52:53], v[62:63] op_sel:[0,0,0] op_sel_hi:[1,1,1]
    v_pk_add_f32 v[60:61], v[60:61], v[52:53] op_sel:[0,0] op_sel_hi:[1,1]
    v_pk_fma_f32 v[64:65], v[54:55], v[54:55], v[64:65] op_sel:[0,0,0] op_sel_hi:[1,1,1]
    v_pk_add_f32 v[66:67], v[66:67], v[54:55] op_sel:[0,0] op_sel_hi:[1,1]
    v_pk_fma_f32 v[62:63], v[56:57], v[56:57], v[62:63] op_sel:[0,0,0] op_sel_hi:[1,1,1]
    v_pk_add_f32 v[60:61], v[60:61], v[56:57] op_sel:[0,0] op_sel_hi:[1,1]
    v_pk_fma_f32 v[64:65], v[58:59], v[58:59], v[64:65] op_sel:[0,0,0] op_sel_hi:[1,1,1]
    v_pk_add_f32 v[66:67], v[66:67], v[58:59] op_sel:[0,0] op_sel_hi:[1,1]
    v_pk_add_f32 v[60:61], v[60:61], v[66:67] op_sel:[0,0] op_sel_hi:[1,1]
    v_pk_add_f32 v[62:63], v[62:63], v[64:65] op_sel:[0,0] op_sel_hi:[1,1]
    v_add_f32 v60, v60, v61
    v_add_f32 v62, v62, v63
    s_nop 1
    v_permlane16_swap_b32 v60, v62
    v_add_f32 v60, v60, v62
    v_mov_b32 v62, v60
    s_nop 1
    v_permlane32_swap_b32 v60, v62
    v_add_f32 v60, v60, v62
    s_mov_b32 exec_hi, 0
    s_cmp_eq_u32 s47, 0
    s_cbranch_scc1 Lsfast_28
    buffer_store_dword v60, v26, s[4:7], s68 offen sc1
    s_branch Lsdone_29
Lsfast_28:
    buffer_store_dword v60, v26, s[4:7], s68 offen
Lsdone_29:
    s_mov_b64 exec, -1
    s_barrier
    s_add_u32 s80, s96, 53248
    s_add_u32 m0, s81, 0
    s_nop 0
    buffer_load_dwordx4 v1, s[4:7], s80 offen sc1 lds
    s_add_u32 s80, s96, 57344
    s_add_u32 m0, s81, 4096
    s_nop 0
    buffer_load_dwordx4 v1, s[4:7], s80 offen sc1 lds
    s_add_u32 s80, s96, 61440
    s_add_u32 m0, s81, 94208
    s_nop 0
    buffer_load_dwordx4 v1, s[4:7], s80 offen sc1 lds
    s_add_u32 s80, s96, 65536
    s_add_u32 m0, s81, 98304
    s_nop 0
    buffer_load_dwordx4 v1, s[4:7], s80 offen sc1 lds
    s_add_u32 s80, s96, 69632
    s_add_u32 m0, s81, 102400
    s_nop 0
    buffer_load_dwordx4 v1, s[4:7], s80 offen sc1 lds
    s_add_u32 s80, s96, 73728
    s_add_u32 m0, s81, 106496
    s_nop 0
    buffer_load_dwordx4 v1, s[4:7], s80 offen sc1 lds
    s_waitcnt vmcnt(6)
    v_mov_b32 v24, s50
    v_mov_b32 v25, 0
    s_mov_b64 exec, 1
    s_cmp_eq_u32 s47, 0
    s_cbranch_scc1 Lsfast_30
    buffer_store_dword v24, v25, s[4:7], s69 offen sc1
    s_branch Lsdone_31
Lsfast_30:
    buffer_store_dword v24, v25, s[4:7], s69 offen
Lsdone_31:
    s_mov_b64 exec, -1
    s_add_u32 s80, s96, 77824
    s_add_u32 m0, s81, 110592
    s_nop 0
    buffer_load_dwordx4 v1, s[4:7], s80 offen sc1 lds
    s_add_u32 s80, s96, 81920
    s_add_u32 m0, s81, 114688
    s_nop 0
    buffer_load_dwordx4 v1, s[4:7], s80 offen sc1 lds
    s_add_u32 s80, s96, 86016
    s_add_u32 m0, s81, 118784
    s_nop 0
    buffer_load_dwordx4 v1, s[4:7], s80 offen sc1 lds
    s_add_u32 s80, s96, 90112
    s_add_u32 m0, s81, 122880
    s_nop 0
    buffer_load_dwordx4 v1, s[4:7], s80 offen sc1 lds
    s_waitcnt lgkmcnt(0)
    s_lshl_b32 s63, s45, 3
    s_lshl_b32 s60, s53, 2
    s_add_u32 s63, s63, s60
    s_add_u32 s63, s63, s44
    s_lshl_b32 s63, s63, 6
    s_add_u32 s63, s63, 4096
    v_lshlrev_b32 v26, 2, v15
    s_mul_i32 s64, s57, 20480
    s_add_u32 s64, s64, s49
    s_add_u32 s64, s64, 0
    v_add_u32 v26, 0, v22
    v_xor_b32 v26, v26, v23
    v_lshlrev_b32 v26, 4, v26
    v_lshl_add_u32 v100, v22, 12, v26
    v_add_u32 v26, 4, v22
    v_xor_b32 v26, v26, v23
    v_lshlrev_b32 v26, 4, v26
    v_lshl_add_u32 v101, v22, 12, v26
    v_add_u32 v26, 8, v22
    v_xor_b32 v26, v26, v23
    v_lshlrev_b32 v26, 4, v26
    v_lshl_add_u32 v102, v22, 12, v26
    v_add_u32 v26, 12, v22
    v_xor_b32 v26, v26, v23
    v_lshlrev_b32 v26, 4, v26
    v_lshl_add_u32 v103, v22, 12, v26
    s_lshl_b32 s67, s45, 2
    s_add_u32 s67, s67, s55
    s_lshl_b32 s67, s67, 1
    s_lshr_b32 s60, s44, 1
    s_add_u32 s68, s67, s60
    s_xor_b32 s69, s68, 1
    s_lshl_b32 s68, s68, 17
    s_lshl_b32 s69, s69, 17
    s_add_u32 s68, s68, s81
    s_add_u32 s69, s69, s81
    s_lshl_b32 s70, s44, 13
    s_cmp_eq_u32 s48, 0
    s_cselect_b32 s79, s68, s69
    s_mul_i32 s76, s55, 0
    v_xor_b32 v27, v22, v23
    v_lshlrev_b32 v27, 4, v27
    v_lshl_add_u32 v27, v23, 8, v27
    s_and_b32 s60, s44, 1
    s_lshl_b32 s60, s60, 12
    s_add_u32 s60, s60, s70
    v_add_u32 v152, s60, v27
    v_xor_b32 v153, 4096, v152
    v_xor_b32 v154, 64, v152
    v_xor_b32 v155, 4160, v152
    v_xor_b32 v156, 128, v152
    v_xor_b32 v157, 4224, v152
    v_xor_b32 v158, 192, v152
    v_xor_b32 v159, 4288, v152
    s_lshl_b32 s65, s44, 8
    s_add_u32 s65, s65, 155904
    v_lshrrev_b32 v27, 3, v23
    v_bfe_u32 v28, v23, 2, 1
    v_and_b32 v29, 3, v23
    v_lshl_add_u32 v29, v28, 3, v29
    v_lshlrev_b32 v38, 4, v29
    v_lshl_add_u32 v39, v27, 4, v29
    v_lshl_add_u32 v32, v22, 5, s65
    v_lshl_add_u32 v31, v39, 2, s65
    v_lshlrev_b32 v28, 2, v23
    v_add_u32 v28, 157440, v28
    v_lshlrev_b32 v29, 4, v22
    v_add_u32 v29, 157632, v29
    v_lshrrev_b32 v26, 3, v23
    v_lshlrev_b32 v26, 7, v26
    v_lshl_add_u32 v26, v22, 5, v26
    v_bfe_u32 v27, v23, 2, 1
    v_lshl_add_u32 v33, v27, 4, v26
    s_lshr_b32 s66, s57, 1
    s_lshl_b32 s66, s66, 12
    s_add_u32 s66, s66, s52
    s_add_u32 s66, s66, 950272
    s_lshl_b32 s71, s54, 8
    s_add_u32 s71, s71, s66
    v_lshrrev_b32 v97, 3, v23
    v_mul_u32_u24 v97, 24576, v97
    v_add_u32 v97, v97, v38
    s_mul_i32 s60, s54, 6
    v_add_u32 v96, s60, v22
    v_lshl_add_u32 v96, v96, 8, v97
    v_lshrrev_b32 v34, 1, v22
    v_add3_u32 v34, v34, s60, 4
    v_lshl_add_u32 v97, v34, 8, v97
    v_and_b32 v34, 1, v22
    v_lshl_add_u32 v97, v34, 3, v97
    s_mul_i32 s72, s57, 24576
    s_add_u32 s72, s72, s49
    s_add_u32 s72, s72, 14901248
    v_add_u32 v98, s65, v1
    s_lshr_b32 s61, s54, 1
    s_lshl_b32 s61, s61, 6
    s_lshr_b32 s62, s57, 1
    s_add_u32 s61, s61, s62
    s_lshl_b32 s61, s61, 1
    s_and_b32 s62, s54, 1
    s_add_u32 s61, s61, s62
    s_mul_i32 s73, s61, 3072
    s_add_u32 s73, s73, s49
    s_add_u32 s73, s73, 8085504
    s_lshr_b32 s78, s54, 1
    s_lshl_b32 s78, s78, 3
    s_add_u32 s78, s78, s45
    s_lshl_b32 s78, s78, 1
    s_add_u32 s78, s78, s53
    s_lshl_b32 s78, s78, 1
    s_and_b32 s60, s54, 1
    s_add_u32 s78, s78, s60
    s_lshl_b32 s78, s78, 5
    s_add_u32 s78, s78, 16384
    s_cmp_eq_u32 s44, 0
    s_cselect_b32 s78, s78, 0x40000000
    v_lshlrev_b32 v26, 2, v15
    s_lshl_b32 s62, s57, 10
    s_add_u32 s62, s62, s49
    s_add_u32 s62, s62, 7954432
    s_mov_b64 exec, 0xffff
    s_mov_b32 s82, 0
Lpoll_32:
    buffer_load_dword v24, v26, s[4:7], s63 offen sc1
    s_add_u32 s82, s82, 1
    s_waitcnt vmcnt(0)
    v_cmp_eq_u32 vcc, s50, v24
    s_cmp_eq_u64 vcc, exec
    s_cbranch_scc1 Lpdone_33
    s_cmp_lt_u32 s82, 200000
    s_cbranch_scc1 Lpoll_32
    s_branch LEND
Lpdone_33:
    s_mov_b64 exec, -1
    s_add_u32 s84, s64, 0
    buffer_load_dwordx4 a[0:3], v1, s[36:39], s84 offen offset:0 sc1
    buffer_load_dwordx4 a[4:7], v1, s[36:39], s84 offen offset:1024 sc1
    buffer_load_dwordx4 v[192:195], v1, s[4:7], s62 offen sc1
    buffer_load_dwordx4 v[196:199], v1, s[4:7], s62 offen offset:1024 sc1
    buffer_load_dwordx4 a[8:11], v1, s[36:39], s84 offen offset:2048 sc1
    buffer_load_dwordx4 a[12:15], v1, s[36:39], s84 offen offset:3072 sc1
    s_add_u32 s85, s64, 4096
    buffer_load_dwordx4 a[16:19], v1, s[36:39], s85 offen offset:0 sc1
    buffer_load_dwordx4 a[20:23], v1, s[36:39], s85 offen offset:1024 sc1
    buffer_load_dwordx4 a[24:27], v1, s[36:39], s85 offen offset:2048 sc1
    buffer_load_dwordx4 a[28:31], v1, s[36:39], s85 offen offset:3072 sc1
    s_barrier
    ds_read_b128 v[104:107], v1 offset:20480
    ds_read_b128 v[108:111], v1 offset:21504
    ds_read_b128 v[112:115], v1 offset:22528
    ds_read_b128 v[116:119], v1 offset:23552
    ds_read_b128 v[120:123], v1 offset:24576
    ds_read_b128 v[124:127], v1 offset:25600
    ds_read_b128 v[128:131], v1 offset:26624
    ds_read_b128 v[132:135], v1 offset:27648
    ds_read_b128 v[136:139], v1 offset:28672
    s_waitcnt vmcnt(8) lgkmcnt(8)
    v_mfma_f32_16x16x32_bf16 v[40:43], a[0:3], v[104:107], 0
    s_add_u32 s86, s64, 8192
    buffer_load_dwordx4 a[32:35], v1, s[36:39], s86 offen offset:0 sc1
    v_mfma_f32_16x16x32_bf16 v[44:47], a[4:7], v[104:107], 0
    ds_read_b128 v[140:143], v1 offset:29696
    buffer_load_dwordx4 a[36:39], v1, s[36:39], s86 offen offset:1024 sc1
    s_waitcnt lgkmcnt(8)
    v_mfma_f32_16x16x32_bf16 v[48:51], a[0:3], v[108:111], 0
    buffer_load_dwordx4 a[40:43], v1, s[36:39], s86 offen offset:2048 sc1
    buffer_load_dwordx4 a[44:47], v1, s[36:39], s86 offen offset:3072 sc1
    v_mfma_f32_16x16x32_bf16 v[52:55], a[4:7], v[108:111], 0
    ds_read_b128 v[104:107], v1 offset:30720
    s_waitcnt lgkmcnt(8)
    v_mfma_f32_16x16x32_bf16 v[56:59], a[0:3], v[112:115], 0
    s_add_u32 s87, s64, 12288
    buffer_load_dwordx4 a[48:51], v1, s[36:39], s87 offen offset:0 sc1
    buffer_load_dwordx4 a[52:55], v1, s[36:39], s87 offen offset:1024 sc1
    v_mfma_f32_16x16x32_bf16 v[60:63], a[4:7], v[112:115], 0
    ds_read_b128 v[108:111], v1 offset:31744
    s_waitcnt vmcnt(12)
    v_add_f32_dpp v200, v192, v192 row_ror:8 row_mask:0xf bank_mask:0x3
    s_waitcnt vmcnt(10) lgkmcnt(8)
    v_mfma_f32_16x16x32_bf16 v[40:43], a[8:11], v[116:119], v[40:43]
    v_add_f32_dpp v201, v193, v193 row_ror:8 row_mask:0xf bank_mask:0x3
    v_mfma_f32_16x16x32_bf16 v[44:47], a[12:15], v[116:119], v[44:47]
    ds_read_b128 v[112:115], v1 offset:32768
    v_add_f32_dpp v202, v194, v194 row_ror:8 row_mask:0xf bank_mask:0x3
    v_add_f32_dpp v203, v195, v195 row_ror:8 row_mask:0xf bank_mask:0x3
    s_waitcnt lgkmcnt(8)
    v_mfma_f32_16x16x32_bf16 v[48:51], a[8:11], v[120:123], v[48:51]
    v_add_f32_dpp v200, v196, v196 row_ror:8 row_mask:0xf bank_mask:0xc
    v_add_f32_dpp v201, v197, v197 row_ror:8 row_mask:0xf bank_mask:0xc
    v_add_f32_dpp v202, v198, v198 row_ror:8 row_mask:0xf bank_mask:0xc
    v_add_f32_dpp v203, v199, v199 row_ror:8 row_mask:0xf bank_mask:0xc
    v_mfma_f32_16x16x32_bf16 v[52:55], a[12:15], v[120:123], v[52:55]
    ds_read_b128 v[116:119], v1 offset:33792
    v_mov_b32 v204, v200
    v_mov_b32 v205, v201
    s_waitcnt lgkmcnt(8)
    v_mfma_f32_16x16x32_bf16 v[56:59], a[8:11], v[124:127], v[56:59]
    buffer_load_dwordx4 a[56:59], v1, s[36:39], s87 offen offset:2048 sc1
    buffer_load_dwordx4 a[60:63], v1, s[36:39], s87 offen offset:3072 sc1
    v_mfma_f32_16x16x32_bf16 v[60:63], a[12:15], v[124:127], v[60:63]
    ds_read_b128 v[120:123], v1 offset:34816
    v_mov_b32 v206, v202
    v_mov_b32 v207, v203
    s_waitcnt vmcnt(10) lgkmcnt(8)
    v_mfma_f32_16x16x32_bf16 v[40:43], a[16:19], v[128:131], v[40:43]
    v_permlane16_swap_b32 v200, v204
    v_permlane16_swap_b32 v201, v205
    v_permlane16_swap_b32 v202, v206
    v_mfma_f32_16x16x32_bf16 v[44:47], a[20:23], v[128:131], v[44:47]
    ds_read_b128 v[124:127], v1 offset:35840
    v_permlane16_swap_b32 v203, v207
    v_add_f32 v200, v200, v204
    s_waitcnt lgkmcnt(8)
    v_mfma_f32_16x16x32_bf16 v[48:51], a[16:19], v[132:135], v[48:51]
    v_add_f32 v201, v201, v205
    v_add_f32 v202, v202, v206
    v_add_f32 v203, v203, v207
    v_mov_b32 v204, v200
    v_mfma_f32_16x16x32_bf16 v[52:55], a[20:23], v[132:135], v[52:55]
    ds_read_b128 v[128:131], v1 offset:36864
    v_mov_b32 v205, v201
    v_mov_b32 v206, v202
    s_waitcnt lgkmcnt(8)
    v_mfma_f32_16x16x32_bf16 v[56:59], a[16:19], v[136:139], v[56:59]
    s_add_u32 s84, s64, 16384
    buffer_load_dwordx4 a[64:67], v1, s[36:39], s84 offen offset:0 sc1
    buffer_load_dwordx4 a[68:71], v1, s[36:39], s84 offen offset:1024 sc1
    v_mfma_f32_16x16x32_bf16 v[60:63], a[20:23], v[136:139], v[60:63]
    ds_read_b128 v[132:135], v1 offset:37888
    v_mov_b32 v207, v203
    s_waitcnt vmcnt(10) lgkmcnt(8)
    v_mfma_f32_16x16x32_bf16 v[40:43], a[24:27], v[140:143], v[40:43]
    v_permlane32_swap_b32 v200, v204
    v_permlane32_swap_b32 v201, v205
    v_permlane32_swap_b32 v202, v206
    v_mfma_f32_16x16x32_bf16 v[44:47], a[28:31], v[140:143], v[44:47]
    ds_read_b128 v[136:139], v1 offset:38912
    v_permlane32_swap_b32 v203, v207
    v_add_f32 v200, v200, v204
    s_waitcnt lgkmcnt(8)
    v_mfma_f32_16x16x32_bf16 v[48:51], a[24:27], v[104:107], v[48:51]
    v_add_f32 v201, v201, v205
    v_add_f32 v202, v202, v206
    v_add_f32 v203, v203, v207
    v_mov_b32_dpp v204, v200 row_shl:4 row_mask:0xf bank_mask:0xf
    v_mfma_f32_16x16x32_bf16 v[52:55], a[28:31], v[104:107], v[52:55]
    ds_read_b128 v[140:143], v1 offset:39936
    v_mov_b32_dpp v205, v201 row_shl:4 row_mask:0xf bank_mask:0xf
    v_mov_b32_dpp v206, v202 row_shl:4 row_mask:0xf bank_mask:0xf
    s_waitcnt lgkmcnt(8)
    v_mfma_f32_16x16x32_bf16 v[56:59], a[24:27], v[108:111], v[56:59]
    buffer_load_dwordx4 a[72:75], v1, s[36:39], s84 offen offset:2048 sc1
    buffer_load_dwordx4 a[76:79], v1, s[36:39], s84 offen offset:3072 sc1
    v_mfma_f32_16x16x32_bf16 v[60:63], a[28:31], v[108:111], v[60:63]
    ds_read_b128 v[104:107], v1 offset:40960
    v_mov_b32_dpp v207, v203 row_shl:4 row_mask:0xf bank_mask:0xf
    s_mov_b32 s60, 0xbacccccd
    s_waitcnt vmcnt(10) lgkmcnt(8)
    v_mfma_f32_16x16x32_bf16 v[40:43], a[32:35], v[112:115], v[40:43]
    s_mov_b32 s61, 0x3acccccd
    v_mul_f32 v200, s60, v200
    v_mul_f32 v201, s60, v201
    v_mfma_f32_16x16x32_bf16 v[44:47], a[36:39], v[112:115], v[44:47]
    ds_read_b128 v[108:111], v1 offset:41984
    v_mul_f32 v202, s60, v202
    v_mul_f32 v203, s60, v203
    s_waitcnt lgkmcnt(8)
    v_mfma_f32_16x16x32_bf16 v[48:51], a[32:35], v[116:119], v[48:51]
    v_mul_f32 v208, v200, v200
    v_mul_f32 v209, v201, v201
    v_mul_f32 v210, v202, v202
    v_mul_f32 v211, v203, v203
    v_mfma_f32_16x16x32_bf16 v[52:55], a[36:39], v[116:119], v[52:55]
    ds_read_b128 v[112:115], v1 offset:43008
    v_fma_f32 v204, v204, s61, -v208
    v_fma_f32 v205, v205, s61, -v209
    s_waitcnt lgkmcnt(8)
    v_mfma_f32_16x16x32_bf16 v[56:59], a[32:35], v[120:123], v[56:59]
    s_add_u32 s85, s64, 20480
    buffer_load_dwordx4 a[80:83], v1, s[36:39], s85 offen offset:0 sc1
    buffer_load_dwordx4 a[84:87], v1, s[36:39], s85 offen offset:1024 sc1
    v_mfma_f32_16x16x32_bf16 v[60:63], a[36:39], v[120:123], v[60:63]
    ds_read_b128 v[116:119], v1 offset:44032
    v_fma_f32 v206, v206, s61, -v210
    s_waitcnt vmcnt(10) lgkmcnt(8)
    v_mfma_f32_16x16x32_bf16 v[40:43], a[40:43], v[124:127], v[40:43]
    v_fma_f32 v207, v207, s61, -v211
    v_max_f32 v204, 0, v204
    v_max_f32 v205, 0, v205
    v_mfma_f32_16x16x32_bf16 v[44:47], a[44:47], v[124:127], v[44:47]
    ds_read_b128 v[120:123], v1 offset:45056
    v_max_f32 v206, 0, v206
    v_max_f32 v207, 0, v207
    s_waitcnt lgkmcnt(8)
    v_mfma_f32_16x16x32_bf16 v[48:51], a[40:43], v[128:131], v[48:51]
    v_add_f32 v204, 0x3727c5ac, v204
    v_add_f32 v205, 0x3727c5ac, v205
    v_add_f32 v206, 0x3727c5ac, v206
    v_add_f32 v207, 0x3727c5ac, v207
    v_mfma_f32_16x16x32_bf16 v[52:55], a[44:47], v[128:131], v[52:55]
    ds_read_b128 v[124:127], v1 offset:46080
    v_rsq_f32 v204, v204
    v_rsq_f32 v205, v205
    s_waitcnt lgkmcnt(8)
    v_mfma_f32_16x16x32_bf16 v[56:59], a[40:43], v[132:135], v[56:59]
    buffer_load_dwordx4 a[88:91], v1, s[36:39], s85 offen offset:2048 sc1
    buffer_load_dwordx4 a[92:95], v1, s[36:39], s85 offen offset:3072 sc1
    v_mfma_f32_16x16x32_bf16 v[60:63], a[44:47], v[132:135], v[60:63]
    ds_read_b128 v[128:131], v1 offset:47104
    v_rsq_f32 v206, v206
    v_rsq_f32 v207, v207
    s_waitcnt vmcnt(10) lgkmcnt(8)
    v_mfma_f32_16x16x32_bf16 v[40:43], a[48:51], v[136:139], v[40:43]
    v_lshrrev_b32 v208, 3, v23
    v_and_b32 v209, 3, v23
    v_lshlrev_b32 v209, 4, v209
    v_mfma_f32_16x16x32_bf16 v[44:47], a[52:55], v[136:139], v[44:47]
    ds_read_b128 v[132:135], v1 offset:48128
    v_lshl_add_u32 v208, v208, 6, v209
    s_lshl_b32 s65, s44, 8
    s_waitcnt lgkmcnt(8)
    v_mfma_f32_16x16x32_bf16 v[48:51], a[48:51], v[140:143], v[48:51]
    s_add_u32 s65, s65, 155904
    v_add_u32 v208, s65, v208
    s_mov_b64 exec, 0x0f0f
    ds_write_b128 v208, v[200:203]
    ds_write_b128 v208, v[204:207] offset:128
    s_mov_b64 exec, -1
    v_mfma_f32_16x16x32_bf16 v[52:55], a[52:55], v[140:143], v[52:55]
    ds_read_b128 v[136:139], v1 offset:49152
    s_waitcnt lgkmcnt(10)
    v_mfma_f32_16x16x32_bf16 v[56:59], a[48:51], v[104:107], v[56:59]
    s_add_u32 s86, s64, 24576
    buffer_load_dwordx4 a[96:99], v1, s[36:39], s86 offen offset:0 sc1
    buffer_load_dwordx4 a[100:103], v1, s[36:39], s86 offen offset:1024 sc1
    v_mfma_f32_16x16x32_bf16 v[60:63], a[52:55], v[104:107], v[60:63]
    ds_read_b128 v[140:143], v1 offset:50176
    ds_read_b128 v[144:147], v32 offset:0
    s_waitcnt vmcnt(10) lgkmcnt(11)
    v_mfma_f32_16x16x32_bf16 v[40:43], a[56:59], v[108:111], v[40:43]
    ds_read_b128 v[88:91], v32 offset:128
    ds_read_b32 v164, v31 offset:0
    ds_read_b32 v166, v31 offset:128
    v_mfma_f32_16x16x32_bf16 v[44:47], a[60:63], v[108:111], v[44:47]
    ds_read_b128 v[104:107], v1 offset:51200
    s_waitcnt lgkmcnt(14)
    ds_read_b128 v[148:151], v32 offset:16
    v_mfma_f32_16x16x32_bf16 v[48:51], a[56:59], v[112:115], v[48:51]
    s_waitcnt lgkmcnt(14)
    ds_read_b128 v[92:95], v32 offset:144
    s_waitcnt lgkmcnt(14)
    ds_read_b32 v165, v31 offset:16
    v_mfma_f32_16x16x32_bf16 v[52:55], a[60:63], v[112:115], v[52:55]
    s_waitcnt lgkmcnt(14)
    ds_read_b128 v[108:111], v1 offset:52224
    s_waitcnt lgkmcnt(14)
    ds_read_b32 v167, v31 offset:144
    v_mfma_f32_16x16x32_bf16 v[56:59], a[56:59], v[116:119], v[56:59]
    buffer_load_dwordx4 a[104:107], v1, s[36:39], s86 offen offset:2048 sc1
    buffer_load_dwordx4 a[108:111], v1, s[36:39], s86 offen offset:3072 sc1
    v_mfma_f32_16x16x32_bf16 v[60:63], a[60:63], v[116:119], v[60:63]
    s_waitcnt lgkmcnt(14)
    ds_read_b128 v[112:115], v1 offset:53248
    s_waitcnt vmcnt(10)
    v_mfma_f32_16x16x32_bf16 v[40:43], a[64:67], v[120:123], v[40:43]
    s_waitcnt lgkmcnt(14)
    ds_read_b32 v160, v28 offset:0
    s_waitcnt lgkmcnt(14)
    ds_read_b32 v161, v28 offset:64
    v_mfma_f32_16x16x32_bf16 v[44:47], a[68:71], v[120:123], v[44:47]
    s_waitcnt lgkmcnt(14)
    ds_read_b128 v[116:119], v1 offset:54272
    s_waitcnt lgkmcnt(14)
    ds_read_b32 v162, v28 offset:128
    v_mfma_f32_16x16x32_bf16 v[48:51], a[64:67], v[124:127], v[48:51]
    s_waitcnt lgkmcnt(14)
    ds_read_b128 v[168:171], v29 offset:0
    s_waitcnt lgkmcnt(14)
    ds_read_b128 v[172:175], v29 offset:64
    v_mfma_f32_16x16x32_bf16 v[52:55], a[68:71], v[124:127], v[52:55]
    s_waitcnt lgkmcnt(14)
    ds_read_b128 v[120:123], v1 offset:55296
    v_mfma_f32_16x16x32_bf16 v[56:59], a[64:67], v[128:131], v[56:59]
    s_add_u32 s87, s64, 28672
    buffer_load_dwordx4 a[112:115], v1, s[36:39], s87 offen offset:0 sc1
    buffer_load_dwordx4 a[116:119], v1, s[36:39], s87 offen offset:1024 sc1
    v_mfma_f32_16x16x32_bf16 v[60:63], a[68:71], v[128:131], v[60:63]
    s_waitcnt lgkmcnt(14)
    ds_read_b128 v[124:127], v1 offset:56320
    s_waitcnt vmcnt(10)
    v_mfma_f32_16x16x32_bf16 v[40:43], a[72:75], v[132:135], v[40:43]
    s_waitcnt lgkmcnt(14)
    ds_read_b128 v[176:179], v29 offset:128
    v_mfma_f32_16x16x32_bf16 v[44:47], a[76:79], v[132:135], v[44:47]
    s_waitcnt lgkmcnt(14)
    ds_read_b128 v[128:131], v1 offset:57344
    v_mfma_f32_16x16x32_bf16 v[48:51], a[72:75], v[136:139], v[48:51]
    v_mfma_f32_16x16x32_bf16 v[52:55], a[76:79], v[136:139], v[52:55]
    s_waitcnt lgkmcnt(14)
    ds_read_b128 v[132:135], v1 offset:58368
    v_mfma_f32_16x16x32_bf16 v[56:59], a[72:75], v[140:143], v[56:59]
    buffer_load_dwordx4 a[120:123], v1, s[36:39], s87 offen offset:2048 sc1
    buffer_load_dwordx4 a[124:127], v1, s[36:39], s87 offen offset:3072 sc1
    v_mfma_f32_16x16x32_bf16 v[60:63], a[76:79], v[140:143], v[60:63]
    s_waitcnt lgkmcnt(14)
    ds_read_b128 v[136:139], v1 offset:59392
    s_waitcnt vmcnt(10)
    v_mfma_f32_16x16x32_bf16 v[40:43], a[80:83], v[104:107], v[40:43]
    v_mfma_f32_16x16x32_bf16 v[44:47], a[84:87], v[104:107], v[44:47]
    s_waitcnt lgkmcnt(14)
    ds_read_b128 v[140:143], v1 offset:60416
    v_mfma_f32_16x16x32_bf16 v[48:51], a[80:83], v[108:111], v[48:51]
    v_mfma_f32_16x16x32_bf16 v[52:55], a[84:87], v[108:111], v[52:55]
    s_waitcnt lgkmcnt(14)
    ds_read_b128 v[104:107], v1 offset:61440
    s_waitcnt lgkmcnt(14)
    v_mfma_f32_16x16x32_bf16 v[56:59], a[80:83], v[112:115], v[56:59]
    s_add_u32 s84, s64, 32768
    buffer_load_dwordx4 a[128:131], v1, s[36:39], s84 offen offset:0 sc1
    buffer_load_dwordx4 a[132:135], v1, s[36:39], s84 offen offset:1024 sc1
    v_mfma_f32_16x16x32_bf16 v[60:63], a[84:87], v[112:115], v[60:63]
    ds_read_b128 v[108:111], v1 offset:62464
    s_waitcnt vmcnt(10) lgkmcnt(12)
    v_mfma_f32_16x16x32_bf16 v[40:43], a[88:91], v[116:119], v[40:43]
    v_mfma_f32_16x16x32_bf16 v[44:47], a[92:95], v[116:119], v[44:47]
    ds_read_b128 v[112:115], v1 offset:63488
    s_waitcnt lgkmcnt(9)
    v_mfma_f32_16x16x32_bf16 v[48:51], a[88:91], v[120:123], v[48:51]
    v_mfma_f32_16x16x32_bf16 v[52:55], a[92:95], v[120:123], v[52:55]
    ds_read_b128 v[116:119], v1 offset:64512
    s_waitcnt lgkmcnt(9)
    v_mfma_f32_16x16x32_bf16 v[56:59], a[88:91], v[124:127], v[56:59]
    buffer_load_dwordx4 a[136:139], v1, s[36:39], s84 offen offset:2048 sc1
    buffer_load_dwordx4 a[140:143], v1, s[36:39], s84 offen offset:3072 sc1
    v_mfma_f32_16x16x32_bf16 v[60:63], a[92:95], v[124:127], v[60:63]
    ds_read_b128 v[120:123], v2 offset:0
    s_waitcnt vmcnt(10) lgkmcnt(8)
    v_mfma_f32_16x16x32_bf16 v[40:43], a[96:99], v[128:131], v[40:43]
    v_mfma_f32_16x16x32_bf16 v[44:47], a[100:103], v[128:131], v[44:47]
    ds_read_b128 v[124:127], v2 offset:1024
    s_waitcnt lgkmcnt(8)
    v_mfma_f32_16x16x32_bf16 v[48:51], a[96:99], v[132:135], v[48:51]
    v_mfma_f32_16x16x32_bf16 v[52:55], a[100:103], v[132:135], v[52:55]
    ds_read_b128 v[128:131], v2 offset:2048
    s_waitcnt lgkmcnt(8)
    v_mfma_f32_16x16x32_bf16 v[56:59], a[96:99], v[136:139], v[56:59]
    s_add_u32 s85, s64, 36864
    buffer_load_dwordx4 a[144:147], v1, s[36:39], s85 offen offset:0 sc1
    buffer_load_dwordx4 a[148:151], v1, s[36:39], s85 offen offset:1024 sc1
    v_mfma_f32_16x16x32_bf16 v[60:63], a[100:103], v[136:139], v[60:63]
    ds_read_b128 v[132:135], v2 offset:3072
    s_waitcnt vmcnt(10) lgkmcnt(8)
    v_mfma_f32_16x16x32_bf16 v[40:43], a[104:107], v[140:143], v[40:43]
    v_mfma_f32_16x16x32_bf16 v[44:47], a[108:111], v[140:143], v[44:47]
    ds_read_b128 v[136:139], v2 offset:4096
    s_waitcnt lgkmcnt(8)
    v_mfma_f32_16x16x32_bf16 v[48:51], a[104:107], v[104:107], v[48:51]
    v_mfma_f32_16x16x32_bf16 v[52:55], a[108:111], v[104:107], v[52:55]
    ds_read_b128 v[140:143], v2 offset:5120
    s_waitcnt lgkmcnt(8)
    v_mfma_f32_16x16x32_bf16 v[56:59], a[104:107], v[108:111], v[56:59]
    buffer_load_dwordx4 a[152:155], v1, s[36:39], s85 offen offset:2048 sc1
    buffer_load_dwordx4 a[156:159], v1, s[36:39], s85 offen offset:3072 sc1
    v_mfma_f32_16x16x32_bf16 v[60:63], a[108:111], v[108:111], v[60:63]
    ds_read_b128 v[104:107], v2 offset:6144
    s_waitcnt vmcnt(10) lgkmcnt(8)
    v_mfma_f32_16x16x32_bf16 v[40:43], a[112:115], v[112:115], v[40:43]
    v_mfma_f32_16x16x32_bf16 v[44:47], a[116:119], v[112:115], v[44:47]
    ds_read_b128 v[108:111], v2 offset:7168
    s_waitcnt lgkmcnt(8)
    v_mfma_f32_16x16x32_bf16 v[48:51], a[112:115], v[116:119], v[48:51]
    v_mfma_f32_16x16x32_bf16 v[52:55], a[116:119], v[116:119], v[52:55]
    ds_read_b128 v[112:115], v1 offset:0
    s_waitcnt lgkmcnt(8)
    v_mfma_f32_16x16x32_bf16 v[56:59], a[112:115], v[120:123], v[56:59]
    v_mfma_f32_16x16x32_bf16 v[60:63], a[116:119], v[120:123], v[60:63]
    ds_read_b128 v[116:119], v1 offset:1024
    s_waitcnt vmcnt(8) lgkmcnt(8)
    v_mfma_f32_16x16x32_bf16 v[40:43], a[120:123], v[124:127], v[40:43]
    v_mfma_f32_16x16x32_bf16 v[44:47], a[124:127], v[124:127], v[44:47]
    ds_read_b128 v[120:123], v1 offset:2048
    s_waitcnt lgkmcnt(8)
    v_mfma_f32_16x16x32_bf16 v[48:51], a[120:123], v[128:131], v[48:51]
    v_mfma_f32_16x16x32_bf16 v[52:55], a[124:127], v[128:131], v[52:55]
    ds_read_b128 v[124:127], v1 offset:3072
    s_waitcnt lgkmcnt(8)
    v_mfma_f32_16x16x32_bf16 v[56:59], a[120:123], v[132:135], v[56:59]
    s_cmp_eq_u32 s48, 0
    s_cbranch_scc0 Ll0_34
    s_mov_b32 exec_lo, 0x11111111
    s_mov_b32 exec_hi, 0x11111111
    buffer_load_dword v36, v96, s[4:7], s72 offen sc1
    buffer_load_dword v36, v97, s[4:7], s72 offen sc1
    s_mov_b64 exec, -1
Ll0_34:
    v_mfma_f32_16x16x32_bf16 v[60:63], a[124:127], v[132:135], v[60:63]
    ds_read_b128 v[128:131], v1 offset:4096
    s_waitcnt vmcnt(6) lgkmcnt(8)
    v_mfma_f32_16x16x32_bf16 v[40:43], a[128:131], v[136:139], v[40:43]
    v_mfma_f32_16x16x32_bf16 v[44:47], a[132:135], v[136:139], v[44:47]
    ds_read_b128 v[132:135], v1 offset:5120
    s_waitcnt lgkmcnt(8)
    v_mfma_f32_16x16x32_bf16 v[48:51], a[128:131], v[140:143], v[48:51]
    s_add_u32 s80, s96, 94208
    s_add_u32 m0, s81, 126976
    s_nop 0
    buffer_load_dwordx4 v1, s[4:7], s80 offen sc1 lds
    v_mfma_f32_16x16x32_bf16 v[52:55], a[132:135], v[140:143], v[52:55]
    ds_read_b128 v[136:139], v1 offset:6144
    s_waitcnt lgkmcnt(8)
    v_mfma_f32_16x16x32_bf16 v[56:59], a[128:131], v[104:107], v[56:59]
    s_add_u32 s80, s96, 98304
    s_add_u32 m0, s81, 131072
    s_nop 0
    buffer_load_dwordx4 v1, s[4:7], s80 offen sc1 lds
    v_mfma_f32_16x16x32_bf16 v[60:63], a[132:135], v[104:107], v[60:63]
    ds_read_b128 v[140:143], v1 offset:7168
    s_waitcnt vmcnt(6) lgkmcnt(8)
    v_mfma_f32_16x16x32_bf16 v[40:43], a[136:139], v[108:111], v[40:43]
    s_add_u32 s80, s96, 102400
    s_add_u32 m0, s81, 135168
    s_nop 0
    buffer_load_dwordx4 v1, s[4:7], s80 offen sc1 lds
    v_mfma_f32_16x16x32_bf16 v[44:47], a[140:143], v[108:111], v[44:47]
    s_waitcnt lgkmcnt(7)
    v_mfma_f32_16x16x32_bf16 v[48:51], a[136:139], v[112:115], v[48:51]
    v_mfma_f32_16x16x32_bf16 v[52:55], a[140:143], v[112:115], v[52:55]
    s_waitcnt lgkmcnt(6)
    v_mfma_f32_16x16x32_bf16 v[56:59], a[136:139], v[116:119], v[56:59]
    s_add_u32 s80, s96, 106496
    s_add_u32 m0, s81, 139264
    s_nop 0
    buffer_load_dwordx4 v1, s[4:7], s80 offen sc1 lds
    v_mfma_f32_16x16x32_bf16 v[60:63], a[140:143], v[116:119], v[60:63]
    s_waitcnt vmcnt(6) lgkmcnt(5)
    v_mfma_f32_16x16x32_bf16 v[40:43], a[144:147], v[120:123], v[40:43]
    s_add_u32 s80, s96, 110592
    s_add_u32 m0, s81, 143360
    s_nop 0
    buffer_load_dwordx4 v1, s[4:7], s80 offen sc1 lds
    v_mfma_f32_16x16x32_bf16 v[44:47], a[148:151], v[120:123], v[44:47]
    s_waitcnt lgkmcnt(4)
    v_mfma_f32_16x16x32_bf16 v[48:51], a[144:147], v[124:127], v[48:51]
    v_mfma_f32_16x16x32_bf16 v[52:55], a[148:151], v[124:127], v[52:55]
    s_waitcnt lgkmcnt(3)
    v_mfma_f32_16x16x32_bf16 v[56:59], a[144:147], v[128:131], v[56:59]
    s_add_u32 s80, s96, 114688
    s_add_u32 m0, s81, 147456
    s_nop 0
    buffer_load_dwordx4 v1, s[4:7], s80 offen sc1 lds
    v_mfma_f32_16x16x32_bf16 v[60:63], a[148:151], v[128:131], v[60:63]
    s_waitcnt vmcnt(6) lgkmcnt(2)
    v_mfma_f32_16x16x32_bf16 v[40:43], a[152:155], v[132:135], v[40:43]
    s_add_u32 s80, s96, 118784
    s_add_u32 m0, s81, 151552
    s_nop 0
    buffer_load_dwordx4 v1, s[4:7], s80 offen sc1 lds
    v_mfma_f32_16x16x32_bf16 v[44:47], a[156:159], v[132:135], v[44:47]
    s_waitcnt lgkmcnt(1)
    v_mfma_f32_16x16x32_bf16 v[48:51], a[152:155], v[136:139], v[48:51]
    v_mfma_f32_16x16x32_bf16 v[52:55], a[156:159], v[136:139], v[52:55]
    s_waitcnt lgkmcnt(0)
    v_mfma_f32_16x16x32_bf16 v[56:59], a[152:155], v[140:143], v[56:59]
    s_lshl_b32 s90, s45, 5
    s_add_u32 s90, s90, s46
    s_lshl_b32 s90, s90, 2
    s_add_u32 s90, s90, s44
    s_lshl_b32 s90, s90, 13
    s_and_b32 s80, s46, 4
    s_xor_b32 s80, s80, 4
    s_lshl_b32 s80, s80, 9
    s_add_u32 s90, s90, s80
    s_cmp_eq_u32 s48, 0
    s_cselect_b32 s90, s90, 0x40000000
    buffer_load_dwordx4 v[180:183], v1, s[24:27], s90 offen offset:0
    v_mfma_f32_16x16x32_bf16 v[60:63], a[156:159], v[140:143], v[60:63]
    buffer_load_dwordx4 v[180:183], v1, s[24:27], s90 offen offset:1024
    s_add_u32 s90, s90, 4096
    buffer_load_dwordx4 v[180:183], v1, s[24:27], s90 offen offset:0
    buffer_load_dwordx4 v[180:183], v1, s[24:27], s90 offen offset:1024
    s_barrier
    v_pk_fma_f32 v[40:41], v[144:145], v[160:161], v[40:41] op_sel:[0,0,0] op_sel_hi:[1,0,1]
    v_pk_fma_f32 v[42:43], v[146:147], v[160:161], v[42:43] op_sel:[0,0,0] op_sel_hi:[1,0,1]
    v_pk_fma_f32 v[44:45], v[148:149], v[160:161], v[44:45] op_sel:[0,0,0] op_sel_hi:[1,0,1]
    v_pk_fma_f32 v[46:47], v[150:151], v[160:161], v[46:47] op_sel:[0,0,0] op_sel_hi:[1,0,1]
    v_pk_fma_f32 v[48:49], v[144:145], v[160:161], v[48:49] op_sel:[0,1,0] op_sel_hi:[1,1,1]
    v_pk_fma_f32 v[50:51], v[146:147], v[160:161], v[50:51] op_sel:[0,1,0] op_sel_hi:[1,1,1]
    v_pk_fma_f32 v[52:53], v[148:149], v[160:161], v[52:53] op_sel:[0,1,0] op_sel_hi:[1,1,1]
    v_pk_fma_f32 v[54:55], v[150:151], v[160:161], v[54:55] op_sel:[0,1,0] op_sel_hi:[1,1,1]
    v_pk_fma_f32 v[56:57], v[144:145], v[162:163], v[56:57] op_sel:[0,0,0] op_sel_hi:[1,0,1]
    v_pk_fma_f32 v[58:59], v[146:147], v[162:163], v[58:59] op_sel:[0,0,0] op_sel_hi:[1,0,1]
    v_pk_fma_f32 v[60:61], v[148:149], v[162:163], v[60:61] op_sel:[0,0,0] op_sel_hi:[1,0,1]
    v_pk_fma_f32 v[62:63], v[150:151], v[162:163], v[62:63] op_sel:[0,0,0] op_sel_hi:[1,0,1]
    v_pk_mul_f32 v[40:41], v[40:41], v[88:89] op_sel:[0,0] op_sel_hi:[1,1]
    v_pk_mul_f32 v[42:43], v[42:43], v[90:91] op_sel:[0,0] op_sel_hi:[1,1]
    v_pk_mul_f32 v[192:193], v[40:41], v[40:41] op_sel:[0,0] op_sel_hi:[1,1]
    v_pk_mul_f32 v[194:195], v[42:43], v[42:43] op_sel:[0,0] op_sel_hi:[1,1]
    v_pk_fma_f32 v[192:193], v[192:193], v[16:17], v[16:17] op_sel:[0,1,0] op_sel_hi:[1,1,0]
    v_pk_fma_f32 v[194:195], v[194:195], v[16:17], v[16:17] op_sel:[0,1,0] op_sel_hi:[1,1,0]
    v_pk_mul_f32 v[192:193], v[192:193], v[40:41] op_sel:[0,0] op_sel_hi:[1,1]
    v_pk_mul_f32 v[194:195], v[194:195], v[42:43] op_sel:[0,0] op_sel_hi:[1,1]
    v_exp_f32 v192, v192
    v_exp_f32 v193, v193
    v_exp_f32 v194, v194
    s_add_u32 s77, s76, 0
    s_and_b32 s77, s77, 1023
    s_add_u32 s77, s77, s79
    s_add_u32 s80, s77, 0
    s_add_u32 m0, s70, 0
    s_nop 0
    buffer_load_dwordx4 v100, s[24:27], s80 offen lds
    v_exp_f32 v195, v195
    v_pk_add_f32 v[192:193], v[192:193], v[18:19] op_sel:[0,0] op_sel_hi:[1,0]
    v_pk_add_f32 v[194:195], v[194:195], v[18:19] op_sel:[0,0] op_sel_hi:[1,0]
    v_rcp_f32 v192, v192
    v_rcp_f32 v193, v193
    v_rcp_f32 v194, v194
    v_rcp_f32 v195, v195
    v_pk_mul_f32 v[40:41], v[40:41], v[192:193] op_sel:[0,0] op_sel_hi:[1,1]
    v_pk_mul_f32 v[42:43], v[42:43], v[194:195] op_sel:[0,0] op_sel_hi:[1,1]
    v_pk_mul_f32 v[44:45], v[44:45], v[92:93] op_sel:[0,0] op_sel_hi:[1,1]
    v_pk_mul_f32 v[46:47], v[46:47], v[94:95] op_sel:[0,0] op_sel_hi:[1,1]
    v_pk_mul_f32 v[192:193], v[44:45], v[44:45] op_sel:[0,0] op_sel_hi:[1,1]
    v_pk_mul_f32 v[194:195], v[46:47], v[46:47] op_sel:[0,0] op_sel_hi:[1,1]
    v_pk_fma_f32 v[192:193], v[192:193], v[16:17], v[16:17] op_sel:[0,1,0] op_sel_hi:[1,1,0]
    v_pk_fma_f32 v[194:195], v[194:195], v[16:17], v[16:17] op_sel:[0,1,0] op_sel_hi:[1,1,0]
    v_pk_mul_f32 v[192:193], v[192:193], v[44:45] op_sel:[0,0] op_sel_hi:[1,1]
    v_pk_mul_f32 v[194:195], v[194:195], v[46:47] op_sel:[0,0] op_sel_hi:[1,1]
    v_exp_f32 v192, v192
    v_exp_f32 v193, v193
    v_exp_f32 v194, v194
    s_add_u32 s80, s77, 16384
    s_add_u32 m0, s70, 1024
    s_nop 0
    buffer_load_dwordx4 v101, s[24:27], s80 offen lds
    v_exp_f32 v195, v195
    v_pk_add_f32 v[192:193], v[192:193], v[18:19] op_sel:[0,0] op_sel_hi:[1,0]
    v_pk_add_f32 v[194:195], v[194:195], v[18:19] op_sel:[0,0] op_sel_hi:[1,0]
    v_rcp_f32 v192, v192
    v_rcp_f32 v193, v193
    v_rcp_f32 v194, v194
    v_rcp_f32 v195, v195
    v_pk_mul_f32 v[44:45], v[44:45], v[192:193] op_sel:[0,0] op_sel_hi:[1,1]
    v_pk_mul_f32 v[46:47], v[46:47], v[194:195] op_sel:[0,0] op_sel_hi:[1,1]
    v_pk_mul_f32 v[48:49], v[48:49], v[88:89] op_sel:[0,0] op_sel_hi:[1,1]
    v_pk_mul_f32 v[50:51], v[50:51], v[90:91] op_sel:[0,0] op_sel_hi:[1,1]
    v_pk_mul_f32 v[192:193], v[48:49], v[48:49] op_sel:[0,0] op_sel_hi:[1,1]
    v_pk_mul_f32 v[194:195], v[50:51], v[50:51] op_sel:[0,0] op_sel_hi:[1,1]
    v_pk_fma_f32 v[192:193], v[192:193], v[16:17], v[16:17] op_sel:[0,1,0] op_sel_hi:[1,1,0]
    v_pk_fma_f32 v[194:195], v[194:195], v[16:17], v[16:17] op_sel:[0,1,0] op_sel_hi:[1,1,0]
    v_pk_mul_f32 v[192:193], v[192:193], v[48:49] op_sel:[0,0] op_sel_hi:[1,1]
    v_pk_mul_f32 v[194:195], v[194:195], v[50:51] op_sel:[0,0] op_sel_hi:[1,1]
    v_exp_f32 v192, v192
    v_exp_f32 v193, v193
    v_exp_f32 v194, v194
    s_add_u32 s80, s77, 32768
    s_add_u32 m0, s70, 2048
    s_nop 0
    buffer_load_dwordx4 v102, s[24:27], s80 offen lds
    v_exp_f32 v195, v195
    v_pk_add_f32 v[192:193], v[192:193], v[18:19] op_sel:[0,0] op_sel_hi:[1,0]
    v_pk_add_f32 v[194:195], v[194:195], v[18:19] op_sel:[0,0] op_sel_hi:[1,0]
    v_rcp_f32 v192, v192
    v_rcp_f32 v193, v193
    v_rcp_f32 v194, v194
    v_rcp_f32 v195, v195
    v_pk_mul_f32 v[48:49], v[48:49], v[192:193] op_sel:[0,0] op_sel_hi:[1,1]
    v_pk_mul_f32 v[50:51], v[50:51], v[194:195] op_sel:[0,0] op_sel_hi:[1,1]
    v_pk_mul_f32 v[52:53], v[52:53], v[92:93] op_sel:[0,0] op_sel_hi:[1,1]
    v_pk_mul_f32 v[54:55], v[54:55], v[94:95] op_sel:[0,0] op_sel_hi:[1,1]
    v_pk_mul_f32 v[192:193], v[52:53], v[52:53] op_sel:[0,0] op_sel_hi:[1,1]
    v_pk_mul_f32 v[194:195], v[54:55], v[54:55] op_sel:[0,0] op_sel_hi:[1,1]
    v_pk_fma_f32 v[192:193], v[192:193], v[16:17], v[16:17] op_sel:[0,1,0] op_sel_hi:[1,1,0]
    v_pk_fma_f32 v[194:195], v[194:195], v[16:17], v[16:17] op_sel:[0,1,0] op_sel_hi:[1,1,0]
    v_pk_mul_f32 v[192:193], v[192:193], v[52:53] op_sel:[0,0] op_sel_hi:[1,1]
    v_pk_mul_f32 v[194:195], v[194:195], v[54:55] op_sel:[0,0] op_sel_hi:[1,1]
    v_exp_f32 v192, v192
    v_exp_f32 v193, v193
    v_exp_f32 v194, v194
    s_add_u32 s80, s77, 49152
    s_add_u32 m0, s70, 3072
    s_nop 0
    buffer_load_dwordx4 v103, s[24:27], s80 offen lds
    v_exp_f32 v195, v195
    v_pk_add_f32 v[192:193], v[192:193], v[18:19] op_sel:[0,0] op_sel_hi:[1,0]
    v_pk_add_f32 v[194:195], v[194:195], v[18:19] op_sel:[0,0] op_sel_hi:[1,0]
    v_rcp_f32 v192, v192
    v_rcp_f32 v193, v193
    v_rcp_f32 v194, v194
    v_rcp_f32 v195, v195
    v_pk_mul_f32 v[52:53], v[52:53], v[192:193] op_sel:[0,0] op_sel_hi:[1,1]
    v_pk_mul_f32 v[54:55], v[54:55], v[194:195] op_sel:[0,0] op_sel_hi:[1,1]
    v_pk_mul_f32 v[56:57], v[56:57], v[88:89] op_sel:[0,0] op_sel_hi:[1,1]
    v_pk_mul_f32 v[58:59], v[58:59], v[90:91] op_sel:[0,0] op_sel_hi:[1,1]
    v_pk_mul_f32 v[192:193], v[56:57], v[56:57] op_sel:[0,0] op_sel_hi:[1,1]
    v_pk_mul_f32 v[194:195], v[58:59], v[58:59] op_sel:[0,0] op_sel_hi:[1,1]
    v_pk_fma_f32 v[192:193], v[192:193], v[16:17], v[16:17] op_sel:[0,1,0] op_sel_hi:[1,1,0]
    v_pk_fma_f32 v[194:195], v[194:195], v[16:17], v[16:17] op_sel:[0,1,0] op_sel_hi:[1,1,0]
    v_pk_mul_f32 v[192:193], v[192:193], v[56:57] op_sel:[0,0] op_sel_hi:[1,1]
    v_pk_mul_f32 v[194:195], v[194:195], v[58:59] op_sel:[0,0] op_sel_hi:[1,1]
    v_exp_f32 v192, v192
    v_exp_f32 v193, v193
    v_exp_f32 v194, v194
    s_add_u32 s80, s77, 65536
    s_add_u32 m0, s70, 4096
    s_nop 0
    buffer_load_dwordx4 v100, s[24:27], s80 offen lds
    v_exp_f32 v195, v195
    v_pk_add_f32 v[192:193], v[192:193], v[18:19] op_sel:[0,0] op_sel_hi:[1,0]
    v_pk_add_f32 v[194:195], v[194:195], v[18:19] op_sel:[0,0] op_sel_hi:[1,0]
    v_rcp_f32 v192, v192
    v_rcp_f32 v193, v193
    v_rcp_f32 v194, v194
    v_rcp_f32 v195, v195
    v_pk_mul_f32 v[56:57], v[56:57], v[192:193] op_sel:[0,0] op_sel_hi:[1,1]
    v_pk_mul_f32 v[58:59], v[58:59], v[194:195] op_sel:[0,0] op_sel_hi:[1,1]
    v_pk_mul_f32 v[60:61], v[60:61], v[92:93] op_sel:[0,0] op_sel_hi:[1,1]
    v_pk_mul_f32 v[62:63], v[62:63], v[94:95] op_sel:[0,0] op_sel_hi:[1,1]
    v_pk_mul_f32 v[192:193], v[60:61], v[60:61] op_sel:[0,0] op_sel_hi:[1,1]
    v_pk_mul_f32 v[194:195], v[62:63], v[62:63] op_sel:[0,0] op_sel_hi:[1,1]
    v_pk_fma_f32 v[192:193], v[192:193], v[16:17], v[16:17] op_sel:[0,1,0] op_sel_hi:[1,1,0]
    v_pk_fma_f32 v[194:195], v[194:195], v[16:17], v[16:17] op_sel:[0,1,0] op_sel_hi:[1,1,0]
    v_pk_mul_f32 v[192:193], v[192:193], v[60:61] op_sel:[0,0] op_sel_hi:[1,1]
    v_pk_mul_f32 v[194:195], v[194:195], v[62:63] op_sel:[0,0] op_sel_hi:[1,1]
    v_exp_f32 v192, v192
    v_exp_f32 v193, v193
    v_exp_f32 v194, v194
    s_add_u32 s80, s77, 81920
    s_add_u32 m0, s70, 5120
    s_nop 0
    buffer_load_dwordx4 v101, s[24:27], s80 offen lds
    v_exp_f32 v195, v195
    v_pk_add_f32 v[192:193], v[192:193], v[18:19] op_sel:[0,0] op_sel_hi:[1,0]
    v_pk_add_f32 v[194:195], v[194:195], v[18:19] op_sel:[0,0] op_sel_hi:[1,0]
    v_rcp_f32 v192, v192
    v_rcp_f32 v193, v193
    v_rcp_f32 v194, v194
    v_rcp_f32 v195, v195
    v_pk_mul_f32 v[60:61], v[60:61], v[192:193] op_sel:[0,0] op_sel_hi:[1,1]
    v_pk_mul_f32 v[62:63], v[62:63], v[194:195] op_sel:[0,0] op_sel_hi:[1,1]
    v_pk_add_f32 v[192:193], v[40:41], v[48:49] op_sel:[0,0] op_sel_hi:[1,1]
    v_pk_add_f32 v[194:195], v[42:43], v[50:51] op_sel:[0,0] op_sel_hi:[1,1]
    v_pk_add_f32 v[196:197], v[44:45], v[52:53] op_sel:[0,0] op_sel_hi:[1,1]
    v_pk_add_f32 v[198:199], v[46:47], v[54:55] op_sel:[0,0] op_sel_hi:[1,1]
    v_pk_mul_f32 v[200:201], v[40:41], v[40:41] op_sel:[0,0] op_sel_hi:[1,1]
    v_pk_mul_f32 v[202:203], v[42:43], v[42:43] op_sel:[0,0] op_sel_hi:[1,1]
    v_pk_mul_f32 v[204:205], v[44:45], v[44:45] op_sel:[0,0] op_sel_hi:[1,1]
    v_pk_mul_f32 v[206:207], v[46:47], v[46:47] op_sel:[0,0] op_sel_hi:[1,1]
    v_pk_add_f32 v[192:193], v[192:193], v[56:57] op_sel:[0,0] op_sel_hi:[1,1]
    v_pk_add_f32 v[194:195], v[194:195], v[58:59] op_sel:[0,0] op_sel_hi:[1,1]
    v_pk_add_f32 v[196:197], v[196:197], v[60:61] op_sel:[0,0] op_sel_hi:[1,1]
    v_pk_add_f32 v[198:199], v[198:199], v[62:63] op_sel:[0,0] op_sel_hi:[1,1]
    v_pk_fma_f32 v[200:201], v[48:49], v[48:49], v[200:201] op_sel:[0,0,0] op_sel_hi:[1,1,1]
    v_pk_fma_f32 v[202:203], v[50:51], v[50:51], v[202:203] op_sel:[0,0,0] op_sel_hi:[1,1,1]
    s_add_u32 s80, s77, 98304
    s_add_u32 m0, s70, 6144
    s_nop 0
    buffer_load_dwordx4 v102, s[24:27], s80 offen lds
    v_pk_fma_f32 v[204:205], v[52:53], v[52:53], v[204:205] op_sel:[0,0,0] op_sel_hi:[1,1,1]
    v_pk_fma_f32 v[206:207], v[54:55], v[54:55], v[206:207] op_sel:[0,0,0] op_sel_hi:[1,1,1]
    v_pk_fma_f32 v[200:201], v[56:57], v[56:57], v[200:201] op_sel:[0,0,0] op_sel_hi:[1,1,1]
    v_pk_fma_f32 v[202:203], v[58:59], v[58:59], v[202:203] op_sel:[0,0,0] op_sel_hi:[1,1,1]
    v_pk_fma_f32 v[204:205], v[60:61], v[60:61], v[204:205] op_sel:[0,0,0] op_sel_hi:[1,1,1]
    v_pk_fma_f32 v[206:207], v[62:63], v[62:63], v[206:207] op_sel:[0,0,0] op_sel_hi:[1,1,1]
    v_add_f32_dpp v208, v192, v192 row_ror:8 row_mask:0xf bank_mask:0x3
    v_add_f32_dpp v209, v193, v193 row_ror:8 row_mask:0xf bank_mask:0x3
    v_add_f32_dpp v210, v194, v194 row_ror:8 row_mask:0xf bank_mask:0x3
    v_add_f32_dpp v211, v195, v195 row_ror:8 row_mask:0xf bank_mask:0x3
    v_add_f32_dpp v212, v196, v196 row_ror:8 row_mask:0xf bank_mask:0x3
    v_add_f32_dpp v213, v197, v197 row_ror:8 row_mask:0xf bank_mask:0x3
    v_add_f32_dpp v214, v198, v198 row_ror:8 row_mask:0xf bank_mask:0x3
    v_add_f32_dpp v215, v199, v199 row_ror:8 row_mask:0xf bank_mask:0x3
    v_add_f32_dpp v208, v200, v200 row_ror:8 row_mask:0xf bank_mask:0xc
    v_add_f32_dpp v209, v201, v201 row_ror:8 row_mask:0xf bank_mask:0xc
    v_add_f32_dpp v210, v202, v202 row_ror:8 row_mask:0xf bank_mask:0xc
    v_add_f32_dpp v211, v203, v203 row_ror:8 row_mask:0xf bank_mask:0xc
    v_add_f32_dpp v212, v204, v204 row_ror:8 row_mask:0xf bank_mask:0xc
    v_add_f32_dpp v213, v205, v205 row_ror:8 row_mask:0xf bank_mask:0xc
    v_add_f32_dpp v214, v206, v206 row_ror:8 row_mask:0xf bank_mask:0xc
    v_add_f32_dpp v215, v207, v207 row_ror:8 row_mask:0xf bank_mask:0xc
    v_add_f32_dpp v192, v208, v208 row_half_mirror row_mask:0xf bank_mask:0x5
    v_add_f32_dpp v193, v209, v209 row_half_mirror row_mask:0xf bank_mask:0x5
    v_add_f32_dpp v194, v210, v210 row_half_mirror row_mask:0xf bank_mask:0x5
    v_add_f32_dpp v195, v211, v211 row_half_mirror row_mask:0xf bank_mask:0x5
    v_add_f32_dpp v192, v212, v212 row_half_mirror row_mask:0xf bank_mask:0xa
    v_add_f32_dpp v193, v213, v213 row_half_mirror row_mask:0xf bank_mask:0xa
    v_add_f32_dpp v194, v214, v214 row_half_mirror row_mask:0xf bank_mask:0xa
    v_add_f32_dpp v195, v215, v215 row_half_mirror row_mask:0xf bank_mask:0xa
    v_add_f32_dpp v192, v192, v192 quad_perm:[1,0,3,2] row_mask:0xf bank_mask:0xf
    v_add_f32_dpp v193, v193, v193 quad_perm:[1,0,3,2] row_mask:0xf bank_mask:0xf
    v_add_f32_dpp v194, v194, v194 quad_perm:[1,0,3,2] row_mask:0xf bank_mask:0xf
    v_add_f32_dpp v195, v195, v195 quad_perm:[1,0,3,2] row_mask:0xf bank_mask:0xf
    v_add_f32_dpp v192, v192, v192 quad_perm:[2,3,0,1] row_mask:0xf bank_mask:0xf
    v_add_f32_dpp v193, v193, v193 quad_perm:[2,3,0,1] row_mask:0xf bank_mask:0xf
    v_add_f32_dpp v194, v194, v194 quad_perm:[2,3,0,1] row_mask:0xf bank_mask:0xf
    v_add_f32_dpp v195, v195, v195 quad_perm:[2,3,0,1] row_mask:0xf bank_mask:0xf
    s_mov_b32 exec_lo, 0x11111111
    s_mov_b32 exec_hi, 0x11111111
    s_cmp_eq_u32 s47, 0
    s_cbranch_scc1 Lsfast_35
    buffer_store_dwordx4 v[192:195], v33, s[4:7], s71 offen sc1
    s_branch Lsdone_36
Lsfast_35:
    buffer_store_dwordx4 v[192:195], v33, s[4:7], s71 offen
Lsdone_36:
    s_mov_b64 exec, -1
    ds_read_b128 v[104:107], v2 offset:28672
    ds_read_b128 v[108:111], v2 offset:29696
    ds_read_b128 v[112:115], v2 offset:30720
    ds_read_b128 v[116:119], v2 offset:31744
    ds_read_b128 v[120:123], v2 offset:32768
    ds_read_b128 v[124:127], v2 offset:33792
    ds_read_b128 v[128:131], v2 offset:34816
    ds_read_b128 v[132:135], v2 offset:35840
    ds_read_b128 v[136:139], v2 offset:36864
    s_waitcnt lgkmcnt(8)
    v_mfma_f32_16x16x32_bf16 v[64:67], v[104:107], a[0:3], 0
    v_mfma_f32_16x16x32_bf16 v[68:71], v[104:107], a[4:7], 0
    ds_read_b128 v[140:143], v2 offset:37888
    s_waitcnt lgkmcnt(8)
    v_mfma_f32_16x16x32_bf16 v[72:75], v[108:111], a[0:3], 0
    v_mfma_f32_16x16x32_bf16 v[76:79], v[108:111], a[4:7], 0
    ds_read_b128 v[104:107], v2 offset:38912
    s_waitcnt lgkmcnt(8)
    v_mfma_f32_16x16x32_bf16 v[80:83], v[112:115], a[0:3], 0
    v_mfma_f32_16x16x32_bf16 v[84:87], v[112:115], a[4:7], 0
    ds_read_b128 v[108:111], v2 offset:39936
    s_waitcnt lgkmcnt(8)
    v_mfma_f32_16x16x32_bf16 v[64:67], v[116:119], a[8:11], v[64:67]
    v_mfma_f32_16x16x32_bf16 v[68:71], v[116:119], a[12:15], v[68:71]
    ds_read_b128 v[112:115], v2 offset:40960
    s_waitcnt lgkmcnt(8)
    v_mfma_f32_16x16x32_bf16 v[72:75], v[120:123], a[8:11], v[72:75]
    v_mfma_f32_16x16x32_bf16 v[76:79], v[120:123], a[12:15], v[76:79]
    ds_read_b128 v[116:119], v2 offset:41984
    s_waitcnt lgkmcnt(8)
    v_mfma_f32_16x16x32_bf16 v[80:83], v[124:127], a[8:11], v[80:83]
    v_mfma_f32_16x16x32_bf16 v[84:87], v[124:127], a[12:15], v[84:87]
    ds_read_b128 v[120:123], v2 offset:43008
    s_waitcnt lgkmcnt(8)
    v_mfma_f32_16x16x32_bf16 v[64:67], v[128:131], a[16:19], v[64:67]
    v_mfma_f32_16x16x32_bf16 v[68:71], v[128:131], a[20:23], v[68:71]
    ds_read_b128 v[124:127], v2 offset:44032
    s_waitcnt lgkmcnt(8)
    v_mfma_f32_16x16x32_bf16 v[72:75], v[132:135], a[16:19], v[72:75]
    v_mfma_f32_16x16x32_bf16 v[76:79], v[132:135], a[20:23], v[76:79]
    ds_read_b128 v[128:131], v2 offset:45056
    s_waitcnt lgkmcnt(8)
    v_mfma_f32_16x16x32_bf16 v[80:83], v[136:139], a[16:19], v[80:83]
    buffer_load_dwordx4 v[208:211], v1, s[4:7], s66 offen offset:0 sc1
    buffer_load_dwordx4 v[212:215], v1, s[4:7], s66 offen offset:1024 sc1
    buffer_load_dwordx4 v[216:219], v1, s[4:7], s66 offen offset:2048 sc1
    buffer_load_dwordx4 v[220:223], v1, s[4:7], s66 offen offset:3072 sc1
    v_mfma_f32_16x16x32_bf16 v[84:87], v[136:139], a[20:23], v[84:87]
    ds_read_b128 v[132:135], v2 offset:46080
    s_waitcnt lgkmcnt(8)
    v_mfma_f32_16x16x32_bf16 v[64:67], v[140:143], a[24:27], v[64:67]
    s_add_u32 s80, s77, 114688
    s_add_u32 m0, s70, 7168
    s_nop 0
    buffer_load_dwordx4 v103, s[24:27], s80 offen lds
    v_mfma_f32_16x16x32_bf16 v[68:71], v[140:143], a[28:31], v[68:71]
    ds_read_b128 v[136:139], v2 offset:47104
    s_waitcnt lgkmcnt(8)
    v_mfma_f32_16x16x32_bf16 v[72:75], v[104:107], a[24:27], v[72:75]
    s_add_u32 s77, s76, 256
    s_and_b32 s77, s77, 1023
    s_add_u32 s77, s77, s79
    s_add_u32 s80, s77, 0
    s_add_u32 m0, s70, 32768
    s_nop 0
    buffer_load_dwordx4 v100, s[24:27], s80 offen lds
    v_mfma_f32_16x16x32_bf16 v[76:79], v[104:107], a[28:31], v[76:79]
    ds_read_b128 v[140:143], v2 offset:48128
    s_waitcnt lgkmcnt(8)
    v_mfma_f32_16x16x32_bf16 v[80:83], v[108:111], a[24:27], v[80:83]
    s_add_u32 s80, s77, 16384
    s_add_u32 m0, s70, 33792
    s_nop 0
    buffer_load_dwordx4 v101, s[24:27], s80 offen lds
    v_mfma_f32_16x16x32_bf16 v[84:87], v[108:111], a[28:31], v[84:87]
    ds_read_b128 v[104:107], v2 offset:49152
    s_waitcnt lgkmcnt(8)
    v_mfma_f32_16x16x32_bf16 v[64:67], v[112:115], a[32:35], v[64:67]
    s_add_u32 s80, s77, 32768
    s_add_u32 m0, s70, 34816
    s_nop 0
    buffer_load_dwordx4 v102, s[24:27], s80 offen lds
    v_mfma_f32_16x16x32_bf16 v[68:71], v[112:115], a[36:39], v[68:71]
    ds_read_b128 v[108:111], v2 offset:50176
    s_waitcnt lgkmcnt(8)
    v_mfma_f32_16x16x32_bf16 v[72:75], v[116:119], a[32:35], v[72:75]
    s_add_u32 s80, s77, 49152
    s_add_u32 m0, s70, 35840
    s_nop 0
    buffer_load_dwordx4 v103, s[24:27], s80 offen lds
    v_mfma_f32_16x16x32_bf16 v[76:79], v[116:119], a[36:39], v[76:79]
    ds_read_b128 v[112:115], v2 offset:51200
    s_waitcnt lgkmcnt(8)
    v_mfma_f32_16x16x32_bf16 v[80:83], v[120:123], a[32:35], v[80:83]
    s_add_u32 s80, s77, 65536
    s_add_u32 m0, s70, 36864
    s_nop 0
    buffer_load_dwordx4 v100, s[24:27], s80 offen lds
    v_mfma_f32_16x16x32_bf16 v[84:87], v[120:123], a[36:39], v[84:87]
    ds_read_b128 v[116:119], v2 offset:52224
    s_waitcnt lgkmcnt(8)
    v_mfma_f32_16x16x32_bf16 v[64:67], v[124:127], a[40:43], v[64:67]
    s_add_u32 s80, s77, 81920
    s_add_u32 m0, s70, 37888
    s_nop 0
    buffer_load_dwordx4 v101, s[24:27], s80 offen lds
    v_mfma_f32_16x16x32_bf16 v[68:71], v[124:127], a[44:47], v[68:71]
    ds_read_b128 v[120:123], v2 offset:53248
    s_waitcnt lgkmcnt(8)
    v_mfma_f32_16x16x32_bf16 v[72:75], v[128:131], a[40:43], v[72:75]
    s_add_u32 s80, s77, 98304
    s_add_u32 m0, s70, 38912
    s_nop 0
    buffer_load_dwordx4 v102, s[24:27], s80 offen lds
    v_mfma_f32_16x16x32_bf16 v[76:79], v[128:131], a[44:47], v[76:79]
    ds_read_b128 v[124:127], v2 offset:54272
    s_waitcnt lgkmcnt(8)
    v_mfma_f32_16x16x32_bf16 v[80:83], v[132:135], a[40:43], v[80:83]
    s_add_u32 s80, s77, 114688
    s_add_u32 m0, s70, 39936
    s_nop 0
    buffer_load_dwordx4 v103, s[24:27], s80 offen lds
    v_mfma_f32_16x16x32_bf16 v[84:87], v[132:135], a[44:47], v[84:87]
    ds_read_b128 v[128:131], v2 offset:55296
    s_waitcnt lgkmcnt(8)
    v_mfma_f32_16x16x32_bf16 v[64:67], v[136:139], a[48:51], v[64:67]
    v_mfma_f32_16x16x32_bf16 v[68:71], v[136:139], a[52:55], v[68:71]
    ds_read_b128 v[132:135], v2 offset:56320
    s_waitcnt lgkmcnt(8)
    v_mfma_f32_16x16x32_bf16 v[72:75], v[140:143], a[48:51], v[72:75]
    v_mfma_f32_16x16x32_bf16 v[76:79], v[140:143], a[52:55], v[76:79]
    ds_read_b128 v[136:139], v2 offset:57344
    s_waitcnt lgkmcnt(8)
    v_mfma_f32_16x16x32_bf16 v[80:83], v[104:107], a[48:51], v[80:83]
    v_mfma_f32_16x16x32_bf16 v[84:87], v[104:107], a[52:55], v[84:87]
    ds_read_b128 v[140:143], v2 offset:58368
    s_waitcnt lgkmcnt(8)
    v_mfma_f32_16x16x32_bf16 v[64:67], v[108:111], a[56:59], v[64:67]
    v_mfma_f32_16x16x32_bf16 v[68:71], v[108:111], a[60:63], v[68:71]
    ds_read_b128 v[104:107], v2 offset:59392
    s_waitcnt lgkmcnt(8)
    v_mfma_f32_16x16x32_bf16 v[72:75], v[112:115], a[56:59], v[72:75]
    v_mfma_f32_16x16x32_bf16 v[76:79], v[112:115], a[60:63], v[76:79]
    ds_read_b128 v[108:111], v2 offset:60416
    s_waitcnt lgkmcnt(8)
    v_mfma_f32_16x16x32_bf16 v[80:83], v[116:119], a[56:59], v[80:83]
    s_waitcnt vmcnt(25)
    s_barrier
    v_mfma_f32_16x16x32_bf16 v[84:87], v[116:119], a[60:63], v[84:87]
    ds_read_b128 v[112:115], v2 offset:61440
    s_waitcnt lgkmcnt(8)
    v_mfma_f32_16x16x32_bf16 v[64:67], v[120:123], a[64:67], v[64:67]
    s_mov_b32 s82, 0
    s_waitcnt vmcnt(9)
Lchk_37:
    v_max_u32 v34, v208, v209
    v_max3_u32 v34, v210, v211, v34
    v_max3_u32 v34, v212, v213, v34
    v_max3_u32 v34, v214, v215, v34
    v_max3_u32 v34, v216, v217, v34
    v_max3_u32 v34, v218, v219, v34
    v_max3_u32 v34, v220, v221, v34
    v_max3_u32 v34, v222, v223, v34
    v_cmp_eq_u32 vcc, -1, v34
    s_add_u32 s82, s82, 1
    s_cmp_eq_u64 vcc, 0
    s_cbranch_scc1 Lok_38
    s_cmp_ge_u32 s82, 200000
    s_cbranch_scc1 LEND
    buffer_load_dwordx4 v[208:211], v1, s[4:7], s66 offen offset:0 sc1
    buffer_load_dwordx4 v[212:215], v1, s[4:7], s66 offen offset:1024 sc1
    buffer_load_dwordx4 v[216:219], v1, s[4:7], s66 offen offset:2048 sc1
    buffer_load_dwordx4 v[220:223], v1, s[4:7], s66 offen offset:3072 sc1
    s_waitcnt vmcnt(0)
    s_branch Lchk_37
Lok_38:
    v_pk_add_f32 v[208:209], v[208:209], v[212:213] op_sel:[0,0] op_sel_hi:[1,1]
    v_pk_add_f32 v[216:217], v[216:217], v[220:221] op_sel:[0,0] op_sel_hi:[1,1]
    v_pk_add_f32 v[210:211], v[210:211], v[214:215] op_sel:[0,0] op_sel_hi:[1,1]
    v_pk_add_f32 v[218:219], v[218:219], v[222:223] op_sel:[0,0] op_sel_hi:[1,1]
    v_pk_add_f32 v[208:209], v[208:209], v[216:217] op_sel:[0,0] op_sel_hi:[1,1]
    v_pk_add_f32 v[210:211], v[210:211], v[218:219] op_sel:[0,0] op_sel_hi:[1,1]
    v_mov_b32 v212, v208
    v_mov_b32 v213, v209
    v_mov_b32 v214, v210
    v_mov_b32 v215, v211
    v_permlane16_swap_b32 v208, v212
    v_permlane16_swap_b32 v209, v213
    v_permlane16_swap_b32 v210, v214
    v_permlane16_swap_b32 v211, v215
    v_add_f32 v208, v208, v212
    v_add_f32 v209, v209, v213
    v_add_f32 v210, v210, v214
    v_add_f32 v211, v211, v215
    v_mov_b32 v212, v208
    v_mov_b32 v213, v209
    v_mov_b32 v214, v210
    v_mov_b32 v215, v211
    v_permlane32_swap_b32 v208, v212
    v_permlane32_swap_b32 v209, v213
    v_permlane32_swap_b32 v210, v214
    v_permlane32_swap_b32 v211, v215
    v_add_f32 v208, v208, v212
    v_add_f32 v209, v209, v213
    v_add_f32 v210, v210, v214
    v_add_f32 v211, v211, v215
    v_mov_b32_dpp v212, v208 row_ror:8 row_mask:0xf bank_mask:0xf
    v_mov_b32_dpp v213, v209 row_ror:8 row_mask:0xf bank_mask:0xf
    v_mov_b32_dpp v214, v210 row_ror:8 row_mask:0xf bank_mask:0xf
    v_mov_b32_dpp v215, v211 row_ror:8 row_mask:0xf bank_mask:0xf
    s_mov_b32 s60, 0xbaaaaaab
    s_mov_b32 s61, 0x3aaaaaab
    v_mul_f32 v208, s60, v208
    v_mul_f32 v209, s60, v209
    v_mul_f32 v210, s60, v210
    v_mul_f32 v211, s60, v211
    v_mul_f32 v216, v208, v208
    v_mul_f32 v217, v209, v209
    v_mul_f32 v218, v210, v210
    v_mul_f32 v219, v211, v211
    v_fma_f32 v212, v212, s61, -v216
    v_fma_f32 v213, v213, s61, -v217
    v_fma_f32 v214, v214, s61, -v218
    v_fma_f32 v215, v215, s61, -v219
    v_max_f32 v212, 0, v212
    v_max_f32 v213, 0, v213
    v_max_f32 v214, 0, v214
    v_max_f32 v215, 0, v215
    v_add_f32 v212, 0x3727c5ac, v212
    v_add_f32 v213, 0x3727c5ac, v213
    v_add_f32 v214, 0x3727c5ac, v214
    v_add_f32 v215, 0x3727c5ac, v215
    v_rsq_f32 v212, v212
    v_rsq_f32 v213, v213
    v_rsq_f32 v214, v214
    v_rsq_f32 v215, v215
    v_mul_f32 v208, v208, v212
    v_mul_f32 v209, v209, v213
    v_mul_f32 v210, v210, v214
    v_mul_f32 v211, v211, v215
    s_mov_b64 exec, 0xff
    ds_write_b128 v98, v[208:211]
    ds_write_b128 v98, v[212:215] offset:128
    s_mov_b64 exec, -1
    ds_read_b128 v[144:147], v32 offset:0
    ds_read_b128 v[88:91], v32 offset:128
    ds_read_b128 v[148:151], v32 offset:16
    ds_read_b128 v[92:95], v32 offset:144
    s_waitcnt lgkmcnt(0)
    v_pk_fma_f32 v[40:41], v[40:41], v[88:89], v[144:145] op_sel:[0,0,0] op_sel_hi:[1,1,1]
    v_pk_fma_f32 v[42:43], v[42:43], v[90:91], v[146:147] op_sel:[0,0,0] op_sel_hi:[1,1,1]
    v_pk_fma_f32 v[44:45], v[44:45], v[92:93], v[148:149] op_sel:[0,0,0] op_sel_hi:[1,1,1]
    v_pk_fma_f32 v[46:47], v[46:47], v[94:95], v[150:151] op_sel:[0,0,0] op_sel_hi:[1,1,1]
    v_cvt_pk_bf16_f32 v192, v40, v41
    v_cvt_pk_bf16_f32 v193, v42, v43
    v_cvt_pk_bf16_f32 v194, v44, v45
    v_cvt_pk_bf16_f32 v195, v46, v47
    buffer_store_dwordx4 v[192:195], v1, s[4:7], s73 offen offset:0 sc1
    v_pk_fma_f32 v[48:49], v[48:49], v[88:89], v[144:145] op_sel:[0,0,0] op_sel_hi:[1,1,1]
    v_pk_fma_f32 v[50:51], v[50:51], v[90:91], v[146:147] op_sel:[0,0,0] op_sel_hi:[1,1,1]
    v_pk_fma_f32 v[52:53], v[52:53], v[92:93], v[148:149] op_sel:[0,0,0] op_sel_hi:[1,1,1]
    v_pk_fma_f32 v[54:55], v[54:55], v[94:95], v[150:151] op_sel:[0,0,0] op_sel_hi:[1,1,1]
    v_cvt_pk_bf16_f32 v196, v48, v49
    v_cvt_pk_bf16_f32 v197, v50, v51
    v_cvt_pk_bf16_f32 v198, v52, v53
    v_cvt_pk_bf16_f32 v199, v54, v55
    buffer_store_dwordx4 v[196:199], v1, s[4:7], s73 offen offset:1024 sc1
    v_pk_fma_f32 v[56:57], v[56:57], v[88:89], v[144:145] op_sel:[0,0,0] op_sel_hi:[1,1,1]
    v_pk_fma_f32 v[58:59], v[58:59], v[90:91], v[146:147] op_sel:[0,0,0] op_sel_hi:[1,1,1]
    v_pk_fma_f32 v[60:61], v[60:61], v[92:93], v[148:149] op_sel:[0,0,0] op_sel_hi:[1,1,1]
    v_pk_fma_f32 v[62:63], v[62:63], v[94:95], v[150:151] op_sel:[0,0,0] op_sel_hi:[1,1,1]
    v_cvt_pk_bf16_f32 v200, v56, v57
    v_cvt_pk_bf16_f32 v201, v58, v59
    v_cvt_pk_bf16_f32 v202, v60, v61
    v_cvt_pk_bf16_f32 v203, v62, v63
    buffer_store_dwordx4 v[200:203], v1, s[4:7], s73 offen offset:2048 sc1
    v_mfma_f32_16x16x32_bf16 v[68:71], v[120:123], a[68:71], v[68:71]
    ds_read_b128 v[116:119], v2 offset:62464
    v_mfma_f32_16x16x32_bf16 v[72:75], v[124:127], a[64:67], v[72:75]
    s_cmp_eq_u32 s48, 0
    s_cbranch_scc0 Ll0_39
    s_waitcnt vmcnt(3)
    ds_read_b128 a[160:163], v152 offset:0
    ds_read_b128 a[164:167], v153 offset:0
    ds_read_b128 a[168:171], v154 offset:0
    ds_read_b128 a[172:175], v155 offset:0
    ds_read_b128 a[176:179], v156 offset:0
    ds_read_b128 a[180:183], v157 offset:0
    ds_read_b128 a[184:187], v158 offset:0
    ds_read_b128 a[188:191], v159 offset:0
Ll0_39:
    v_mfma_f32_16x16x32_bf16 v[76:79], v[124:127], a[68:71], v[76:79]
    ds_read_b128 v[120:123], v2 offset:63488
    v_mfma_f32_16x16x32_bf16 v[80:83], v[128:131], a[64:67], v[80:83]
    v_mfma_f32_16x16x32_bf16 v[84:87], v[128:131], a[68:71], v[84:87]
    ds_read_b128 v[124:127], v2 offset:64512
    v_mfma_f32_16x16x32_bf16 v[64:67], v[132:135], a[72:75], v[64:67]
    v_mfma_f32_16x16x32_bf16 v[68:71], v[132:135], a[76:79], v[68:71]
    ds_read_b128 v[128:131], v3 offset:0
    v_mfma_f32_16x16x32_bf16 v[72:75], v[136:139], a[72:75], v[72:75]
    s_cmp_eq_u32 s48, 0
    s_cbranch_scc0 Ll0_40
    ds_read_b128 a[192:195], v152 offset:32768
    ds_read_b128 a[196:199], v153 offset:32768
    ds_read_b128 a[200:203], v154 offset:32768
    s_waitcnt lgkmcnt(14)
    ds_read_b128 a[204:207], v155 offset:32768
    s_waitcnt lgkmcnt(14)
    ds_read_b128 a[208:211], v156 offset:32768
    s_waitcnt lgkmcnt(14)
    ds_read_b128 a[212:215], v157 offset:32768
    s_waitcnt lgkmcnt(14)
    ds_read_b128 a[216:219], v158 offset:32768
    s_waitcnt lgkmcnt(14)
    ds_read_b128 a[220:223], v159 offset:32768
Ll0_40:
    v_mfma_f32_16x16x32_bf16 v[76:79], v[136:139], a[76:79], v[76:79]
    s_waitcnt lgkmcnt(14)
    ds_read_b128 v[132:135], v3 offset:1024
    v_mfma_f32_16x16x32_bf16 v[80:83], v[140:143], a[72:75], v[80:83]
    v_mfma_f32_16x16x32_bf16 v[84:87], v[140:143], a[76:79], v[84:87]
    s_waitcnt lgkmcnt(14)
    ds_read_b128 v[136:139], v3 offset:2048
    v_mfma_f32_16x16x32_bf16 v[64:67], v[104:107], a[80:83], v[64:67]
    v_mfma_f32_16x16x32_bf16 v[68:71], v[104:107], a[84:87], v[68:71]
    s_waitcnt lgkmcnt(14)
    ds_read_b128 v[140:143], v3 offset:3072
    v_mfma_f32_16x16x32_bf16 v[72:75], v[108:111], a[80:83], v[72:75]
    s_cmp_eq_u32 s48, 0
    s_cbranch_scc0 Ll0_41
    s_waitcnt lgkmcnt(3)
    s_add_u32 s77, s76, 512
    s_and_b32 s77, s77, 1023
    s_add_u32 s77, s77, s68
    s_add_u32 s80, s77, 0
    s_add_u32 m0, s70, 0
    s_nop 0
    buffer_load_dwordx4 v100, s[24:27], s80 offen lds
    s_add_u32 s80, s77, 16384
    s_add_u32 m0, s70, 1024
    s_nop 0
    buffer_load_dwordx4 v101, s[24:27], s80 offen lds
    s_add_u32 s80, s77, 32768
    s_add_u32 m0, s70, 2048
    s_nop 0
    buffer_load_dwordx4 v102, s[24:27], s80 offen lds
    s_add_u32 s80, s77, 49152
    s_add_u32 m0, s70, 3072
    s_nop 0
    buffer_load_dwordx4 v103, s[24:27], s80 offen lds
    s_add_u32 s80, s77, 65536
    s_add_u32 m0, s70, 4096
    s_nop 0
    buffer_load_dwordx4 v100, s[24:27], s80 offen lds
    s_add_u32 s80, s77, 81920
    s_add_u32 m0, s70, 5120
    s_nop 0
    buffer_load_dwordx4 v101, s[24:27], s80 offen lds
Ll0_41:
    v_mfma_f32_16x16x32_bf16 v[76:79], v[108:111], a[84:87], v[76:79]
    ds_read_b128 v[104:107], v3 offset:4096
    v_mfma_f32_16x16x32_bf16 v[80:83], v[112:115], a[80:83], v[80:83]
    v_mfma_f32_16x16x32_bf16 v[84:87], v[112:115], a[84:87], v[84:87]
    ds_read_b128 v[108:111], v3 offset:5120
    s_waitcnt lgkmcnt(8)
    v_mfma_f32_16x16x32_bf16 v[64:67], v[116:119], a[88:91], v[64:67]
    v_mfma_f32_16x16x32_bf16 v[68:71], v[116:119], a[92:95], v[68:71]
    ds_read_b128 v[112:115], v3 offset:6144
    s_waitcnt lgkmcnt(8)
    v_mfma_f32_16x16x32_bf16 v[72:75], v[120:123], a[88:91], v[72:75]
    s_cmp_eq_u32 s48, 0
    s_cbranch_scc0 Ll0_42
    s_add_u32 s80, s77, 98304
    s_add_u32 m0, s70, 6144
    s_nop 0
    buffer_load_dwordx4 v102, s[24:27], s80 offen lds
    s_add_u32 s80, s77, 114688
    s_add_u32 m0, s70, 7168
    s_nop 0
    buffer_load_dwordx4 v103, s[24:27], s80 offen lds
    s_add_u32 s77, s76, 768
    s_and_b32 s77, s77, 1023
    s_add_u32 s77, s77, s68
    s_add_u32 s80, s77, 0
    s_add_u32 m0, s70, 32768
    s_nop 0
    buffer_load_dwordx4 v100, s[24:27], s80 offen lds
    s_add_u32 s80, s77, 16384
    s_add_u32 m0, s70, 33792
    s_nop 0
    buffer_load_dwordx4 v101, s[24:27], s80 offen lds
    s_add_u32 s80, s77, 32768
    s_add_u32 m0, s70, 34816
    s_nop 0
    buffer_load_dwordx4 v102, s[24:27], s80 offen lds
Ll0_42:
    v_mfma_f32_16x16x32_bf16 v[76:79], v[120:123], a[92:95], v[76:79]
    ds_read_b128 v[116:119], v3 offset:7168
    s_waitcnt lgkmcnt(8)
    v_mfma_f32_16x16x32_bf16 v[80:83], v[124:127], a[88:91], v[80:83]
    v_mfma_f32_16x16x32_bf16 v[84:87], v[124:127], a[92:95], v[84:87]
    ds_read_b128 v[120:123], v3 offset:8192
    s_waitcnt lgkmcnt(8)
    v_mfma_f32_16x16x32_bf16 v[64:67], v[128:131], a[96:99], v[64:67]
    v_mfma_f32_16x16x32_bf16 v[68:71], v[128:131], a[100:103], v[68:71]
    ds_read_b128 v[124:127], v3 offset:9216
    s_waitcnt lgkmcnt(8)
    v_mfma_f32_16x16x32_bf16 v[72:75], v[132:135], a[96:99], v[72:75]
    s_cmp_eq_u32 s48, 0
    s_cbranch_scc0 Ll0_43
    s_add_u32 s80, s77, 49152
    s_add_u32 m0, s70, 35840
    s_nop 0
    buffer_load_dwordx4 v103, s[24:27], s80 offen lds
    s_add_u32 s80, s77, 65536
    s_add_u32 m0, s70, 36864
    s_nop 0
    buffer_load_dwordx4 v100, s[24:27], s80 offen lds
    s_add_u32 s80, s77, 81920
    s_add_u32 m0, s70, 37888
    s_nop 0
    buffer_load_dwordx4 v101, s[24:27], s80 offen lds
    s_add_u32 s80, s77, 98304
    s_add_u32 m0, s70, 38912
    s_nop 0
    buffer_load_dwordx4 v102, s[24:27], s80 offen lds
    s_add_u32 s80, s77, 114688
    s_add_u32 m0, s70, 39936
    s_nop 0
    buffer_load_dwordx4 v103, s[24:27], s80 offen lds
Ll0_43:
    v_mfma_f32_16x16x32_bf16 v[76:79], v[132:135], a[100:103], v[76:79]
    ds_read_b128 v[128:131], v3 offset:10240
    s_waitcnt lgkmcnt(8)
    v_mfma_f32_16x16x32_bf16 v[80:83], v[136:139], a[96:99], v[80:83]
    s_add_u32 s77, s76, 512
    s_and_b32 s77, s77, 1023
    s_add_u32 s77, s77, s69
    s_add_u32 s80, s77, 0
    s_add_u32 m0, s70, 65536
    s_nop 0
    buffer_load_dwordx4 v100, s[24:27], s80 offen lds
    v_mfma_f32_16x16x32_bf16 v[84:87], v[136:139], a[100:103], v[84:87]
    ds_read_b128 v[132:135], v3 offset:11264
    s_waitcnt lgkmcnt(8)
    v_mfma_f32_16x16x32_bf16 v[64:67], v[140:143], a[104:107], v[64:67]
    s_add_u32 s80, s77, 16384
    s_add_u32 m0, s70, 66560
    s_nop 0
    buffer_load_dwordx4 v101, s[24:27], s80 offen lds
    v_mfma_f32_16x16x32_bf16 v[68:71], v[140:143], a[108:111], v[68:71]
    ds_read_b128 v[136:139], v3 offset:12288
    s_waitcnt lgkmcnt(8)
    v_mfma_f32_16x16x32_bf16 v[72:75], v[104:107], a[104:107], v[72:75]
    s_add_u32 s80, s77, 32768
    s_add_u32 m0, s70, 67584
    s_nop 0
    buffer_load_dwordx4 v102, s[24:27], s80 offen lds
    v_mfma_f32_16x16x32_bf16 v[76:79], v[104:107], a[108:111], v[76:79]
    ds_read_b128 v[140:143], v3 offset:13312
    s_waitcnt lgkmcnt(8)
    v_mfma_f32_16x16x32_bf16 v[80:83], v[108:111], a[104:107], v[80:83]
    s_add_u32 s80, s77, 49152
    s_add_u32 m0, s70, 68608
    s_nop 0
    buffer_load_dwordx4 v103, s[24:27], s80 offen lds
    v_mfma_f32_16x16x32_bf16 v[84:87], v[108:111], a[108:111], v[84:87]
    ds_read_b128 v[104:107], v3 offset:14336
    s_waitcnt lgkmcnt(8)
    v_mfma_f32_16x16x32_bf16 v[64:67], v[112:115], a[112:115], v[64:67]
    s_add_u32 s80, s77, 65536
    s_add_u32 m0, s70, 69632
    s_nop 0
    buffer_load_dwordx4 v100, s[24:27], s80 offen lds
    v_mfma_f32_16x16x32_bf16 v[68:71], v[112:115], a[116:119], v[68:71]
    ds_read_b128 v[108:111], v3 offset:15360
    s_waitcnt lgkmcnt(8)
    v_mfma_f32_16x16x32_bf16 v[72:75], v[116:119], a[112:115], v[72:75]
    s_add_u32 s80, s77, 81920
    s_add_u32 m0, s70, 70656
    s_nop 0
    buffer_load_dwordx4 v101, s[24:27], s80 offen lds
    v_mfma_f32_16x16x32_bf16 v[76:79], v[116:119], a[116:119], v[76:79]
    ds_read_b128 v[112:115], v3 offset:16384
    s_waitcnt lgkmcnt(8)
    v_mfma_f32_16x16x32_bf16 v[80:83], v[120:123], a[112:115], v[80:83]
    s_add_u32 s80, s77, 98304
    s_add_u32 m0, s70, 71680
    s_nop 0
    buffer_load_dwordx4 v102, s[24:27], s80 offen lds
    v_mfma_f32_16x16x32_bf16 v[84:87], v[120:123], a[116:119], v[84:87]
    ds_read_b128 v[116:119], v3 offset:17408
    s_waitcnt lgkmcnt(8)
    v_mfma_f32_16x16x32_bf16 v[64:67], v[124:127], a[120:123], v[64:67]
    s_add_u32 s80, s77, 114688
    s_add_u32 m0, s70, 72704
    s_nop 0
    buffer_load_dwordx4 v103, s[24:27], s80 offen lds
    v_mfma_f32_16x16x32_bf16 v[68:71], v[124:127], a[124:127], v[68:71]
    ds_read_b128 v[120:123], v3 offset:18432
    s_waitcnt lgkmcnt(8)
    v_mfma_f32_16x16x32_bf16 v[72:75], v[128:131], a[120:123], v[72:75]
    v_mfma_f32_16x16x32_bf16 v[76:79], v[128:131], a[124:127], v[76:79]
    ds_read_b128 v[124:127], v3 offset:19456
    s_waitcnt lgkmcnt(8)
    v_mfma_f32_16x16x32_bf16 v[80:83], v[132:135], a[120:123], v[80:83]
    v_mfma_f32_16x16x32_bf16 v[84:87], v[132:135], a[124:127], v[84:87]
    ds_read_b128 v[128:131], v3 offset:20480
    s_waitcnt lgkmcnt(8)
    v_mfma_f32_16x16x32_bf16 v[64:67], v[136:139], a[128:131], v[64:67]
    s_barrier
    v_mfma_f32_16x16x32_bf16 v[68:71], v[136:139], a[132:135], v[68:71]
    ds_read_b128 v[132:135], v3 offset:21504
    s_waitcnt lgkmcnt(8)
    v_mfma_f32_16x16x32_bf16 v[72:75], v[140:143], a[128:131], v[72:75]
    v_mfma_f32_16x16x32_bf16 v[76:79], v[140:143], a[132:135], v[76:79]
    ds_read_b128 v[136:139], v3 offset:22528
    s_waitcnt lgkmcnt(8)
    v_mfma_f32_16x16x32_bf16 v[80:83], v[104:107], a[128:131], v[80:83]
    s_add_u32 s77, s76, 768
    s_and_b32 s77, s77, 1023
    s_add_u32 s77, s77, s69
    s_add_u32 s80, s77, 0
    s_add_u32 m0, s70, 98304
    s_nop 0
    buffer_load_dwordx4 v100, s[24:27], s80 offen lds
    v_mfma_f32_16x16x32_bf16 v[84:87], v[104:107], a[132:135], v[84:87]
    ds_read_b128 v[140:143], v3 offset:23552
    s_waitcnt lgkmcnt(8)
    v_mfma_f32_16x16x32_bf16 v[64:67], v[108:111], a[136:139], v[64:67]
    s_add_u32 s80, s77, 16384
    s_add_u32 m0, s70, 99328
    s_nop 0
    buffer_load_dwordx4 v101, s[24:27], s80 offen lds
    v_mfma_f32_16x16x32_bf16 v[68:71], v[108:111], a[140:143], v[68:71]
    s_waitcnt lgkmcnt(7)
    v_mfma_f32_16x16x32_bf16 v[72:75], v[112:115], a[136:139], v[72:75]
    s_add_u32 s80, s77, 32768
    s_add_u32 m0, s70, 100352
    s_nop 0
    buffer_load_dwordx4 v102, s[24:27], s80 offen lds
    v_mfma_f32_16x16x32_bf16 v[76:79], v[112:115], a[140:143], v[76:79]
    s_waitcnt lgkmcnt(6)
    v_mfma_f32_16x16x32_bf16 v[80:83], v[116:119], a[136:139], v[80:83]
    s_add_u32 s80, s77, 49152
    s_add_u32 m0, s70, 101376
    s_nop 0
    buffer_load_dwordx4 v103, s[24:27], s80 offen lds
    v_mfma_f32_16x16x32_bf16 v[84:87], v[116:119], a[140:143], v[84:87]
    s_waitcnt lgkmcnt(5)
    v_mfma_f32_16x16x32_bf16 v[64:67], v[120:123], a[144:147], v[64:67]
    s_add_u32 s80, s77, 65536
    s_add_u32 m0, s70, 102400
    s_nop 0
    buffer_load_dwordx4 v100, s[24:27], s80 offen lds
    v_mfma_f32_16x16x32_bf16 v[68:71], v[120:123], a[148:151], v[68:71]
    s_waitcnt lgkmcnt(4)
    v_mfma_f32_16x16x32_bf16 v[72:75], v[124:127], a[144:147], v[72:75]
    s_add_u32 s80, s77, 81920
    s_add_u32 m0, s70, 103424
    s_nop 0
    buffer_load_dwordx4 v101, s[24:27], s80 offen lds
    v_mfma_f32_16x16x32_bf16 v[76:79], v[124:127], a[148:151], v[76:79]
    s_waitcnt lgkmcnt(3)
    v_mfma_f32_16x16x32_bf16 v[80:83], v[128:131], a[144:147], v[80:83]
    s_add_u32 s80, s77, 98304
    s_add_u32 m0, s70, 104448
    s_nop 0
    buffer_load_dwordx4 v102, s[24:27], s80 offen lds
    v_mfma_f32_16x16x32_bf16 v[84:87], v[128:131], a[148:151], v[84:87]
    s_waitcnt lgkmcnt(2)
    v_mfma_f32_16x16x32_bf16 v[64:67], v[132:135], a[152:155], v[64:67]
    s_add_u32 s80, s77, 114688
    s_add_u32 m0, s70, 105472
    s_nop 0
    buffer_load_dwordx4 v103, s[24:27], s80 offen lds
    v_mfma_f32_16x16x32_bf16 v[68:71], v[132:135], a[156:159], v[68:71]
    s_waitcnt lgkmcnt(1)
    v_mfma_f32_16x16x32_bf16 v[72:75], v[136:139], a[152:155], v[72:75]
    v_mfma_f32_16x16x32_bf16 v[76:79], v[136:139], a[156:159], v[76:79]
    s_waitcnt lgkmcnt(0)
    v_mfma_f32_16x16x32_bf16 v[80:83], v[140:143], a[152:155], v[80:83]
    v_mfma_f32_16x16x32_bf16 v[84:87], v[140:143], a[156:159], v[84:87]
    v_pk_fma_f32 v[64:65], v[168:169], v[164:165], v[64:65] op_sel:[0,0,0] op_sel_hi:[1,0,1]
    v_pk_fma_f32 v[66:67], v[170:171], v[164:165], v[66:67] op_sel:[0,0,0] op_sel_hi:[1,0,1]
    v_pk_fma_f32 v[68:69], v[168:169], v[164:165], v[68:69] op_sel:[0,1,0] op_sel_hi:[1,1,1]
    v_pk_fma_f32 v[70:71], v[170:171], v[164:165], v[70:71] op_sel:[0,1,0] op_sel_hi:[1,1,1]
    v_pk_fma_f32 v[72:73], v[172:173], v[164:165], v[72:73] op_sel:[0,0,0] op_sel_hi:[1,0,1]
    v_pk_fma_f32 v[74:75], v[174:175], v[164:165], v[74:75] op_sel:[0,0,0] op_sel_hi:[1,0,1]
    v_pk_fma_f32 v[76:77], v[172:173], v[164:165], v[76:77] op_sel:[0,1,0] op_sel_hi:[1,1,1]
    v_pk_fma_f32 v[78:79], v[174:175], v[164:165], v[78:79] op_sel:[0,1,0] op_sel_hi:[1,1,1]
    v_pk_fma_f32 v[80:81], v[176:177], v[164:165], v[80:81] op_sel:[0,0,0] op_sel_hi:[1,0,1]
    v_pk_fma_f32 v[82:83], v[178:179], v[164:165], v[82:83] op_sel:[0,0,0] op_sel_hi:[1,0,1]
    v_pk_fma_f32 v[84:85], v[176:177], v[164:165], v[84:85] op_sel:[0,1,0] op_sel_hi:[1,1,1]
    v_pk_fma_f32 v[86:87], v[178:179], v[164:165], v[86:87] op_sel:[0,1,0] op_sel_hi:[1,1,1]
    s_waitcnt vmcnt(16) lgkmcnt(0)
    s_barrier
    v_mov_b32 v24, s50
    v_mov_b32 v25, 0
    s_mov_b64 exec, 1
    buffer_store_dword v24, v25, s[4:7], s78 offen sc1
    s_mov_b64 exec, -1
    v_pk_mul_f32 v[64:65], v[64:65], v[166:167] op_sel:[0,0] op_sel_hi:[1,0]
    v_pk_mul_f32 v[66:67], v[66:67], v[166:167] op_sel:[0,0] op_sel_hi:[1,0]
    v_pk_mul_f32 v[204:205], v[64:65], v[64:65] op_sel:[0,0] op_sel_hi:[1,1]
    v_pk_mul_f32 v[206:207], v[66:67], v[66:67] op_sel:[0,0] op_sel_hi:[1,1]
    v_pk_fma_f32 v[204:205], v[204:205], v[16:17], v[16:17] op_sel:[0,1,0] op_sel_hi:[1,1,0]
    v_pk_fma_f32 v[206:207], v[206:207], v[16:17], v[16:17] op_sel:[0,1,0] op_sel_hi:[1,1,0]
    v_pk_mul_f32 v[204:205], v[204:205], v[64:65] op_sel:[0,0] op_sel_hi:[1,1]
    v_pk_mul_f32 v[206:207], v[206:207], v[66:67] op_sel:[0,0] op_sel_hi:[1,1]
    v_exp_f32 v204, v204
    v_exp_f32 v205, v205
    v_exp_f32 v206, v206
    v_exp_f32 v207, v207
    v_pk_add_f32 v[204:205], v[204:205], v[18:19] op_sel:[0,0] op_sel_hi:[1,0]
    v_pk_add_f32 v[206:207], v[206:207], v[18:19] op_sel:[0,0] op_sel_hi:[1,0]
    v_rcp_f32 v204, v204
    v_rcp_f32 v205, v205
    v_rcp_f32 v206, v206
    s_cmp_eq_u32 s48, 0
    s_cbranch_scc0 Ll0_44
    s_waitcnt vmcnt(17)
    ds_read_b128 a[224:227], v152 offset:0
    ds_read_b128 a[228:231], v153 offset:0
    ds_read_b128 a[232:235], v154 offset:0
    ds_read_b128 a[236:239], v155 offset:0
    ds_read_b128 a[240:243], v156 offset:0
    ds_read_b128 a[244:247], v157 offset:0
    ds_read_b128 a[248:251], v158 offset:0
    ds_read_b128 a[252:255], v159 offset:0
    ds_read_b128 v[224:227], v152 offset:32768
    ds_read_b128 v[228:231], v153 offset:32768
    ds_read_b128 v[232:235], v154 offset:32768
    ds_read_b128 v[236:239], v155 offset:32768
    ds_read_b128 v[240:243], v156 offset:32768
    ds_read_b128 v[244:247], v157 offset:32768
    ds_read_b128 v[248:251], v158 offset:32768
    s_waitcnt lgkmcnt(14)
    ds_read_b128 v[252:255], v159 offset:32768
    s_waitcnt lgkmcnt(0)
    s_add_u32 s77, s76, 0
    s_and_b32 s77, s77, 1023
    s_add_u32 s77, s77, s69
    s_add_u32 s80, s77, 0
    s_add_u32 m0, s70, 0
    s_nop 0
    buffer_load_dwordx4 v100, s[24:27], s80 offen lds
    s_add_u32 s80, s77, 16384
    s_add_u32 m0, s70, 1024
    s_nop 0
    buffer_load_dwordx4 v101, s[24:27], s80 offen lds
    s_add_u32 s80, s77, 32768
    s_add_u32 m0, s70, 2048
    s_nop 0
    buffer_load_dwordx4 v102, s[24:27], s80 offen lds
    s_add_u32 s80, s77, 49152
    s_add_u32 m0, s70, 3072
    s_nop 0
    buffer_load_dwordx4 v103, s[24:27], s80 offen lds
Ll0_44:
    v_rcp_f32 v207, v207
    v_pk_mul_f32 v[64:65], v[64:65], v[204:205] op_sel:[0,0] op_sel_hi:[1,1]
    v_pk_mul_f32 v[66:67], v[66:67], v[206:207] op_sel:[0,0] op_sel_hi:[1,1]
    v_pk_mul_f32 v[68:69], v[68:69], v[166:167] op_sel:[0,1] op_sel_hi:[1,1]
    v_pk_mul_f32 v[70:71], v[70:71], v[166:167] op_sel:[0,1] op_sel_hi:[1,1]
    v_pk_mul_f32 v[204:205], v[68:69], v[68:69] op_sel:[0,0] op_sel_hi:[1,1]
    v_pk_mul_f32 v[206:207], v[70:71], v[70:71] op_sel:[0,0] op_sel_hi:[1,1]
    v_pk_fma_f32 v[204:205], v[204:205], v[16:17], v[16:17] op_sel:[0,1,0] op_sel_hi:[1,1,0]
    v_pk_fma_f32 v[206:207], v[206:207], v[16:17], v[16:17] op_sel:[0,1,0] op_sel_hi:[1,1,0]
    v_pk_mul_f32 v[204:205], v[204:205], v[68:69] op_sel:[0,0] op_sel_hi:[1,1]
    v_pk_mul_f32 v[206:207], v[206:207], v[70:71] op_sel:[0,0] op_sel_hi:[1,1]
    v_exp_f32 v204, v204
    v_exp_f32 v205, v205
    v_exp_f32 v206, v206
    v_exp_f32 v207, v207
    v_pk_add_f32 v[204:205], v[204:205], v[18:19] op_sel:[0,0] op_sel_hi:[1,0]
    v_pk_add_f32 v[206:207], v[206:207], v[18:19] op_sel:[0,0] op_sel_hi:[1,0]
    v_rcp_f32 v204, v204
    v_rcp_f32 v205, v205
    v_rcp_f32 v206, v206
    v_rcp_f32 v207, v207
    v_pk_mul_f32 v[68:69], v[68:69], v[204:205] op_sel:[0,0] op_sel_hi:[1,1]
    v_pk_mul_f32 v[70:71], v[70:71], v[206:207] op_sel:[0,0] op_sel_hi:[1,1]
    v_pk_mul_f32 v[72:73], v[72:73], v[166:167] op_sel:[0,0] op_sel_hi:[1,0]
    v_pk_mul_f32 v[74:75], v[74:75], v[166:167] op_sel:[0,0] op_sel_hi:[1,0]
    v_pk_mul_f32 v[204:205], v[72:73], v[72:73] op_sel:[0,0] op_sel_hi:[1,1]
    v_pk_mul_f32 v[206:207], v[74:75], v[74:75] op_sel:[0,0] op_sel_hi:[1,1]
    v_pk_fma_f32 v[204:205], v[204:205], v[16:17], v[16:17] op_sel:[0,1,0] op_sel_hi:[1,1,0]
    v_pk_fma_f32 v[206:207], v[206:207], v[16:17], v[16:17] op_sel:[0,1,0] op_sel_hi:[1,1,0]
    v_pk_mul_f32 v[204:205], v[204:205], v[72:73] op_sel:[0,0] op_sel_hi:[1,1]
    v_pk_mul_f32 v[206:207], v[206:207], v[74:75] op_sel:[0,0] op_sel_hi:[1,1]
    v_exp_f32 v204, v204
    v_exp_f32 v205, v205
    v_exp_f32 v206, v206
    s_cmp_eq_u32 s48, 0
    s_cbranch_scc0 Ll0_45
    s_add_u32 s80, s77, 65536
    s_add_u32 m0, s70, 4096
    s_nop 0
    buffer_load_dwordx4 v100, s[24:27], s80 offen lds
    s_add_u32 s80, s77, 81920
    s_add_u32 m0, s70, 5120
    s_nop 0
    buffer_load_dwordx4 v101, s[24:27], s80 offen lds
    s_add_u32 s80, s77, 98304
    s_add_u32 m0, s70, 6144
    s_nop 0
    buffer_load_dwordx4 v102, s[24:27], s80 offen lds
    s_add_u32 s80, s77, 114688
    s_add_u32 m0, s70, 7168
    s_nop 0
    buffer_load_dwordx4 v103, s[24:27], s80 offen lds
Ll0_45:
    v_exp_f32 v207, v207
    v_pk_add_f32 v[204:205], v[204:205], v[18:19] op_sel:[0,0] op_sel_hi:[1,0]
    v_pk_add_f32 v[206:207], v[206:207], v[18:19] op_sel:[0,0] op_sel_hi:[1,0]
    v_rcp_f32 v204, v204
    v_rcp_f32 v205, v205
    v_rcp_f32 v206, v206
    v_rcp_f32 v207, v207
    v_pk_mul_f32 v[72:73], v[72:73], v[204:205] op_sel:[0,0] op_sel_hi:[1,1]
    v_pk_mul_f32 v[74:75], v[74:75], v[206:207] op_sel:[0,0] op_sel_hi:[1,1]
    v_pk_mul_f32 v[76:77], v[76:77], v[166:167] op_sel:[0,1] op_sel_hi:[1,1]
    v_pk_mul_f32 v[78:79], v[78:79], v[166:167] op_sel:[0,1] op_sel_hi:[1,1]
    v_pk_mul_f32 v[204:205], v[76:77], v[76:77] op_sel:[0,0] op_sel_hi:[1,1]
    v_pk_mul_f32 v[206:207], v[78:79], v[78:79] op_sel:[0,0] op_sel_hi:[1,1]
    v_pk_fma_f32 v[204:205], v[204:205], v[16:17], v[16:17] op_sel:[0,1,0] op_sel_hi:[1,1,0]
    v_pk_fma_f32 v[206:207], v[206:207], v[16:17], v[16:17] op_sel:[0,1,0] op_sel_hi:[1,1,0]
    v_pk_mul_f32 v[204:205], v[204:205], v[76:77] op_sel:[0,0] op_sel_hi:[1,1]
    v_pk_mul_f32 v[206:207], v[206:207], v[78:79] op_sel:[0,0] op_sel_hi:[1,1]
    v_exp_f32 v204, v204
    v_exp_f32 v205, v205
    v_exp_f32 v206, v206
    v_exp_f32 v207, v207
    v_pk_add_f32 v[204:205], v[204:205], v[18:19] op_sel:[0,0] op_sel_hi:[1,0]
    v_pk_add_f32 v[206:207], v[206:207], v[18:19] op_sel:[0,0] op_sel_hi:[1,0]
    v_rcp_f32 v204, v204
    v_rcp_f32 v205, v205
    v_rcp_f32 v206, v206
    v_rcp_f32 v207, v207
    v_pk_mul_f32 v[76:77], v[76:77], v[204:205] op_sel:[0,0] op_sel_hi:[1,1]
    v_pk_mul_f32 v[78:79], v[78:79], v[206:207] op_sel:[0,0] op_sel_hi:[1,1]
    v_pk_mul_f32 v[80:81], v[80:81], v[166:167] op_sel:[0,0] op_sel_hi:[1,0]
    v_pk_mul_f32 v[82:83], v[82:83], v[166:167] op_sel:[0,0] op_sel_hi:[1,0]
    v_pk_mul_f32 v[204:205], v[80:81], v[80:81] op_sel:[0,0] op_sel_hi:[1,1]
    s_cmp_eq_u32 s48, 0
    s_cbranch_scc0 Ll0_46
    s_add_u32 s77, s76, 256
    s_and_b32 s77, s77, 1023
    s_add_u32 s77, s77, s69
    s_add_u32 s80, s77, 0
    s_add_u32 m0, s70, 32768
    s_nop 0
    buffer_load_dwordx4 v100, s[24:27], s80 offen lds
    s_add_u32 s80, s77, 16384
    s_add_u32 m0, s70, 33792
    s_nop 0
    buffer_load_dwordx4 v101, s[24:27], s80 offen lds
    s_add_u32 s80, s77, 32768
    s_add_u32 m0, s70, 34816
    s_nop 0
    buffer_load_dwordx4 v102, s[24:27], s80 offen lds
    s_add_u32 s80, s77, 49152
    s_add_u32 m0, s70, 35840
    s_nop 0
    buffer_load_dwordx4 v103, s[24:27], s80 offen lds
Ll0_46:
    v_pk_mul_f32 v[206:207], v[82:83], v[82:83] op_sel:[0,0] op_sel_hi:[1,1]
    v_pk_fma_f32 v[204:205], v[204:205], v[16:17], v[16:17] op_sel:[0,1,0] op_sel_hi:[1,1,0]
    v_pk_fma_f32 v[206:207], v[206:207], v[16:17], v[16:17] op_sel:[0,1,0] op_sel_hi:[1,1,0]
    v_pk_mul_f32 v[204:205], v[204:205], v[80:81] op_sel:[0,0] op_sel_hi:[1,1]
    v_pk_mul_f32 v[206:207], v[206:207], v[82:83] op_sel:[0,0] op_sel_hi:[1,1]
    v_exp_f32 v204, v204
    v_exp_f32 v205, v205
    v_exp_f32 v206, v206
    v_exp_f32 v207, v207
    v_pk_add_f32 v[204:205], v[204:205], v[18:19] op_sel:[0,0] op_sel_hi:[1,0]
    v_pk_add_f32 v[206:207], v[206:207], v[18:19] op_sel:[0,0] op_sel_hi:[1,0]
    v_rcp_f32 v204, v204
    v_rcp_f32 v205, v205
    v_rcp_f32 v206, v206
    v_rcp_f32 v207, v207
    v_pk_mul_f32 v[80:81], v[80:81], v[204:205] op_sel:[0,0] op_sel_hi:[1,1]
    v_pk_mul_f32 v[82:83], v[82:83], v[206:207] op_sel:[0,0] op_sel_hi:[1,1]
    v_pk_mul_f32 v[84:85], v[84:85], v[166:167] op_sel:[0,1] op_sel_hi:[1,1]
    v_pk_mul_f32 v[86:87], v[86:87], v[166:167] op_sel:[0,1] op_sel_hi:[1,1]
    v_pk_mul_f32 v[204:205], v[84:85], v[84:85] op_sel:[0,0] op_sel_hi:[1,1]
    v_pk_mul_f32 v[206:207], v[86:87], v[86:87] op_sel:[0,0] op_sel_hi:[1,1]
    v_pk_fma_f32 v[204:205], v[204:205], v[16:17], v[16:17] op_sel:[0,1,0] op_sel_hi:[1,1,0]
    v_pk_fma_f32 v[206:207], v[206:207], v[16:17], v[16:17] op_sel:[0,1,0] op_sel_hi:[1,1,0]
    v_pk_mul_f32 v[204:205], v[204:205], v[84:85] op_sel:[0,0] op_sel_hi:[1,1]
    v_pk_mul_f32 v[206:207], v[206:207], v[86:87] op_sel:[0,0] op_sel_hi:[1,1]
    v_exp_f32 v204, v204
    v_exp_f32 v205, v205
    v_exp_f32 v206, v206
    v_exp_f32 v207, v207
    v_pk_add_f32 v[204:205], v[204:205], v[18:19] op_sel:[0,0] op_sel_hi:[1,0]
    v_pk_add_f32 v[206:207], v[206:207], v[18:19] op_sel:[0,0] op_sel_hi:[1,0]
    v_rcp_f32 v204, v204
    s_cmp_eq_u32 s48, 0
    s_cbranch_scc0 Ll0_47
    s_add_u32 s80, s77, 65536
    s_add_u32 m0, s70, 36864
    s_nop 0
    buffer_load_dwordx4 v100, s[24:27], s80 offen lds
    s_add_u32 s80, s77, 81920
    s_add_u32 m0, s70, 37888
    s_nop 0
    buffer_load_dwordx4 v101, s[24:27], s80 offen lds
    s_add_u32 s80, s77, 98304
    s_add_u32 m0, s70, 38912
    s_nop 0
    buffer_load_dwordx4 v102, s[24:27], s80 offen lds
    s_add_u32 s80, s77, 114688
    s_add_u32 m0, s70, 39936
    s_nop 0
    buffer_load_dwordx4 v103, s[24:27], s80 offen lds
Ll0_47:
    v_rcp_f32 v205, v205
    v_rcp_f32 v206, v206
    v_rcp_f32 v207, v207
    v_pk_mul_f32 v[84:85], v[84:85], v[204:205] op_sel:[0,0] op_sel_hi:[1,1]
    v_pk_mul_f32 v[86:87], v[86:87], v[206:207] op_sel:[0,0] op_sel_hi:[1,1]
    v_cvt_pk_bf16_f32 v192, v64, v65
    v_cvt_pk_bf16_f32 v193, v66, v67
    v_cvt_pk_bf16_f32 v194, v72, v73
    v_cvt_pk_bf16_f32 v195, v74, v75
    v_cvt_pk_bf16_f32 v196, v80, v81
    v_cvt_pk_bf16_f32 v197, v82, v83
    s_cmp_eq_u32 s47, 0
    s_cbranch_scc1 Lsfast_48
    buffer_store_dwordx4 v[192:195], v96, s[4:7], s72 offen offset:0 sc1
    buffer_store_dwordx2 v[196:197], v97, s[4:7], s72 offen offset:0 sc1
    s_branch Lsdone_49
Lsfast_48:
    buffer_store_dwordx4 v[192:195], v96, s[4:7], s72 offen offset:0
    buffer_store_dwordx2 v[196:197], v97, s[4:7], s72 offen offset:0
Lsdone_49:
    v_cvt_pk_bf16_f32 v198, v68, v69
    v_cvt_pk_bf16_f32 v199, v70, v71
    v_cvt_pk_bf16_f32 v200, v76, v77
    v_cvt_pk_bf16_f32 v201, v78, v79
    v_cvt_pk_bf16_f32 v202, v84, v85
    v_cvt_pk_bf16_f32 v203, v86, v87
    s_cmp_eq_u32 s47, 0
    s_cbranch_scc1 Lsfast_50
    buffer_store_dwordx4 v[198:201], v96, s[4:7], s72 offen offset:64 sc1
    buffer_store_dwordx2 v[202:203], v97, s[4:7], s72 offen offset:64 sc1
    s_branch Lsdone_51
Lsfast_50:
    buffer_store_dwordx4 v[198:201], v96, s[4:7], s72 offen offset:64
    buffer_store_dwordx2 v[202:203], v97, s[4:7], s72 offen offset:64
Lsdone_51:
    s_lshl_b32 s60, s56, 5
    s_lshl_b32 s61, s44, 3
    s_add_u32 s60, s60, s61
    v_add_lshl_u32 v26, s60, v15, 5
    s_lshr_b32 s60, s58, 1
    s_lshl_b32 s60, s60, 3
    s_add_u32 s60, s60, s56
    s_lshl_b32 s60, s60, 1
    v_add_lshl_u32 v29, s60, v15, 2
    s_lshl_b32 s71, s57, 3
    s_add_u32 s71, s71, s54
    s_lshl_b32 s71, s71, 2
    s_add_u32 s71, s71, 0
    s_add_u32 s72, s50, 2
    s_mov_b32 s73, 0
    s_mov_b32 s63, 16384
    s_lshl_b32 s64, s56, 2
    s_add_u32 s64, s64, s44
    s_mul_i32 s64, s64, 98304
    s_add_u32 s64, s64, s49
    s_add_u32 s64, s64, 8085504
    s_mul_i32 s65, s58, 24576
    s_mul_i32 s60, s56, 3072
    s_add_u32 s65, s65, s60
    s_add_u32 s65, s65, s49
    s_lshl_b32 s66, s58, 5
    v_lshlrev_b32 v27, 1, v23
    s_lshl_b32 s67, s58, 3
    s_add_u32 s67, s67, s56
    s_lshl_b32 s67, s67, 2
    s_add_u32 s67, s67, 8192
    s_xor_b32 s60, s44, 0
    s_lshl_b32 s61, s60, 13
    s_add_u32 s61, s61, 32768
    v_add_u32 v32, s61, v1
    s_lshl_b32 s61, s60, 10
    v_add_u32 v36, s61, v3
    s_xor_b32 s60, s44, 1
    s_lshl_b32 s61, s60, 13
    s_add_u32 s61, s61, 32768
    v_add_u32 v33, s61, v1
    s_xor_b32 s60, s44, 2
    s_lshl_b32 s61, s60, 13
    s_add_u32 s61, s61, 32768
    v_add_u32 v34, s61, v1
    s_xor_b32 s60, s44, 3
    s_lshl_b32 s61, s60, 13
    s_add_u32 s61, s61, 32768
    v_add_u32 v35, s61, v1
    s_lshl_b32 s61, s60, 10
    v_add_u32 v37, s61, v3
    v_add_u32 v200, 0x10000, v152
    v_add_u32 v201, 0x10000, v153
    v_add_u32 v202, 0x10000, v154
    v_add_u32 v203, 0x10000, v155
    v_add_u32 v204, 0x10000, v156
    v_add_u32 v205, 0x10000, v157
    v_add_u32 v206, 0x10000, v158
    v_add_u32 v207, 0x10000, v159
    v_add_u32 v208, s81, v1
    v_add_u32 v209, s81, v2
    v_add_u32 v210, s81, v3
    s_cmp_eq_u32 s48, 0
    s_cbranch_scc0 Ll0_52
    v_lshlrev_b32 v28, 4, v15
    v_add_lshl_u32 v28, v28, s54, 4
    s_mov_b32 s60, 28672
    s_mov_b64 exec, 0xffff
    s_mov_b32 s82, 0
Lpoll_53:
    buffer_load_dword v24, v28, s[4:7], s60 offen sc1
    s_add_u32 s82, s82, 1
    s_waitcnt vmcnt(0)
    v_cmp_eq_u32 vcc, s50, v24
    s_cmp_eq_u64 vcc, exec
    s_cbranch_scc1 Lpdone_54
    s_cmp_lt_u32 s82, 200000
    s_cbranch_scc1 Lpoll_53
    s_branch LEND
Lpdone_54:
    s_mov_b64 exec, -1
Ll0_52:
    s_mov_b64 exec, 0xff
    s_mov_b32 s82, 0
Lpoll_55:
    buffer_load_dword v24, v26, s[4:7], s63 offen sc1
    s_add_u32 s82, s82, 1
    s_waitcnt vmcnt(0)
    v_cmp_eq_u32 vcc, s50, v24
    s_cmp_eq_u64 vcc, exec
    s_cbranch_scc1 Lpdone_56
    s_cmp_lt_u32 s82, 200000
    s_cbranch_scc1 Lpoll_55
    s_branch LEND
Lpdone_56:
    s_mov_b64 exec, -1
    s_add_u32 s84, s64, 0
    buffer_load_dwordx4 a[0:3], v1, s[4:7], s84 offen offset:0 sc1
    buffer_load_dwordx4 a[4:7], v1, s[4:7], s84 offen offset:1024 sc1
    buffer_load_dwordx4 a[8:11], v1, s[4:7], s84 offen offset:2048 sc1
    buffer_load_dwordx4 a[12:15], v1, s[4:7], s84 offen offset:3072 sc1
    s_add_u32 s85, s64, 4096
    buffer_load_dwordx4 a[16:19], v1, s[4:7], s85 offen offset:0 sc1
    buffer_load_dwordx4 a[20:23], v1, s[4:7], s85 offen offset:1024 sc1
    buffer_load_dwordx4 a[24:27], v1, s[4:7], s85 offen offset:2048 sc1
    buffer_load_dwordx4 a[28:31], v1, s[4:7], s85 offen offset:3072 sc1
    s_add_u32 s84, s64, 8192
    buffer_load_dwordx4 a[32:35], v1, s[4:7], s84 offen offset:0 sc1
    buffer_load_dwordx4 a[36:39], v1, s[4:7], s84 offen offset:1024 sc1
    buffer_load_dwordx4 a[40:43], v1, s[4:7], s84 offen offset:2048 sc1
    buffer_load_dwordx4 a[44:47], v1, s[4:7], s84 offen offset:3072 sc1
    ds_read_b128 v[136:139], v152 offset:0
    ds_read_b128 v[140:143], v153 offset:0
    s_waitcnt vmcnt(11) lgkmcnt(0)
    v_mfma_f32_16x16x32_bf16 v[40:43], a[0:3], a[160:163], 0
    s_add_u32 s85, s64, 12288
    buffer_load_dwordx4 a[48:51], v1, s[4:7], s85 offen offset:0 sc1
    v_mfma_f32_16x16x32_bf16 v[64:67], a[0:3], a[164:167], 0
    v_mov_b32 v24, s72
    v_mov_b32 v25, 0
    s_mov_b64 exec, 1
    s_cmp_eq_u32 s47, 0
    s_cbranch_scc1 Lsfast_57
    buffer_store_dword v24, v25, s[4:7], s71 offen sc1
    s_branch Lsdone_58
Lsfast_57:
    buffer_store_dword v24, v25, s[4:7], s71 offen
Lsdone_58:
    s_mov_b64 exec, -1
    v_mfma_f32_16x16x32_bf16 v[88:91], a[0:3], v[136:139], 0
    v_mfma_f32_16x16x32_bf16 v[112:115], a[0:3], v[140:143], 0
    s_waitcnt vmcnt(12)
    v_mfma_f32_16x16x32_bf16 v[44:47], a[4:7], a[160:163], 0
    buffer_load_dwordx4 a[0:3], v1, s[4:7], s85 offen offset:1024 sc1
    ds_read_b128 v[144:147], v154 offset:0
    v_mfma_f32_16x16x32_bf16 v[68:71], a[4:7], a[164:167], 0
    ds_read_b128 v[148:151], v155 offset:0
    v_mfma_f32_16x16x32_bf16 v[92:95], a[4:7], v[136:139], 0
    v_mfma_f32_16x16x32_bf16 v[116:119], a[4:7], v[140:143], 0
    s_waitcnt vmcnt(12)
    v_mfma_f32_16x16x32_bf16 v[48:51], a[8:11], a[160:163], 0
    buffer_load_dwordx4 a[4:7], v1, s[4:7], s85 offen offset:2048 sc1
    v_mfma_f32_16x16x32_bf16 v[72:75], a[8:11], a[164:167], 0
    v_mfma_f32_16x16x32_bf16 v[96:99], a[8:11], v[136:139], 0
    v_mfma_f32_16x16x32_bf16 v[120:123], a[8:11], v[140:143], 0
    s_waitcnt vmcnt(12)
    v_mfma_f32_16x16x32_bf16 v[52:55], a[12:15], a[160:163], 0
    buffer_load_dwordx4 a[8:11], v1, s[4:7], s85 offen offset:3072 sc1
    v_mfma_f32_16x16x32_bf16 v[76:79], a[12:15], a[164:167], 0
    v_mfma_f32_16x16x32_bf16 v[100:103], a[12:15], v[136:139], 0
    v_mfma_f32_16x16x32_bf16 v[124:127], a[12:15], v[140:143], 0
    s_waitcnt vmcnt(12)
    v_mfma_f32_16x16x32_bf16 v[56:59], a[16:19], a[160:163], 0
    s_add_u32 s84, s64, 16384
    buffer_load_dwordx4 a[12:15], v1, s[4:7], s84 offen offset:0 sc1
    v_mfma_f32_16x16x32_bf16 v[80:83], a[16:19], a[164:167], 0
    v_mfma_f32_16x16x32_bf16 v[104:107], a[16:19], v[136:139], 0
    v_mfma_f32_16x16x32_bf16 v[128:131], a[16:19], v[140:143], 0
    s_waitcnt vmcnt(12)
    v_mfma_f32_16x16x32_bf16 v[60:63], a[20:23], a[160:163], 0
    buffer_load_dwordx4 a[16:19], v1, s[4:7], s84 offen offset:1024 sc1
    v_mfma_f32_16x16x32_bf16 v[84:87], a[20:23], a[164:167], 0
    v_mfma_f32_16x16x32_bf16 v[108:111], a[20:23], v[136:139], 0
    v_mfma_f32_16x16x32_bf16 v[132:135], a[20:23], v[140:143], 0
    s_waitcnt vmcnt(12) lgkmcnt(0)
    v_mfma_f32_16x16x32_bf16 v[40:43], a[24:27], a[168:171], v[40:43]
    buffer_load_dwordx4 a[20:23], v1, s[4:7], s84 offen offset:2048 sc1
    v_mfma_f32_16x16x32_bf16 v[64:67], a[24:27], a[172:175], v[64:67]
    v_mfma_f32_16x16x32_bf16 v[88:91], a[24:27], v[144:147], v[88:91]
    v_mfma_f32_16x16x32_bf16 v[112:115], a[24:27], v[148:151], v[112:115]
    s_waitcnt vmcnt(12)
    v_mfma_f32_16x16x32_bf16 v[44:47], a[28:31], a[168:171], v[44:47]
    buffer_load_dwordx4 a[24:27], v1, s[4:7], s84 offen offset:3072 sc1
    ds_read_b128 v[136:139], v156 offset:0
    v_mfma_f32_16x16x32_bf16 v[68:71], a[28:31], a[172:175], v[68:71]
    ds_read_b128 v[140:143], v157 offset:0
    v_mfma_f32_16x16x32_bf16 v[92:95], a[28:31], v[144:147], v[92:95]
    v_mfma_f32_16x16x32_bf16 v[116:119], a[28:31], v[148:151], v[116:119]
    s_waitcnt vmcnt(12)
    v_mfma_f32_16x16x32_bf16 v[48:51], a[32:35], a[168:171], v[48:51]
    s_add_u32 s85, s64, 20480
    buffer_load_dwordx4 a[28:31], v1, s[4:7], s85 offen offset:0 sc1
    v_mfma_f32_16x16x32_bf16 v[72:75], a[32:35], a[172:175], v[72:75]
    v_mfma_f32_16x16x32_bf16 v[96:99], a[32:35], v[144:147], v[96:99]
    v_mfma_f32_16x16x32_bf16 v[120:123], a[32:35], v[148:151], v[120:123]
    s_waitcnt vmcnt(12)
    v_mfma_f32_16x16x32_bf16 v[52:55], a[36:39], a[168:171], v[52:55]
    buffer_load_dwordx4 a[32:35], v1, s[4:7], s85 offen offset:1024 sc1
    v_mfma_f32_16x16x32_bf16 v[76:79], a[36:39], a[172:175], v[76:79]
    v_mfma_f32_16x16x32_bf16 v[100:103], a[36:39], v[144:147], v[100:103]
    v_mfma_f32_16x16x32_bf16 v[124:127], a[36:39], v[148:151], v[124:127]
    s_waitcnt vmcnt(12)
    v_mfma_f32_16x16x32_bf16 v[56:59], a[40:43], a[168:171], v[56:59]
    buffer_load_dwordx4 a[36:39], v1, s[4:7], s85 offen offset:2048 sc1
    v_mfma_f32_16x16x32_bf16 v[80:83], a[40:43], a[172:175], v[80:83]
    v_mfma_f32_16x16x32_bf16 v[104:107], a[40:43], v[144:147], v[104:107]
    v_mfma_f32_16x16x32_bf16 v[128:131], a[40:43], v[148:151], v[128:131]
    s_waitcnt vmcnt(12)
    v_mfma_f32_16x16x32_bf16 v[60:63], a[44:47], a[168:171], v[60:63]
    buffer_load_dwordx4 a[40:43], v1, s[4:7], s85 offen offset:3072 sc1
    v_mfma_f32_16x16x32_bf16 v[84:87], a[44:47], a[172:175], v[84:87]
    v_mfma_f32_16x16x32_bf16 v[108:111], a[44:47], v[144:147], v[108:111]
    v_mfma_f32_16x16x32_bf16 v[132:135], a[44:47], v[148:151], v[132:135]
    s_waitcnt vmcnt(12) lgkmcnt(0)
    v_mfma_f32_16x16x32_bf16 v[40:43], a[48:51], a[176:179], v[40:43]
    s_add_u32 s84, s64, 24576
    buffer_load_dwordx4 a[44:47], v1, s[4:7], s84 offen offset:0 sc1
    v_mfma_f32_16x16x32_bf16 v[64:67], a[48:51], a[180:183], v[64:67]
    v_mfma_f32_16x16x32_bf16 v[88:91], a[48:51], v[136:139], v[88:91]
    v_mfma_f32_16x16x32_bf16 v[112:115], a[48:51], v[140:143], v[112:115]
    s_waitcnt vmcnt(11)
    v_mfma_f32_16x16x32_bf16 v[44:47], a[0:3], a[176:179], v[44:47]
    buffer_load_dwordx4 a[48:51], v1, s[4:7], s84 offen offset:1024 sc1
    ds_read_b128 v[144:147], v158 offset:0
    v_mfma_f32_16x16x32_bf16 v[68:71], a[0:3], a[180:183], v[68:71]
    ds_read_b128 v[148:151], v159 offset:0
    v_mfma_f32_16x16x32_bf16 v[92:95], a[0:3], v[136:139], v[92:95]
    v_mfma_f32_16x16x32_bf16 v[116:119], a[0:3], v[140:143], v[116:119]
    s_waitcnt vmcnt(11)
    v_mfma_f32_16x16x32_bf16 v[48:51], a[4:7], a[176:179], v[48:51]
    buffer_load_dwordx4 a[0:3], v1, s[4:7], s84 offen offset:2048 sc1
    v_mfma_f32_16x16x32_bf16 v[72:75], a[4:7], a[180:183], v[72:75]
    v_mfma_f32_16x16x32_bf16 v[96:99], a[4:7], v[136:139], v[96:99]
    v_mfma_f32_16x16x32_bf16 v[120:123], a[4:7], v[140:143], v[120:123]
    s_waitcnt vmcnt(11)
    v_mfma_f32_16x16x32_bf16 v[52:55], a[8:11], a[176:179], v[52:55]
    buffer_load_dwordx4 a[4:7], v1, s[4:7], s84 offen offset:3072 sc1
    v_mfma_f32_16x16x32_bf16 v[76:79], a[8:11], a[180:183], v[76:79]
    v_mfma_f32_16x16x32_bf16 v[100:103], a[8:11], v[136:139], v[100:103]
    v_mfma_f32_16x16x32_bf16 v[124:127], a[8:11], v[140:143], v[124:127]
    s_waitcnt vmcnt(11)
    v_mfma_f32_16x16x32_bf16 v[56:59], a[12:15], a[176:179], v[56:59]
    s_add_u32 s85, s64, 28672
    buffer_load_dwordx4 a[8:11], v1, s[4:7], s85 offen offset:0 sc1
    v_mfma_f32_16x16x32_bf16 v[80:83], a[12:15], a[180:183], v[80:83]
    v_mfma_f32_16x16x32_bf16 v[104:107], a[12:15], v[136:139], v[104:107]
    v_mfma_f32_16x16x32_bf16 v[128:131], a[12:15], v[140:143], v[128:131]
    s_waitcnt vmcnt(11)
    v_mfma_f32_16x16x32_bf16 v[60:63], a[16:19], a[176:179], v[60:63]
    buffer_load_dwordx4 a[12:15], v1, s[4:7], s85 offen offset:1024 sc1
    v_mfma_f32_16x16x32_bf16 v[84:87], a[16:19], a[180:183], v[84:87]
    v_mfma_f32_16x16x32_bf16 v[108:111], a[16:19], v[136:139], v[108:111]
    v_mfma_f32_16x16x32_bf16 v[132:135], a[16:19], v[140:143], v[132:135]
    s_waitcnt vmcnt(11) lgkmcnt(0)
    v_mfma_f32_16x16x32_bf16 v[40:43], a[20:23], a[184:187], v[40:43]
    buffer_load_dwordx4 a[16:19], v1, s[4:7], s85 offen offset:2048 sc1
    s_mov_b64 exec, 3
    buffer_load_dword v28, v29, s[4:7], s73 offen sc1
    s_mov_b64 exec, -1
    v_mfma_f32_16x16x32_bf16 v[64:67], a[20:23], a[188:191], v[64:67]
    v_mfma_f32_16x16x32_bf16 v[88:91], a[20:23], v[144:147], v[88:91]
    v_mfma_f32_16x16x32_bf16 v[112:115], a[20:23], v[148:151], v[112:115]
    s_waitcnt vmcnt(12)
    v_mfma_f32_16x16x32_bf16 v[44:47], a[24:27], a[184:187], v[44:47]
    buffer_load_dwordx4 a[20:23], v1, s[4:7], s85 offen offset:3072 sc1
    ds_read_b128 v[136:139], v152 offset:32768
    v_mfma_f32_16x16x32_bf16 v[68:71], a[24:27], a[188:191], v[68:71]
    ds_read_b128 v[140:143], v153 offset:32768
    v_mfma_f32_16x16x32_bf16 v[92:95], a[24:27], v[144:147], v[92:95]
    v_mfma_f32_16x16x32_bf16 v[116:119], a[24:27], v[148:151], v[116:119]
    s_waitcnt vmcnt(12)
    v_mfma_f32_16x16x32_bf16 v[48:51], a[28:31], a[184:187], v[48:51]
    s_add_u32 s84, s64, 32768
    buffer_load_dwordx4 a[24:27], v1, s[4:7], s84 offen offset:0 sc1
    v_mfma_f32_16x16x32_bf16 v[72:75], a[28:31], a[188:191], v[72:75]
    v_mfma_f32_16x16x32_bf16 v[96:99], a[28:31], v[144:147], v[96:99]
    v_mfma_f32_16x16x32_bf16 v[120:123], a[28:31], v[148:151], v[120:123]
    s_waitcnt vmcnt(12)
    v_mfma_f32_16x16x32_bf16 v[52:55], a[32:35], a[184:187], v[52:55]
    buffer_load_dwordx4 a[28:31], v1, s[4:7], s84 offen offset:1024 sc1
    v_mfma_f32_16x16x32_bf16 v[76:79], a[32:35], a[188:191], v[76:79]
    v_mfma_f32_16x16x32_bf16 v[100:103], a[32:35], v[144:147], v[100:103]
    v_mfma_f32_16x16x32_bf16 v[124:127], a[32:35], v[148:151], v[124:127]
    s_waitcnt vmcnt(12)
    v_mfma_f32_16x16x32_bf16 v[56:59], a[36:39], a[184:187], v[56:59]
    buffer_load_dwordx4 a[32:35], v1, s[4:7], s84 offen offset:2048 sc1
    v_mfma_f32_16x16x32_bf16 v[80:83], a[36:39], a[188:191], v[80:83]
    v_mfma_f32_16x16x32_bf16 v[104:107], a[36:39], v[144:147], v[104:107]
    v_mfma_f32_16x16x32_bf16 v[128:131], a[36:39], v[148:151], v[128:131]
    s_waitcnt vmcnt(12)
    v_mfma_f32_16x16x32_bf16 v[60:63], a[40:43], a[184:187], v[60:63]
    buffer_load_dwordx4 a[36:39], v1, s[4:7], s84 offen offset:3072 sc1
    v_mfma_f32_16x16x32_bf16 v[84:87], a[40:43], a[188:191], v[84:87]
    v_mfma_f32_16x16x32_bf16 v[108:111], a[40:43], v[144:147], v[108:111]
    v_mfma_f32_16x16x32_bf16 v[132:135], a[40:43], v[148:151], v[132:135]
    s_waitcnt vmcnt(12) lgkmcnt(0)
    v_mfma_f32_16x16x32_bf16 v[40:43], a[44:47], a[192:195], v[40:43]
    s_add_u32 s85, s64, 36864
    buffer_load_dwordx4 a[40:43], v1, s[4:7], s85 offen offset:0 sc1
    v_mfma_f32_16x16x32_bf16 v[64:67], a[44:47], a[196:199], v[64:67]
    v_mfma_f32_16x16x32_bf16 v[88:91], a[44:47], v[136:139], v[88:91]
    v_mfma_f32_16x16x32_bf16 v[112:115], a[44:47], v[140:143], v[112:115]
    s_waitcnt vmcnt(12)
    v_mfma_f32_16x16x32_bf16 v[44:47], a[48:51], a[192:195], v[44:47]
    buffer_load_dwordx4 a[44:47], v1, s[4:7], s85 offen offset:1024 sc1
    ds_read_b128 v[144:147], v154 offset:32768
    v_mfma_f32_16x16x32_bf16 v[68:71], a[48:51], a[196:199], v[68:71]
    ds_read_b128 v[148:151], v155 offset:32768
    v_mfma_f32_16x16x32_bf16 v[92:95], a[48:51], v[136:139], v[92:95]
    v_mfma_f32_16x16x32_bf16 v[116:119], a[48:51], v[140:143], v[116:119]
    s_waitcnt vmcnt(12)
    v_mfma_f32_16x16x32_bf16 v[48:51], a[0:3], a[192:195], v[48:51]
    buffer_load_dwordx4 a[48:51], v1, s[4:7], s85 offen offset:2048 sc1
    v_mfma_f32_16x16x32_bf16 v[72:75], a[0:3], a[196:199], v[72:75]
    v_mfma_f32_16x16x32_bf16 v[96:99], a[0:3], v[136:139], v[96:99]
    v_mfma_f32_16x16x32_bf16 v[120:123], a[0:3], v[140:143], v[120:123]
    s_waitcnt vmcnt(12)
    v_mfma_f32_16x16x32_bf16 v[52:55], a[4:7], a[192:195], v[52:55]
    buffer_load_dwordx4 a[0:3], v1, s[4:7], s85 offen offset:3072 sc1
    v_mfma_f32_16x16x32_bf16 v[76:79], a[4:7], a[196:199], v[76:79]
    v_mfma_f32_16x16x32_bf16 v[100:103], a[4:7], v[136:139], v[100:103]
    v_mfma_f32_16x16x32_bf16 v[124:127], a[4:7], v[140:143], v[124:127]
    s_waitcnt vmcnt(12)
    v_mfma_f32_16x16x32_bf16 v[56:59], a[8:11], a[192:195], v[56:59]
    s_add_u32 s84, s64, 40960
    buffer_load_dwordx4 a[4:7], v1, s[4:7], s84 offen offset:0 sc1
    v_mfma_f32_16x16x32_bf16 v[80:83], a[8:11], a[196:199], v[80:83]
    v_mfma_f32_16x16x32_bf16 v[104:107], a[8:11], v[136:139], v[104:107]
    v_mfma_f32_16x16x32_bf16 v[128:131], a[8:11], v[140:143], v[128:131]
    s_waitcnt vmcnt(12)
    v_mfma_f32_16x16x32_bf16 v[60:63], a[12:15], a[192:195], v[60:63]
    buffer_load_dwordx4 a[8:11], v1, s[4:7], s84 offen offset:1024 sc1
    v_mfma_f32_16x16x32_bf16 v[84:87], a[12:15], a[196:199], v[84:87]
    v_mfma_f32_16x16x32_bf16 v[108:111], a[12:15], v[136:139], v[108:111]
    v_mfma_f32_16x16x32_bf16 v[132:135], a[12:15], v[140:143], v[132:135]
    s_waitcnt vmcnt(12) lgkmcnt(0)
    v_mfma_f32_16x16x32_bf16 v[40:43], a[16:19], a[200:203], v[40:43]
    buffer_load_dwordx4 a[12:15], v1, s[4:7], s84 offen offset:2048 sc1
    v_mfma_f32_16x16x32_bf16 v[64:67], a[16:19], a[204:207], v[64:67]
    v_mfma_f32_16x16x32_bf16 v[88:91], a[16:19], v[144:147], v[88:91]
    v_mfma_f32_16x16x32_bf16 v[112:115], a[16:19], v[148:151], v[112:115]
    s_waitcnt vmcnt(11)
    v_mfma_f32_16x16x32_bf16 v[44:47], a[20:23], a[200:203], v[44:47]
    buffer_load_dwordx4 a[16:19], v1, s[4:7], s84 offen offset:3072 sc1
    ds_read_b128 v[136:139], v156 offset:32768
    v_mfma_f32_16x16x32_bf16 v[68:71], a[20:23], a[204:207], v[68:71]
    ds_read_b128 v[140:143], v157 offset:32768
    v_mfma_f32_16x16x32_bf16 v[92:95], a[20:23], v[144:147], v[92:95]
    v_mfma_f32_16x16x32_bf16 v[116:119], a[20:23], v[148:151], v[116:119]
    s_waitcnt vmcnt(11)
    v_mfma_f32_16x16x32_bf16 v[48:51], a[24:27], a[200:203], v[48:51]
    s_add_u32 s85, s64, 45056
    buffer_load_dwordx4 a[20:23], v1, s[4:7], s85 offen offset:0 sc1
    v_mfma_f32_16x16x32_bf16 v[72:75], a[24:27], a[204:207], v[72:75]
    v_mfma_f32_16x16x32_bf16 v[96:99], a[24:27], v[144:147], v[96:99]
    v_mfma_f32_16x16x32_bf16 v[120:123], a[24:27], v[148:151], v[120:123]
    s_waitcnt vmcnt(11)
    v_mfma_f32_16x16x32_bf16 v[52:55], a[28:31], a[200:203], v[52:55]
    buffer_load_dwordx4 a[24:27], v1, s[4:7], s85 offen offset:1024 sc1
    v_mfma_f32_16x16x32_bf16 v[76:79], a[28:31], a[204:207], v[76:79]
    v_mfma_f32_16x16x32_bf16 v[100:103], a[28:31], v[144:147], v[100:103]
    v_mfma_f32_16x16x32_bf16 v[124:127], a[28:31], v[148:151], v[124:127]
    s_waitcnt vmcnt(11)
    v_mfma_f32_16x16x32_bf16 v[56:59], a[32:35], a[200:203], v[56:59]
    buffer_load_dwordx4 a[28:31], v1, s[4:7], s85 offen offset:2048 sc1
    v_mfma_f32_16x16x32_bf16 v[80:83], a[32:35], a[204:207], v[80:83]
    v_mfma_f32_16x16x32_bf16 v[104:107], a[32:35], v[144:147], v[104:107]
    v_mfma_f32_16x16x32_bf16 v[128:131], a[32:35], v[148:151], v[128:131]
    s_waitcnt vmcnt(11)
    v_mfma_f32_16x16x32_bf16 v[60:63], a[36:39], a[200:203], v[60:63]
    buffer_load_dwordx4 a[32:35], v1, s[4:7], s85 offen offset:3072 sc1
    v_mfma_f32_16x16x32_bf16 v[84:87], a[36:39], a[204:207], v[84:87]
    v_mfma_f32_16x16x32_bf16 v[108:111], a[36:39], v[144:147], v[108:111]
    v_mfma_f32_16x16x32_bf16 v[132:135], a[36:39], v[148:151], v[132:135]
    s_waitcnt vmcnt(11) lgkmcnt(0)
    v_mfma_f32_16x16x32_bf16 v[40:43], a[40:43], a[208:211], v[40:43]
    s_add_u32 s84, s64, 49152
    buffer_load_dwordx4 a[36:39], v1, s[4:7], s84 offen offset:0 sc1
    v_mfma_f32_16x16x32_bf16 v[64:67], a[40:43], a[212:215], v[64:67]
    v_mfma_f32_16x16x32_bf16 v[88:91], a[40:43], v[136:139], v[88:91]
    v_mfma_f32_16x16x32_bf16 v[112:115], a[40:43], v[140:143], v[112:115]
    s_waitcnt vmcnt(11)
    v_mfma_f32_16x16x32_bf16 v[44:47], a[44:47], a[208:211], v[44:47]
    buffer_load_dwordx4 a[40:43], v1, s[4:7], s84 offen offset:1024 sc1
    ds_read_b128 v[144:147], v158 offset:32768
    v_mfma_f32_16x16x32_bf16 v[68:71], a[44:47], a[212:215], v[68:71]
    ds_read_b128 v[148:151], v159 offset:32768
    v_mfma_f32_16x16x32_bf16 v[92:95], a[44:47], v[136:139], v[92:95]
    v_mfma_f32_16x16x32_bf16 v[116:119], a[44:47], v[140:143], v[116:119]
    s_waitcnt vmcnt(11)
    v_mfma_f32_16x16x32_bf16 v[48:51], a[48:51], a[208:211], v[48:51]
    buffer_load_dwordx4 a[44:47], v1, s[4:7], s84 offen offset:2048 sc1
    v_mfma_f32_16x16x32_bf16 v[72:75], a[48:51], a[212:215], v[72:75]
    v_mfma_f32_16x16x32_bf16 v[96:99], a[48:51], v[136:139], v[96:99]
    v_mfma_f32_16x16x32_bf16 v[120:123], a[48:51], v[140:143], v[120:123]
    s_waitcnt vmcnt(11)
    v_mfma_f32_16x16x32_bf16 v[52:55], a[0:3], a[208:211], v[52:55]
    buffer_load_dwordx4 a[48:51], v1, s[4:7], s84 offen offset:3072 sc1
    v_mfma_f32_16x16x32_bf16 v[76:79], a[0:3], a[212:215], v[76:79]
    v_mfma_f32_16x16x32_bf16 v[100:103], a[0:3], v[136:139], v[100:103]
    v_mfma_f32_16x16x32_bf16 v[124:127], a[0:3], v[140:143], v[124:127]
    s_waitcnt vmcnt(11)
    v_mfma_f32_16x16x32_bf16 v[56:59], a[4:7], a[208:211], v[56:59]
    s_add_u32 s85, s64, 53248
    buffer_load_dwordx4 a[0:3], v1, s[4:7], s85 offen offset:0 sc1
    v_mfma_f32_16x16x32_bf16 v[80:83], a[4:7], a[212:215], v[80:83]
    v_mfma_f32_16x16x32_bf16 v[104:107], a[4:7], v[136:139], v[104:107]
    v_mfma_f32_16x16x32_bf16 v[128:131], a[4:7], v[140:143], v[128:131]
    s_waitcnt vmcnt(11)
    v_mfma_f32_16x16x32_bf16 v[60:63], a[8:11], a[208:211], v[60:63]
    buffer_load_dwordx4 a[4:7], v1, s[4:7], s85 offen offset:1024 sc1
    v_mfma_f32_16x16x32_bf16 v[84:87], a[8:11], a[212:215], v[84:87]
    v_mfma_f32_16x16x32_bf16 v[108:111], a[8:11], v[136:139], v[108:111]
    v_mfma_f32_16x16x32_bf16 v[132:135], a[8:11], v[140:143], v[132:135]
    s_waitcnt vmcnt(11) lgkmcnt(0)
    v_mfma_f32_16x16x32_bf16 v[40:43], a[12:15], a[216:219], v[40:43]
    buffer_load_dwordx4 a[8:11], v1, s[4:7], s85 offen offset:2048 sc1
    v_mfma_f32_16x16x32_bf16 v[64:67], a[12:15], a[220:223], v[64:67]
    v_mfma_f32_16x16x32_bf16 v[88:91], a[12:15], v[144:147], v[88:91]
    v_mfma_f32_16x16x32_bf16 v[112:115], a[12:15], v[148:151], v[112:115]
    s_waitcnt vmcnt(11)
    v_mfma_f32_16x16x32_bf16 v[44:47], a[16:19], a[216:219], v[44:47]
    buffer_load_dwordx4 a[12:15], v1, s[4:7], s85 offen offset:3072 sc1
    ds_read_b128 v[136:139], v200 offset:0
    v_mfma_f32_16x16x32_bf16 v[68:71], a[16:19], a[220:223], v[68:71]
    ds_read_b128 v[140:143], v201 offset:0
    v_mfma_f32_16x16x32_bf16 v[92:95], a[16:19], v[144:147], v[92:95]
    v_mfma_f32_16x16x32_bf16 v[116:119], a[16:19], v[148:151], v[116:119]
    s_waitcnt vmcnt(11)
    v_mfma_f32_16x16x32_bf16 v[48:51], a[20:23], a[216:219], v[48:51]
    s_add_u32 s84, s64, 57344
    buffer_load_dwordx4 a[16:19], v1, s[4:7], s84 offen offset:0 sc1
    v_mfma_f32_16x16x32_bf16 v[72:75], a[20:23], a[220:223], v[72:75]
    v_mfma_f32_16x16x32_bf16 v[96:99], a[20:23], v[144:147], v[96:99]
    v_mfma_f32_16x16x32_bf16 v[120:123], a[20:23], v[148:151], v[120:123]
    s_waitcnt vmcnt(11)
    v_mfma_f32_16x16x32_bf16 v[52:55], a[24:27], a[216:219], v[52:55]
    buffer_load_dwordx4 a[20:23], v1, s[4:7], s84 offen offset:1024 sc1
    v_mfma_f32_16x16x32_bf16 v[76:79], a[24:27], a[220:223], v[76:79]
    v_mfma_f32_16x16x32_bf16 v[100:103], a[24:27], v[144:147], v[100:103]
    v_mfma_f32_16x16x32_bf16 v[124:127], a[24:27], v[148:151], v[124:127]
    s_waitcnt vmcnt(11)
    v_mfma_f32_16x16x32_bf16 v[56:59], a[28:31], a[216:219], v[56:59]
    buffer_load_dwordx4 a[24:27], v1, s[4:7], s84 offen offset:2048 sc1
    v_mfma_f32_16x16x32_bf16 v[80:83], a[28:31], a[220:223], v[80:83]
    v_mfma_f32_16x16x32_bf16 v[104:107], a[28:31], v[144:147], v[104:107]
    v_mfma_f32_16x16x32_bf16 v[128:131], a[28:31], v[148:151], v[128:131]
    s_waitcnt vmcnt(11)
    v_mfma_f32_16x16x32_bf16 v[60:63], a[32:35], a[216:219], v[60:63]
    buffer_load_dwordx4 a[28:31], v1, s[4:7], s84 offen offset:3072 sc1
    v_mfma_f32_16x16x32_bf16 v[84:87], a[32:35], a[220:223], v[84:87]
    v_mfma_f32_16x16x32_bf16 v[108:111], a[32:35], v[144:147], v[108:111]
    v_mfma_f32_16x16x32_bf16 v[132:135], a[32:35], v[148:151], v[132:135]
    s_waitcnt vmcnt(11) lgkmcnt(0)
    v_mfma_f32_16x16x32_bf16 v[40:43], a[36:39], a[224:227], v[40:43]
    s_add_u32 s85, s64, 61440
    buffer_load_dwordx4 a[32:35], v1, s[4:7], s85 offen offset:0 sc1
    v_mfma_f32_16x16x32_bf16 v[64:67], a[36:39], a[228:231], v[64:67]
    v_mfma_f32_16x16x32_bf16 v[88:91], a[36:39], v[136:139], v[88:91]
    v_mfma_f32_16x16x32_bf16 v[112:115], a[36:39], v[140:143], v[112:115]
    s_waitcnt vmcnt(11)
    v_mfma_f32_16x16x32_bf16 v[44:47], a[40:43], a[224:227], v[44:47]
    buffer_load_dwordx4 a[36:39], v1, s[4:7], s85 offen offset:1024 sc1
    ds_read_b128 v[144:147], v202 offset:0
    v_mfma_f32_16x16x32_bf16 v[68:71], a[40:43], a[228:231], v[68:71]
    ds_read_b128 v[148:151], v203 offset:0
    v_mfma_f32_16x16x32_bf16 v[92:95], a[40:43], v[136:139], v[92:95]
    v_mfma_f32_16x16x32_bf16 v[116:119], a[40:43], v[140:143], v[116:119]
    s_waitcnt vmcnt(11)
    v_mfma_f32_16x16x32_bf16 v[48:51], a[44:47], a[224:227], v[48:51]
    buffer_load_dwordx4 a[40:43], v1, s[4:7], s85 offen offset:2048 sc1
    v_mfma_f32_16x16x32_bf16 v[72:75], a[44:47], a[228:231], v[72:75]
    v_mfma_f32_16x16x32_bf16 v[96:99], a[44:47], v[136:139], v[96:99]
    v_mfma_f32_16x16x32_bf16 v[120:123], a[44:47], v[140:143], v[120:123]
    s_waitcnt vmcnt(11)
    v_mfma_f32_16x16x32_bf16 v[52:55], a[48:51], a[224:227], v[52:55]
    buffer_load_dwordx4 a[44:47], v1, s[4:7], s85 offen offset:3072 sc1
    v_mfma_f32_16x16x32_bf16 v[76:79], a[48:51], a[228:231], v[76:79]
    v_mfma_f32_16x16x32_bf16 v[100:103], a[48:51], v[136:139], v[100:103]
    v_mfma_f32_16x16x32_bf16 v[124:127], a[48:51], v[140:143], v[124:127]
    s_waitcnt vmcnt(11)
    v_mfma_f32_16x16x32_bf16 v[56:59], a[0:3], a[224:227], v[56:59]
    s_add_u32 s84, s64, 65536
    buffer_load_dwordx4 a[48:51], v1, s[4:7], s84 offen offset:0 sc1
    v_mfma_f32_16x16x32_bf16 v[80:83], a[0:3], a[228:231], v[80:83]
    v_mfma_f32_16x16x32_bf16 v[104:107], a[0:3], v[136:139], v[104:107]
    v_mfma_f32_16x16x32_bf16 v[128:131], a[0:3], v[140:143], v[128:131]
    s_waitcnt vmcnt(11)
    v_mfma_f32_16x16x32_bf16 v[60:63], a[4:7], a[224:227], v[60:63]
    buffer_load_dwordx4 a[0:3], v1, s[4:7], s84 offen offset:1024 sc1
    v_mfma_f32_16x16x32_bf16 v[84:87], a[4:7], a[228:231], v[84:87]
    v_mfma_f32_16x16x32_bf16 v[108:111], a[4:7], v[136:139], v[108:111]
    v_mfma_f32_16x16x32_bf16 v[132:135], a[4:7], v[140:143], v[132:135]
    s_waitcnt vmcnt(11) lgkmcnt(0)
    v_mfma_f32_16x16x32_bf16 v[40:43], a[8:11], a[232:235], v[40:43]
    buffer_load_dwordx4 a[4:7], v1, s[4:7], s84 offen offset:2048 sc1
    v_cmp_eq_u32 vcc, s72, v28
    s_and_b32 s60, vcc_lo, 3
    s_cmp_eq_u32 s60, 3
    s_cbranch_scc1 Lz1ok_59
    s_mov_b64 exec, 3
    s_mov_b32 s82, 0
Lpoll_60:
    buffer_load_dword v24, v29, s[4:7], s73 offen sc1
    s_add_u32 s82, s82, 1
    s_waitcnt vmcnt(0)
    v_cmp_eq_u32 vcc, s72, v24
    s_cmp_eq_u64 vcc, exec
    s_cbranch_scc1 Lpdone_61
    s_cmp_lt_u32 s82, 200000
    s_cbranch_scc1 Lpoll_60
    s_branch LEND
Lpdone_61:
    s_mov_b64 exec, -1
Lz1ok_59:
    s_add_u32 s60, s65, 14901248
    buffer_load_dwordx4 v[160:163], v1, s[4:7], s60 offen offset:0 sc1
    buffer_load_dwordx4 v[164:167], v1, s[4:7], s60 offen offset:1024 sc1
    buffer_load_dwordx4 v[168:171], v1, s[4:7], s60 offen offset:2048 sc1
    buffer_load_ushort v196, v27, s[28:31], s66 offen
    s_barrier
    v_mfma_f32_16x16x32_bf16 v[64:67], a[8:11], a[236:239], v[64:67]
    v_mfma_f32_16x16x32_bf16 v[88:91], a[8:11], v[144:147], v[88:91]
    v_mfma_f32_16x16x32_bf16 v[112:115], a[8:11], v[148:151], v[112:115]
    s_waitcnt vmcnt(15)
    v_mfma_f32_16x16x32_bf16 v[44:47], a[12:15], a[232:235], v[44:47]
    buffer_load_dwordx4 a[8:11], v1, s[4:7], s84 offen offset:3072 sc1
    ds_read_b128 v[136:139], v204 offset:0
    v_mfma_f32_16x16x32_bf16 v[68:71], a[12:15], a[236:239], v[68:71]
    ds_read_b128 v[140:143], v205 offset:0
    v_mfma_f32_16x16x32_bf16 v[92:95], a[12:15], v[144:147], v[92:95]
    v_mfma_f32_16x16x32_bf16 v[116:119], a[12:15], v[148:151], v[116:119]
    s_waitcnt vmcnt(15)
    v_mfma_f32_16x16x32_bf16 v[48:51], a[16:19], a[232:235], v[48:51]
    s_add_u32 s85, s64, 69632
    buffer_load_dwordx4 a[12:15], v1, s[4:7], s85 offen offset:0 sc1
    v_mfma_f32_16x16x32_bf16 v[72:75], a[16:19], a[236:239], v[72:75]
    v_mfma_f32_16x16x32_bf16 v[96:99], a[16:19], v[144:147], v[96:99]
    v_mfma_f32_16x16x32_bf16 v[120:123], a[16:19], v[148:151], v[120:123]
    s_waitcnt vmcnt(15)
    v_mfma_f32_16x16x32_bf16 v[52:55], a[20:23], a[232:235], v[52:55]
    buffer_load_dwordx4 a[16:19], v1, s[4:7], s85 offen offset:1024 sc1
    v_mfma_f32_16x16x32_bf16 v[76:79], a[20:23], a[236:239], v[76:79]
    v_mfma_f32_16x16x32_bf16 v[100:103], a[20:23], v[144:147], v[100:103]
    v_mfma_f32_16x16x32_bf16 v[124:127], a[20:23], v[148:151], v[124:127]
    s_waitcnt vmcnt(15)
    v_mfma_f32_16x16x32_bf16 v[56:59], a[24:27], a[232:235], v[56:59]
    buffer_load_dwordx4 a[20:23], v1, s[4:7], s85 offen offset:2048 sc1
    v_mfma_f32_16x16x32_bf16 v[80:83], a[24:27], a[236:239], v[80:83]
    v_mfma_f32_16x16x32_bf16 v[104:107], a[24:27], v[144:147], v[104:107]
    v_mfma_f32_16x16x32_bf16 v[128:131], a[24:27], v[148:151], v[128:131]
    s_waitcnt vmcnt(15)
    v_mfma_f32_16x16x32_bf16 v[60:63], a[28:31], a[232:235], v[60:63]
    buffer_load_dwordx4 a[24:27], v1, s[4:7], s85 offen offset:3072 sc1
    v_mfma_f32_16x16x32_bf16 v[84:87], a[28:31], a[236:239], v[84:87]
    v_mfma_f32_16x16x32_bf16 v[108:111], a[28:31], v[144:147], v[108:111]
    v_mfma_f32_16x16x32_bf16 v[132:135], a[28:31], v[148:151], v[132:135]
    s_waitcnt vmcnt(15) lgkmcnt(0)
    v_mfma_f32_16x16x32_bf16 v[40:43], a[32:35], a[240:243], v[40:43]
    s_add_u32 s84, s64, 73728
    buffer_load_dwordx4 a[28:31], v1, s[4:7], s84 offen offset:0 sc1
    v_mfma_f32_16x16x32_bf16 v[64:67], a[32:35], a[244:247], v[64:67]
    v_mfma_f32_16x16x32_bf16 v[88:91], a[32:35], v[136:139], v[88:91]
    v_mfma_f32_16x16x32_bf16 v[112:115], a[32:35], v[140:143], v[112:115]
    s_waitcnt vmcnt(15)
    v_mfma_f32_16x16x32_bf16 v[44:47], a[36:39], a[240:243], v[44:47]
    buffer_load_dwordx4 a[32:35], v1, s[4:7], s84 offen offset:1024 sc1
    ds_read_b128 v[144:147], v206 offset:0
    v_mfma_f32_16x16x32_bf16 v[68:71], a[36:39], a[244:247], v[68:71]
    ds_read_b128 v[148:151], v207 offset:0
    v_mfma_f32_16x16x32_bf16 v[92:95], a[36:39], v[136:139], v[92:95]
    v_mfma_f32_16x16x32_bf16 v[116:119], a[36:39], v[140:143], v[116:119]
    s_waitcnt vmcnt(15)
    v_mfma_f32_16x16x32_bf16 v[48:51], a[40:43], a[240:243], v[48:51]
    buffer_load_dwordx4 a[36:39], v1, s[4:7], s84 offen offset:2048 sc1
    v_mfma_f32_16x16x32_bf16 v[72:75], a[40:43], a[244:247], v[72:75]
    v_mfma_f32_16x16x32_bf16 v[96:99], a[40:43], v[136:139], v[96:99]
    v_mfma_f32_16x16x32_bf16 v[120:123], a[40:43], v[140:143], v[120:123]
    s_waitcnt vmcnt(15)
    v_mfma_f32_16x16x32_bf16 v[52:55], a[44:47], a[240:243], v[52:55]
    buffer_load_dwordx4 a[40:43], v1, s[4:7], s84 offen offset:3072 sc1
    v_mfma_f32_16x16x32_bf16 v[76:79], a[44:47], a[244:247], v[76:79]
    v_mfma_f32_16x16x32_bf16 v[100:103], a[44:47], v[136:139], v[100:103]
    v_mfma_f32_16x16x32_bf16 v[124:127], a[44:47], v[140:143], v[124:127]
    s_waitcnt vmcnt(15)
    v_mfma_f32_16x16x32_bf16 v[56:59], a[48:51], a[240:243], v[56:59]
    s_add_u32 s85, s64, 77824
    buffer_load_dwordx4 a[44:47], v1, s[4:7], s85 offen offset:0 sc1
    v_mfma_f32_16x16x32_bf16 v[80:83], a[48:51], a[244:247], v[80:83]
    v_mfma_f32_16x16x32_bf16 v[104:107], a[48:51], v[136:139], v[104:107]
    v_mfma_f32_16x16x32_bf16 v[128:131], a[48:51], v[140:143], v[128:131]
    s_waitcnt vmcnt(15)
    v_mfma_f32_16x16x32_bf16 v[60:63], a[0:3], a[240:243], v[60:63]
    buffer_load_dwordx4 a[48:51], v1, s[4:7], s85 offen offset:1024 sc1
    v_mfma_f32_16x16x32_bf16 v[84:87], a[0:3], a[244:247], v[84:87]
    v_mfma_f32_16x16x32_bf16 v[108:111], a[0:3], v[136:139], v[108:111]
    v_mfma_f32_16x16x32_bf16 v[132:135], a[0:3], v[140:143], v[132:135]
    s_waitcnt vmcnt(15) lgkmcnt(0)
    v_mfma_f32_16x16x32_bf16 v[40:43], a[4:7], a[248:251], v[40:43]
    buffer_load_dwordx4 a[0:3], v1, s[4:7], s85 offen offset:2048 sc1
    v_mfma_f32_16x16x32_bf16 v[64:67], a[4:7], a[252:255], v[64:67]
    v_mfma_f32_16x16x32_bf16 v[88:91], a[4:7], v[144:147], v[88:91]
    v_mfma_f32_16x16x32_bf16 v[112:115], a[4:7], v[148:151], v[112:115]
    s_waitcnt vmcnt(11)
    v_mfma_f32_16x16x32_bf16 v[44:47], a[8:11], a[248:251], v[44:47]
    buffer_load_dwordx4 a[4:7], v1, s[4:7], s85 offen offset:3072 sc1
    ds_read_b128 v[136:139], v200 offset:32768
    v_mfma_f32_16x16x32_bf16 v[68:71], a[8:11], a[252:255], v[68:71]
    ds_read_b128 v[140:143], v201 offset:32768
    v_mfma_f32_16x16x32_bf16 v[92:95], a[8:11], v[144:147], v[92:95]
    v_mfma_f32_16x16x32_bf16 v[116:119], a[8:11], v[148:151], v[116:119]
    s_waitcnt vmcnt(11)
    v_mfma_f32_16x16x32_bf16 v[48:51], a[12:15], a[248:251], v[48:51]
    s_add_u32 s84, s64, 81920
    buffer_load_dwordx4 a[8:11], v1, s[4:7], s84 offen offset:0 sc1
    v_mfma_f32_16x16x32_bf16 v[72:75], a[12:15], a[252:255], v[72:75]
    v_mfma_f32_16x16x32_bf16 v[96:99], a[12:15], v[144:147], v[96:99]
    v_mfma_f32_16x16x32_bf16 v[120:123], a[12:15], v[148:151], v[120:123]
    s_waitcnt vmcnt(11)
    v_mfma_f32_16x16x32_bf16 v[52:55], a[16:19], a[248:251], v[52:55]
    buffer_load_dwordx4 a[12:15], v1, s[4:7], s84 offen offset:1024 sc1
    v_mfma_f32_16x16x32_bf16 v[76:79], a[16:19], a[252:255], v[76:79]
    v_mfma_f32_16x16x32_bf16 v[100:103], a[16:19], v[144:147], v[100:103]
    v_mfma_f32_16x16x32_bf16 v[124:127], a[16:19], v[148:151], v[124:127]
    s_waitcnt vmcnt(11)
    v_mfma_f32_16x16x32_bf16 v[56:59], a[20:23], a[248:251], v[56:59]
    buffer_load_dwordx4 a[16:19], v1, s[4:7], s84 offen offset:2048 sc1
    v_mfma_f32_16x16x32_bf16 v[80:83], a[20:23], a[252:255], v[80:83]
    v_mfma_f32_16x16x32_bf16 v[104:107], a[20:23], v[144:147], v[104:107]
    v_mfma_f32_16x16x32_bf16 v[128:131], a[20:23], v[148:151], v[128:131]
    s_waitcnt vmcnt(11)
    v_mfma_f32_16x16x32_bf16 v[60:63], a[24:27], a[248:251], v[60:63]
    buffer_load_dwordx4 a[20:23], v1, s[4:7], s84 offen offset:3072 sc1
    v_mfma_f32_16x16x32_bf16 v[84:87], a[24:27], a[252:255], v[84:87]
    v_mfma_f32_16x16x32_bf16 v[108:111], a[24:27], v[144:147], v[108:111]
    v_mfma_f32_16x16x32_bf16 v[132:135], a[24:27], v[148:151], v[132:135]
    s_waitcnt vmcnt(11) lgkmcnt(0)
    v_mfma_f32_16x16x32_bf16 v[40:43], a[28:31], v[224:227], v[40:43]
    s_add_u32 s85, s64, 86016
    buffer_load_dwordx4 a[24:27], v1, s[4:7], s85 offen offset:0 sc1
    v_mfma_f32_16x16x32_bf16 v[64:67], a[28:31], v[228:231], v[64:67]
    v_mfma_f32_16x16x32_bf16 v[88:91], a[28:31], v[136:139], v[88:91]
    v_mfma_f32_16x16x32_bf16 v[112:115], a[28:31], v[140:143], v[112:115]
    s_waitcnt vmcnt(11)
    v_mfma_f32_16x16x32_bf16 v[44:47], a[32:35], v[224:227], v[44:47]
    buffer_load_dwordx4 a[28:31], v1, s[4:7], s85 offen offset:1024 sc1
    ds_read_b128 v[144:147], v202 offset:32768
    v_mfma_f32_16x16x32_bf16 v[68:71], a[32:35], v[228:231], v[68:71]
    ds_read_b128 v[148:151], v203 offset:32768
    v_mfma_f32_16x16x32_bf16 v[92:95], a[32:35], v[136:139], v[92:95]
    v_mfma_f32_16x16x32_bf16 v[116:119], a[32:35], v[140:143], v[116:119]
    s_waitcnt vmcnt(11)
    v_mfma_f32_16x16x32_bf16 v[48:51], a[36:39], v[224:227], v[48:51]
    buffer_load_dwordx4 a[32:35], v1, s[4:7], s85 offen offset:2048 sc1
    v_mfma_f32_16x16x32_bf16 v[72:75], a[36:39], v[228:231], v[72:75]
    v_mfma_f32_16x16x32_bf16 v[96:99], a[36:39], v[136:139], v[96:99]
    v_mfma_f32_16x16x32_bf16 v[120:123], a[36:39], v[140:143], v[120:123]
    s_waitcnt vmcnt(11)
    v_mfma_f32_16x16x32_bf16 v[52:55], a[40:43], v[224:227], v[52:55]
    buffer_load_dwordx4 a[36:39], v1, s[4:7], s85 offen offset:3072 sc1
    v_mfma_f32_16x16x32_bf16 v[76:79], a[40:43], v[228:231], v[76:79]
    v_mfma_f32_16x16x32_bf16 v[100:103], a[40:43], v[136:139], v[100:103]
    v_mfma_f32_16x16x32_bf16 v[124:127], a[40:43], v[140:143], v[124:127]
    s_waitcnt vmcnt(11)
    v_mfma_f32_16x16x32_bf16 v[56:59], a[44:47], v[224:227], v[56:59]
    s_add_u32 s84, s64, 90112
    buffer_load_dwordx4 a[40:43], v1, s[4:7], s84 offen offset:0 sc1
    v_mfma_f32_16x16x32_bf16 v[80:83], a[44:47], v[228:231], v[80:83]
    v_mfma_f32_16x16x32_bf16 v[104:107], a[44:47], v[136:139], v[104:107]
    v_mfma_f32_16x16x32_bf16 v[128:131], a[44:47], v[140:143], v[128:131]
    s_waitcnt vmcnt(11)
    v_mfma_f32_16x16x32_bf16 v[60:63], a[48:51], v[224:227], v[60:63]
    buffer_load_dwordx4 a[44:47], v1, s[4:7], s84 offen offset:1024 sc1
    v_mfma_f32_16x16x32_bf16 v[84:87], a[48:51], v[228:231], v[84:87]
    v_mfma_f32_16x16x32_bf16 v[108:111], a[48:51], v[136:139], v[108:111]
    v_mfma_f32_16x16x32_bf16 v[132:135], a[48:51], v[140:143], v[132:135]
    s_waitcnt vmcnt(11) lgkmcnt(0)
    v_mfma_f32_16x16x32_bf16 v[40:43], a[0:3], v[232:235], v[40:43]
    buffer_load_dwordx4 a[48:51], v1, s[4:7], s84 offen offset:2048 sc1
    v_mfma_f32_16x16x32_bf16 v[64:67], a[0:3], v[236:239], v[64:67]
    v_mfma_f32_16x16x32_bf16 v[88:91], a[0:3], v[144:147], v[88:91]
    v_mfma_f32_16x16x32_bf16 v[112:115], a[0:3], v[148:151], v[112:115]
    s_waitcnt vmcnt(11)
    v_mfma_f32_16x16x32_bf16 v[44:47], a[4:7], v[232:235], v[44:47]
    buffer_load_dwordx4 a[0:3], v1, s[4:7], s84 offen offset:3072 sc1
    ds_read_b128 v[136:139], v204 offset:32768
    v_mfma_f32_16x16x32_bf16 v[68:71], a[4:7], v[236:239], v[68:71]
    ds_read_b128 v[140:143], v205 offset:32768
    v_mfma_f32_16x16x32_bf16 v[92:95], a[4:7], v[144:147], v[92:95]
    v_mfma_f32_16x16x32_bf16 v[116:119], a[4:7], v[148:151], v[116:119]
    s_waitcnt vmcnt(11)
    v_mfma_f32_16x16x32_bf16 v[48:51], a[8:11], v[232:235], v[48:51]
    s_add_u32 s85, s64, 94208
    buffer_load_dwordx4 a[4:7], v1, s[4:7], s85 offen offset:0 sc1
    v_mfma_f32_16x16x32_bf16 v[72:75], a[8:11], v[236:239], v[72:75]
    v_mfma_f32_16x16x32_bf16 v[96:99], a[8:11], v[144:147], v[96:99]
    v_mfma_f32_16x16x32_bf16 v[120:123], a[8:11], v[148:151], v[120:123]
    s_waitcnt vmcnt(11)
    v_mfma_f32_16x16x32_bf16 v[52:55], a[12:15], v[232:235], v[52:55]
    buffer_load_dwordx4 a[8:11], v1, s[4:7], s85 offen offset:1024 sc1
    v_mfma_f32_16x16x32_bf16 v[76:79], a[12:15], v[236:239], v[76:79]
    v_mfma_f32_16x16x32_bf16 v[100:103], a[12:15], v[144:147], v[100:103]
    v_mfma_f32_16x16x32_bf16 v[124:127], a[12:15], v[148:151], v[124:127]
    s_waitcnt vmcnt(11)
    v_mfma_f32_16x16x32_bf16 v[56:59], a[16:19], v[232:235], v[56:59]
    buffer_load_dwordx4 a[12:15], v1, s[4:7], s85 offen offset:2048 sc1
    v_mfma_f32_16x16x32_bf16 v[80:83], a[16:19], v[236:239], v[80:83]
    v_mfma_f32_16x16x32_bf16 v[104:107], a[16:19], v[144:147], v[104:107]
    v_mfma_f32_16x16x32_bf16 v[128:131], a[16:19], v[148:151], v[128:131]
    s_waitcnt vmcnt(11)
    v_mfma_f32_16x16x32_bf16 v[60:63], a[20:23], v[232:235], v[60:63]
    buffer_load_dwordx4 a[16:19], v1, s[4:7], s85 offen offset:3072 sc1
    v_mfma_f32_16x16x32_bf16 v[84:87], a[20:23], v[236:239], v[84:87]
    v_mfma_f32_16x16x32_bf16 v[108:111], a[20:23], v[144:147], v[108:111]
    v_mfma_f32_16x16x32_bf16 v[132:135], a[20:23], v[148:151], v[132:135]
    s_waitcnt vmcnt(11) lgkmcnt(0)
    v_mfma_f32_16x16x32_bf16 v[40:43], a[24:27], v[240:243], v[40:43]
    s_add_u32 s80, s97, 0
    s_add_u32 m0, s81, 0
    v_mfma_f32_16x16x32_bf16 v[64:67], a[24:27], v[244:247], v[64:67]
    buffer_load_dwordx4 v1, s[4:7], s80 offen sc1 lds
    v_mfma_f32_16x16x32_bf16 v[88:91], a[24:27], v[136:139], v[88:91]
    v_mfma_f32_16x16x32_bf16 v[112:115], a[24:27], v[140:143], v[112:115]
    s_waitcnt vmcnt(11)
    v_mfma_f32_16x16x32_bf16 v[44:47], a[28:31], v[240:243], v[44:47]
    ds_read_b128 v[144:147], v206 offset:32768
    ds_read_b128 v[148:151], v207 offset:32768
    v_mfma_f32_16x16x32_bf16 v[68:71], a[28:31], v[244:247], v[68:71]
    v_mfma_f32_16x16x32_bf16 v[92:95], a[28:31], v[136:139], v[92:95]
    v_mfma_f32_16x16x32_bf16 v[116:119], a[28:31], v[140:143], v[116:119]
    s_waitcnt vmcnt(10)
    v_mfma_f32_16x16x32_bf16 v[48:51], a[32:35], v[240:243], v[48:51]
    s_add_u32 s80, s97, 4096
    s_add_u32 m0, s81, 4096
    v_mfma_f32_16x16x32_bf16 v[72:75], a[32:35], v[244:247], v[72:75]
    buffer_load_dwordx4 v1, s[4:7], s80 offen sc1 lds
    v_mfma_f32_16x16x32_bf16 v[96:99], a[32:35], v[136:139], v[96:99]
    v_mfma_f32_16x16x32_bf16 v[120:123], a[32:35], v[140:143], v[120:123]
    s_waitcnt vmcnt(10)
    v_mfma_f32_16x16x32_bf16 v[52:55], a[36:39], v[240:243], v[52:55]
    v_mfma_f32_16x16x32_bf16 v[76:79], a[36:39], v[244:247], v[76:79]
    v_mfma_f32_16x16x32_bf16 v[100:103], a[36:39], v[136:139], v[100:103]
    v_mfma_f32_16x16x32_bf16 v[124:127], a[36:39], v[140:143], v[124:127]
    s_waitcnt vmcnt(9)
    v_mfma_f32_16x16x32_bf16 v[56:59], a[40:43], v[240:243], v[56:59]
    s_add_u32 s80, s97, 8192
    s_add_u32 m0, s81, 8192
    v_mfma_f32_16x16x32_bf16 v[80:83], a[40:43], v[244:247], v[80:83]
    buffer_load_dwordx4 v1, s[4:7], s80 offen sc1 lds
    v_mfma_f32_16x16x32_bf16 v[104:107], a[40:43], v[136:139], v[104:107]
    v_mfma_f32_16x16x32_bf16 v[128:131], a[40:43], v[140:143], v[128:131]
    s_waitcnt vmcnt(9)
    v_mfma_f32_16x16x32_bf16 v[60:63], a[44:47], v[240:243], v[60:63]
    v_mfma_f32_16x16x32_bf16 v[84:87], a[44:47], v[244:247], v[84:87]
    v_mfma_f32_16x16x32_bf16 v[108:111], a[44:47], v[136:139], v[108:111]
    v_mfma_f32_16x16x32_bf16 v[132:135], a[44:47], v[140:143], v[132:135]
    s_waitcnt vmcnt(8) lgkmcnt(0)
    v_mfma_f32_16x16x32_bf16 v[40:43], a[48:51], v[248:251], v[40:43]
    s_add_u32 s80, s97, 12288
    s_add_u32 m0, s81, 12288
    v_mfma_f32_16x16x32_bf16 v[64:67], a[48:51], v[252:255], v[64:67]
    buffer_load_dwordx4 v1, s[4:7], s80 offen sc1 lds
    v_lshlrev_b32 v172, 16, v160
    v_mfma_f32_16x16x32_bf16 v[88:91], a[48:51], v[144:147], v[88:91]
    v_and_b32 v173, 0xffff0000, v160
    v_lshlrev_b32 v174, 16, v161
    v_mfma_f32_16x16x32_bf16 v[112:115], a[48:51], v[148:151], v[112:115]
    v_and_b32 v175, 0xffff0000, v161
    s_waitcnt vmcnt(8)
    v_mfma_f32_16x16x32_bf16 v[44:47], a[0:3], v[248:251], v[44:47]
    v_lshlrev_b32 v176, 16, v162
    v_and_b32 v177, 0xffff0000, v162
    v_mfma_f32_16x16x32_bf16 v[68:71], a[0:3], v[252:255], v[68:71]
    v_lshlrev_b32 v178, 16, v163
    v_and_b32 v179, 0xffff0000, v163
    v_mfma_f32_16x16x32_bf16 v[92:95], a[0:3], v[144:147], v[92:95]
    v_lshlrev_b32 v180, 16, v164
    v_and_b32 v181, 0xffff0000, v164
    v_mfma_f32_16x16x32_bf16 v[116:119], a[0:3], v[148:151], v[116:119]
    v_lshlrev_b32 v182, 16, v165
    s_waitcnt vmcnt(7)
    v_mfma_f32_16x16x32_bf16 v[48:51], a[4:7], v[248:251], v[48:51]
    s_add_u32 s80, s97, 16384
    s_add_u32 m0, s81, 16384
    v_mfma_f32_16x16x32_bf16 v[72:75], a[4:7], v[252:255], v[72:75]
    buffer_load_dwordx4 v1, s[4:7], s80 offen sc1 lds
    v_and_b32 v183, 0xffff0000, v165
    v_mfma_f32_16x16x32_bf16 v[96:99], a[4:7], v[144:147], v[96:99]
    v_lshlrev_b32 v184, 16, v166
    v_and_b32 v185, 0xffff0000, v166
    v_mfma_f32_16x16x32_bf16 v[120:123], a[4:7], v[148:151], v[120:123]
    v_lshlrev_b32 v186, 16, v167
    s_waitcnt vmcnt(7)
    v_mfma_f32_16x16x32_bf16 v[52:55], a[8:11], v[248:251], v[52:55]
    v_and_b32 v187, 0xffff0000, v167
    v_lshlrev_b32 v188, 16, v168
    v_mfma_f32_16x16x32_bf16 v[76:79], a[8:11], v[252:255], v[76:79]
    v_and_b32 v189, 0xffff0000, v168
    v_lshlrev_b32 v190, 16, v169
    v_mfma_f32_16x16x32_bf16 v[100:103], a[8:11], v[144:147], v[100:103]
    v_and_b32 v191, 0xffff0000, v169
    v_lshlrev_b32 v192, 16, v170
    v_mfma_f32_16x16x32_bf16 v[124:127], a[8:11], v[148:151], v[124:127]
    v_and_b32 v193, 0xffff0000, v170
    s_waitcnt vmcnt(6)
    v_mfma_f32_16x16x32_bf16 v[56:59], a[12:15], v[248:251], v[56:59]
    s_add_u32 s80, s97, 20480
    s_add_u32 m0, s81, 20480
    v_mfma_f32_16x16x32_bf16 v[80:83], a[12:15], v[252:255], v[80:83]
    buffer_load_dwordx4 v1, s[4:7], s80 offen sc1 lds
    v_lshlrev_b32 v194, 16, v171
    v_mfma_f32_16x16x32_bf16 v[104:107], a[12:15], v[144:147], v[104:107]
    v_and_b32 v195, 0xffff0000, v171
    v_lshlrev_b32 v196, 16, v196
    v_mfma_f32_16x16x32_bf16 v[128:131], a[12:15], v[148:151], v[128:131]
    s_add_u32 s65, s65, 14901248
    s_waitcnt vmcnt(6)
    v_mfma_f32_16x16x32_bf16 v[60:63], a[16:19], v[248:251], v[60:63]
    v_mfma_f32_16x16x32_bf16 v[84:87], a[16:19], v[252:255], v[84:87]
    v_mfma_f32_16x16x32_bf16 v[108:111], a[16:19], v[144:147], v[108:111]
    v_mfma_f32_16x16x32_bf16 v[132:135], a[16:19], v[148:151], v[132:135]
    v_cvt_pk_bf16_f32 v64, v64, v65
    v_cvt_pk_bf16_f32 v65, v66, v67
    v_cvt_pk_bf16_f32 v66, v68, v69
    v_cvt_pk_bf16_f32 v67, v70, v71
    ds_write_b128 v33, v[64:67] offset:0
    v_cvt_pk_bf16_f32 v72, v72, v73
    v_cvt_pk_bf16_f32 v73, v74, v75
    v_cvt_pk_bf16_f32 v74, v76, v77
    v_cvt_pk_bf16_f32 v75, v78, v79
    ds_write_b128 v33, v[72:75] offset:1024
    v_cvt_pk_bf16_f32 v80, v80, v81
    v_cvt_pk_bf16_f32 v81, v82, v83
    v_cvt_pk_bf16_f32 v82, v84, v85
    v_cvt_pk_bf16_f32 v83, v86, v87
    ds_write_b128 v33, v[80:83] offset:2048
    s_add_u32 s80, s97, 24576
    s_add_u32 m0, s81, 24576
    s_nop 0
    buffer_load_dwordx4 v1, s[4:7], s80 offen sc1 lds
    v_cvt_pk_bf16_f32 v88, v88, v89
    v_cvt_pk_bf16_f32 v89, v90, v91
    v_cvt_pk_bf16_f32 v90, v92, v93
    v_cvt_pk_bf16_f32 v91, v94, v95
    ds_write_b128 v34, v[88:91] offset:3072
    v_cvt_pk_bf16_f32 v96, v96, v97
    v_cvt_pk_bf16_f32 v97, v98, v99
    v_cvt_pk_bf16_f32 v98, v100, v101
    v_cvt_pk_bf16_f32 v99, v102, v103
    ds_write_b128 v34, v[96:99] offset:4096
    v_cvt_pk_bf16_f32 v104, v104, v105
    v_cvt_pk_bf16_f32 v105, v106, v107
    v_cvt_pk_bf16_f32 v106, v108, v109
    v_cvt_pk_bf16_f32 v107, v110, v111
    ds_write_b128 v34, v[104:107] offset:5120
    s_add_u32 s80, s97, 28672
    s_add_u32 m0, s81, 28672
    s_nop 0
    buffer_load_dwordx4 v1, s[4:7], s80 offen sc1 lds
    v_cvt_pk_bf16_f32 v112, v112, v113
    v_cvt_pk_bf16_f32 v113, v114, v115
    v_cvt_pk_bf16_f32 v114, v116, v117
    v_cvt_pk_bf16_f32 v115, v118, v119
    ds_write_b128 v35, v[112:115] offset:6144
    v_cvt_pk_bf16_f32 v120, v120, v121
    v_cvt_pk_bf16_f32 v121, v122, v123
    v_cvt_pk_bf16_f32 v122, v124, v125
    v_cvt_pk_bf16_f32 v123, v126, v127
    ds_write_b128 v35, v[120:123] offset:7168
    v_cvt_pk_bf16_f32 v128, v128, v129
    v_cvt_pk_bf16_f32 v129, v130, v131
    v_cvt_pk_bf16_f32 v130, v132, v133
    v_cvt_pk_bf16_f32 v131, v134, v135
    ds_write_b128 v37, v[128:131] offset:0
    s_add_u32 s80, s97, 32768
    s_add_u32 m0, s81, 135168
    s_nop 0
    buffer_load_dwordx4 v1, s[4:7], s80 offen sc1 lds
    v_mov_b32 v148, 0x3f80
    v_mov_b32 v149, 0x3f800000
    v_pk_add_f32 v[40:41], v[40:41], v[196:197] op_sel:[0,0] op_sel_hi:[1,0]
    v_pk_add_f32 v[42:43], v[42:43], v[196:197] op_sel:[0,0] op_sel_hi:[1,0]
    v_pk_add_f32 v[44:45], v[44:45], v[196:197] op_sel:[0,0] op_sel_hi:[1,0]
    v_pk_add_f32 v[46:47], v[46:47], v[196:197] op_sel:[0,0] op_sel_hi:[1,0]
    v_pk_add_f32 v[48:49], v[48:49], v[196:197] op_sel:[0,0] op_sel_hi:[1,0]
    v_pk_add_f32 v[50:51], v[50:51], v[196:197] op_sel:[0,0] op_sel_hi:[1,0]
    v_pk_add_f32 v[52:53], v[52:53], v[196:197] op_sel:[0,0] op_sel_hi:[1,0]
    v_pk_add_f32 v[54:55], v[54:55], v[196:197] op_sel:[0,0] op_sel_hi:[1,0]
    v_pk_add_f32 v[56:57], v[56:57], v[196:197] op_sel:[0,0] op_sel_hi:[1,0]
    v_pk_add_f32 v[58:59], v[58:59], v[196:197] op_sel:[0,0] op_sel_hi:[1,0]
    v_pk_add_f32 v[60:61], v[60:61], v[196:197] op_sel:[0,0] op_sel_hi:[1,0]
    v_pk_add_f32 v[62:63], v[62:63], v[196:197] op_sel:[0,0] op_sel_hi:[1,0]
    s_waitcnt lgkmcnt(0)
    s_barrier
    ds_read_b128 v[64:67], v32 offset:0
    ds_read_b128 v[88:91], v32 offset:3072
    ds_read_b128 v[112:115], v32 offset:6144
    ds_read_b128 v[72:75], v32 offset:1024
    ds_read_b128 v[96:99], v32 offset:4096
    ds_read_b128 v[120:123], v32 offset:7168
    ds_read_b128 v[80:83], v32 offset:2048
    ds_read_b128 v[104:107], v32 offset:5120
    ds_read_b128 v[128:131], v36 offset:0
    s_add_u32 s80, s97, 36864
    s_add_u32 m0, s81, 139264
    s_nop 0
    buffer_load_dwordx4 v1, s[4:7], s80 offen sc1 lds
    s_add_u32 s80, s97, 40960
    s_add_u32 m0, s81, 143360
    s_nop 0
    buffer_load_dwordx4 v1, s[4:7], s80 offen sc1 lds
    s_add_u32 s80, s97, 45056
    s_add_u32 m0, s81, 147456
    s_nop 0
    buffer_load_dwordx4 v1, s[4:7], s80 offen sc1 lds
    s_add_u32 s80, s97, 49152
    s_add_u32 m0, s81, 151552
    s_nop 0
    buffer_load_dwordx4 v1, s[4:7], s80 offen sc1 lds
    s_add_u32 s80, s97, 53248
    s_add_u32 m0, s81, 65536
    s_nop 0
    buffer_load_dwordx4 v1, s[4:7], s80 offen sc1 lds
    s_add_u32 s80, s97, 57344
    s_add_u32 m0, s81, 69632
    s_nop 0
    buffer_load_dwordx4 v1, s[4:7], s80 offen sc1 lds
    s_waitcnt lgkmcnt(6)
    v_dot2c_f32_bf16 v40, v64, v148
    v_dot2c_f32_bf16 v41, v64, v149
    v_dot2c_f32_bf16 v42, v65, v148
    v_dot2c_f32_bf16 v43, v65, v149
    v_dot2c_f32_bf16 v44, v66, v148
    v_dot2c_f32_bf16 v45, v66, v149
    v_dot2c_f32_bf16 v46, v67, v148
    v_dot2c_f32_bf16 v47, v67, v149
    v_dot2c_f32_bf16 v40, v88, v148
    v_dot2c_f32_bf16 v41, v88, v149
    v_dot2c_f32_bf16 v42, v89, v148
    v_dot2c_f32_bf16 v43, v89, v149
    v_dot2c_f32_bf16 v44, v90, v148
    v_dot2c_f32_bf16 v45, v90, v149
    v_dot2c_f32_bf16 v46, v91, v148
    v_dot2c_f32_bf16 v47, v91, v149
    v_dot2c_f32_bf16 v40, v112, v148
    v_dot2c_f32_bf16 v41, v112, v149
    v_dot2c_f32_bf16 v42, v113, v148
    v_dot2c_f32_bf16 v43, v113, v149
    v_dot2c_f32_bf16 v44, v114, v148
    v_dot2c_f32_bf16 v45, v114, v149
    v_dot2c_f32_bf16 v46, v115, v148
    v_dot2c_f32_bf16 v47, v115, v149
    v_pk_mul_f32 v[40:41], v[40:41], v[172:173] op_sel:[0,0] op_sel_hi:[1,1]
    v_pk_mul_f32 v[42:43], v[42:43], v[174:175] op_sel:[0,0] op_sel_hi:[1,1]
    v_pk_mul_f32 v[44:45], v[44:45], v[176:177] op_sel:[0,0] op_sel_hi:[1,1]
    v_pk_mul_f32 v[46:47], v[46:47], v[178:179] op_sel:[0,0] op_sel_hi:[1,1]
    v_cvt_pk_bf16_f32 v136, v40, v41
    v_cvt_pk_bf16_f32 v137, v42, v43
    v_cvt_pk_bf16_f32 v138, v44, v45
    v_cvt_pk_bf16_f32 v139, v46, v47
    s_cmp_eq_u32 s47, 0
    s_cbranch_scc1 Lsfast_62
    buffer_store_dwordx4 v[136:139], v1, s[4:7], s65 offen offset:0 sc1
    s_branch Lsdone_63
Lsfast_62:
    buffer_store_dwordx4 v[136:139], v1, s[4:7], s65 offen offset:0
Lsdone_63:
    s_waitcnt lgkmcnt(3)
    v_dot2c_f32_bf16 v48, v72, v148
    v_dot2c_f32_bf16 v49, v72, v149
    v_dot2c_f32_bf16 v50, v73, v148
    v_dot2c_f32_bf16 v51, v73, v149
    v_dot2c_f32_bf16 v52, v74, v148
    v_dot2c_f32_bf16 v53, v74, v149
    v_dot2c_f32_bf16 v54, v75, v148
    v_dot2c_f32_bf16 v55, v75, v149
    v_dot2c_f32_bf16 v48, v96, v148
    v_dot2c_f32_bf16 v49, v96, v149
    v_dot2c_f32_bf16 v50, v97, v148
    v_dot2c_f32_bf16 v51, v97, v149
    v_dot2c_f32_bf16 v52, v98, v148
    v_dot2c_f32_bf16 v53, v98, v149
    v_dot2c_f32_bf16 v54, v99, v148
    v_dot2c_f32_bf16 v55, v99, v149
    v_dot2c_f32_bf16 v48, v120, v148
    v_dot2c_f32_bf16 v49, v120, v149
    v_dot2c_f32_bf16 v50, v121, v148
    v_dot2c_f32_bf16 v51, v121, v149
    v_dot2c_f32_bf16 v52, v122, v148
    v_dot2c_f32_bf16 v53, v122, v149
    v_dot2c_f32_bf16 v54, v123, v148
    v_dot2c_f32_bf16 v55, v123, v149
    v_pk_mul_f32 v[48:49], v[48:49], v[180:181] op_sel:[0,0] op_sel_hi:[1,1]
    v_pk_mul_f32 v[50:51], v[50:51], v[182:183] op_sel:[0,0] op_sel_hi:[1,1]
    v_pk_mul_f32 v[52:53], v[52:53], v[184:185] op_sel:[0,0] op_sel_hi:[1,1]
    v_pk_mul_f32 v[54:55], v[54:55], v[186:187] op_sel:[0,0] op_sel_hi:[1,1]
    v_cvt_pk_bf16_f32 v140, v48, v49
    v_cvt_pk_bf16_f32 v141, v50, v51
    v_cvt_pk_bf16_f32 v142, v52, v53
    v_cvt_pk_bf16_f32 v143, v54, v55
    s_cmp_eq_u32 s47, 0
    s_cbranch_scc1 Lsfast_64
    buffer_store_dwordx4 v[140:143], v1, s[4:7], s65 offen offset:1024 sc1
    s_branch Lsdone_65
Lsfast_64:
    buffer_store_dwordx4 v[140:143], v1, s[4:7], s65 offen offset:1024
Lsdone_65:
    s_waitcnt lgkmcnt(0)
    s_barrier
    v_dot2c_f32_bf16 v56, v80, v148
    v_dot2c_f32_bf16 v57, v80, v149
    v_dot2c_f32_bf16 v58, v81, v148
    v_dot2c_f32_bf16 v59, v81, v149
    v_dot2c_f32_bf16 v60, v82, v148
    v_dot2c_f32_bf16 v61, v82, v149
    v_dot2c_f32_bf16 v62, v83, v148
    v_dot2c_f32_bf16 v63, v83, v149
    v_dot2c_f32_bf16 v56, v104, v148
    v_dot2c_f32_bf16 v57, v104, v149
    v_dot2c_f32_bf16 v58, v105, v148
    v_dot2c_f32_bf16 v59, v105, v149
    v_dot2c_f32_bf16 v60, v106, v148
    v_dot2c_f32_bf16 v61, v106, v149
    v_dot2c_f32_bf16 v62, v107, v148
    v_dot2c_f32_bf16 v63, v107, v149
    v_dot2c_f32_bf16 v56, v128, v148
    v_dot2c_f32_bf16 v57, v128, v149
    v_dot2c_f32_bf16 v58, v129, v148
    v_dot2c_f32_bf16 v59, v129, v149
    v_dot2c_f32_bf16 v60, v130, v148
    v_dot2c_f32_bf16 v61, v130, v149
    v_dot2c_f32_bf16 v62, v131, v148
    v_dot2c_f32_bf16 v63, v131, v149
    v_pk_mul_f32 v[56:57], v[56:57], v[188:189] op_sel:[0,0] op_sel_hi:[1,1]
    v_pk_mul_f32 v[58:59], v[58:59], v[190:191] op_sel:[0,0] op_sel_hi:[1,1]
    v_pk_mul_f32 v[60:61], v[60:61], v[192:193] op_sel:[0,0] op_sel_hi:[1,1]
    v_pk_mul_f32 v[62:63], v[62:63], v[194:195] op_sel:[0,0] op_sel_hi:[1,1]
    v_cvt_pk_bf16_f32 v144, v56, v57
    v_cvt_pk_bf16_f32 v145, v58, v59
    v_cvt_pk_bf16_f32 v146, v60, v61
    v_cvt_pk_bf16_f32 v147, v62, v63
    s_cmp_eq_u32 s47, 0
    s_cbranch_scc1 Lsfast_66
    buffer_store_dwordx4 v[144:147], v1, s[4:7], s65 offen offset:2048 sc1
    s_branch Lsdone_67
Lsfast_66:
    buffer_store_dwordx4 v[144:147], v1, s[4:7], s65 offen offset:2048
Lsdone_67:
    s_add_u32 s80, s97, 61440
    s_add_u32 m0, s81, 106496
    s_nop 0
    buffer_load_dwordx4 v1, s[4:7], s80 offen sc1 lds
    s_add_u32 s80, s97, 65536
    s_add_u32 m0, s81, 110592
    s_nop 0
    buffer_load_dwordx4 v1, s[4:7], s80 offen sc1 lds
    s_add_u32 s80, s97, 69632
    s_add_u32 m0, s81, 114688
    s_nop 0
    buffer_load_dwordx4 v1, s[4:7], s80 offen sc1 lds
    s_add_u32 s80, s97, 73728
    s_add_u32 m0, s81, 118784
    s_nop 0
    buffer_load_dwordx4 v1, s[4:7], s80 offen sc1 lds
    s_add_u32 s80, s97, 77824
    s_add_u32 m0, s81, 122880
    s_nop 0
    buffer_load_dwordx4 v1, s[4:7], s80 offen sc1 lds
    s_add_u32 s80, s97, 81920
    s_add_u32 m0, s81, 126976
    s_nop 0
    buffer_load_dwordx4 v1, s[4:7], s80 offen sc1 lds
    s_waitcnt vmcnt(6)
    v_mov_b32 v24, s50
    v_mov_b32 v25, 0
    s_mov_b64 exec, 1
    s_cmp_eq_u32 s47, 0
    s_cbranch_scc1 Lsfast_68
    buffer_store_dword v24, v25, s[4:7], s67 offen sc1
    s_branch Lsdone_69
Lsfast_68:
    buffer_store_dword v24, v25, s[4:7], s67 offen
Lsdone_69:
    s_mov_b64 exec, -1
    s_add_u32 s80, s97, 86016
    s_add_u32 m0, s81, 32768
    s_nop 0
    buffer_load_dwordx4 v1, s[4:7], s80 offen sc1 lds
    s_add_u32 s80, s97, 90112
    s_add_u32 m0, s81, 36864
    s_nop 0
    buffer_load_dwordx4 v1, s[4:7], s80 offen sc1 lds
    s_add_u32 s80, s97, 94208
    s_add_u32 m0, s81, 40960
    s_nop 0
    buffer_load_dwordx4 v1, s[4:7], s80 offen sc1 lds
    s_add_u32 s80, s97, 98304
    s_add_u32 m0, s81, 45056
    s_nop 0
    buffer_load_dwordx4 v1, s[4:7], s80 offen sc1 lds
    s_add_u32 s80, s97, 102400
    s_add_u32 m0, s81, 49152
    s_nop 0
    buffer_load_dwordx4 v1, s[4:7], s80 offen sc1 lds
    s_add_u32 s80, s97, 106496
    s_add_u32 m0, s81, 53248
    s_nop 0
    buffer_load_dwordx4 v1, s[4:7], s80 offen sc1 lds
    s_add_u32 s80, s97, 110592
    s_add_u32 m0, s81, 57344
    s_nop 0
    buffer_load_dwordx4 v1, s[4:7], s80 offen sc1 lds
    s_add_u32 s80, s97, 114688
    s_add_u32 m0, s81, 61440
    s_nop 0
    buffer_load_dwordx4 v1, s[4:7], s80 offen sc1 lds
    s_add_u32 s80, s97, 118784
    s_add_u32 m0, s81, 131072
    s_nop 0
    buffer_load_dwordx4 v1, s[4:7], s80 offen sc1 lds
    s_cmp_eq_u32 s48, 0
    s_cbranch_scc0 Ll0_70
    s_add_u32 s80, s51, 0
    s_add_u32 m0, s81, 73728
    s_nop 0
    buffer_load_dwordx4 v1, s[4:7], s80 offen sc1 lds
    s_add_u32 s80, s51, 4096
    s_add_u32 m0, s81, 77824
    s_nop 0
    buffer_load_dwordx4 v1, s[4:7], s80 offen sc1 lds
Ll0_70:
    s_waitcnt lgkmcnt(0)
    s_lshl_b32 s66, s45, 2
    s_add_u32 s66, s66, s55
    s_lshl_b32 s66, s66, 1
    s_lshr_b32 s60, s44, 1
    s_add_u32 s66, s66, s60
    s_lshl_b32 s63, s58, 5
    s_add_u32 s63, s63, 8192
    v_lshlrev_b32 v26, 2, v15
    s_mul_i32 s64, s58, 24576
    s_add_u32 s64, s64, s49
    s_add_u32 s64, s64, 14901248
    v_lshlrev_b32 v40, 16, v4
    v_and_b32 v41, 0xffff0000, v4
    v_lshlrev_b32 v42, 16, v5
    v_and_b32 v43, 0xffff0000, v5
    v_lshlrev_b32 v44, 16, v6
    v_and_b32 v45, 0xffff0000, v6
    v_lshlrev_b32 v46, 16, v7
    v_and_b32 v47, 0xffff0000, v7
    v_lshlrev_b32 v48, 16, v8
    v_and_b32 v49, 0xffff0000, v8
    v_lshlrev_b32 v50, 16, v9
    v_and_b32 v51, 0xffff0000, v9
    v_lshlrev_b32 v52, 16, v10
    v_and_b32 v53, 0xffff0000, v10
    v_lshlrev_b32 v54, 16, v11
    v_and_b32 v55, 0xffff0000, v11
    v_lshlrev_b32 v56, 16, v12
    v_and_b32 v57, 0xffff0000, v12
    v_lshlrev_b32 v58, 16, v13
    v_and_b32 v59, 0xffff0000, v13
    s_mul_i32 s67, s58, 20480
    v_mov_b32 v27, v20
    v_mov_b32 v28, v21
    s_add_u32 s67, s67, s49
    s_add_u32 s67, s67, 0
    s_lshl_b32 s68, s58, 10
    s_lshl_b32 s61, s56, 7
    s_add_u32 s68, s68, s61
    s_add_u32 s68, s68, s49
    s_add_u32 s68, s68, 7823360
    s_lshl_b32 s69, s66, 3
    s_add_u32 s69, s69, s56
    s_lshl_b32 s69, s69, 1
    s_and_b32 s60, s44, 1
    s_add_u32 s69, s69, s60
    s_lshl_b32 s69, s69, 2
    s_add_u32 s69, s69, 12288
    v_lshlrev_b32 v29, 2, v23
    s_mov_b64 exec, 0xff
    s_mov_b32 s82, 0
Lpoll_71:
    buffer_load_dword v24, v26, s[4:7], s63 offen sc1
    s_add_u32 s82, s82, 1
    s_waitcnt vmcnt(0)
    v_cmp_eq_u32 vcc, s50, v24
    s_cmp_eq_u64 vcc, exec
    s_cbranch_scc1 Lpdone_72
    s_cmp_lt_u32 s82, 200000
    s_cbranch_scc1 Lpoll_71
    s_branch LEND
Lpdone_72:
    s_mov_b64 exec, -1
    s_add_u32 s84, s64, 0
    buffer_load_dwordx4 a[0:3], v1, s[4:7], s84 offen offset:0 sc1
    buffer_load_dwordx4 a[4:7], v1, s[4:7], s84 offen offset:1024 sc1
    buffer_load_dwordx4 a[8:11], v1, s[4:7], s84 offen offset:2048 sc1
    buffer_load_dwordx4 a[12:15], v1, s[4:7], s84 offen offset:3072 sc1
    s_add_u32 s85, s64, 4096
    buffer_load_dwordx4 a[16:19], v1, s[4:7], s85 offen offset:0 sc1
    buffer_load_dwordx4 a[20:23], v1, s[4:7], s85 offen offset:1024 sc1
    buffer_load_dwordx4 a[24:27], v1, s[4:7], s85 offen offset:2048 sc1
    buffer_load_dwordx4 a[28:31], v1, s[4:7], s85 offen offset:3072 sc1
    s_barrier
    ds_read_b128 v[104:107], v1 offset:0
    ds_read_b128 v[108:111], v1 offset:1024
    ds_read_b128 v[112:115], v1 offset:2048
    ds_read_b128 v[116:119], v1 offset:3072
    ds_read_b128 v[120:123], v1 offset:4096
    ds_read_b128 v[124:127], v1 offset:5120
    ds_read_b128 v[128:131], v1 offset:6144
    ds_read_b128 v[132:135], v1 offset:7168
    ds_read_b128 v[136:139], v1 offset:8192
    ds_read_b128 v[140:143], v1 offset:9216
    ds_read_b128 v[144:147], v1 offset:10240
    ds_read_b128 v[148:151], v1 offset:11264
    ds_read_b128 v[152:155], v1 offset:12288
    s_waitcnt vmcnt(7) lgkmcnt(8)
    v_mfma_f32_16x16x32_bf16 v[40:43], v[104:107], a[0:3], v[40:43]
    ds_read_b128 v[156:159], v1 offset:13312
    v_mfma_f32_16x16x32_bf16 v[44:47], v[108:111], a[0:3], v[44:47]
    ds_read_b128 v[104:107], v1 offset:14336
    s_add_u32 s86, s64, 8192
    buffer_load_dwordx4 a[32:35], v1, s[4:7], s86 offen offset:0 sc1
    v_mfma_f32_16x16x32_bf16 v[48:51], v[112:115], a[0:3], v[48:51]
    ds_read_b128 v[108:111], v1 offset:15360
    v_mfma_f32_16x16x32_bf16 v[52:55], v[116:119], a[0:3], v[52:55]
    ds_read_b128 v[112:115], v1 offset:16384
    v_mfma_f32_16x16x32_bf16 v[56:59], v[120:123], a[0:3], v[56:59]
    ds_read_b128 v[116:119], v1 offset:17408
    s_waitcnt vmcnt(7) lgkmcnt(8)
    v_mfma_f32_16x16x32_bf16 v[40:43], v[124:127], a[4:7], v[40:43]
    ds_read_b128 v[120:123], v1 offset:18432
    v_mfma_f32_16x16x32_bf16 v[44:47], v[128:131], a[4:7], v[44:47]
    ds_read_b128 v[124:127], v1 offset:19456
    buffer_load_dwordx4 a[36:39], v1, s[4:7], s86 offen offset:1024 sc1
    v_mfma_f32_16x16x32_bf16 v[48:51], v[132:135], a[4:7], v[48:51]
    ds_read_b128 v[128:131], v1 offset:20480
    v_mfma_f32_16x16x32_bf16 v[52:55], v[136:139], a[4:7], v[52:55]
    ds_read_b128 v[132:135], v1 offset:21504
    v_mfma_f32_16x16x32_bf16 v[56:59], v[140:143], a[4:7], v[56:59]
    ds_read_b128 v[136:139], v1 offset:22528
    s_waitcnt vmcnt(7) lgkmcnt(8)
    v_mfma_f32_16x16x32_bf16 v[40:43], v[144:147], a[8:11], v[40:43]
    ds_read_b128 v[140:143], v1 offset:23552
    v_mfma_f32_16x16x32_bf16 v[44:47], v[148:151], a[8:11], v[44:47]
    ds_read_b128 v[144:147], v1 offset:24576
    buffer_load_dwordx4 a[40:43], v1, s[4:7], s86 offen offset:2048 sc1
    v_mfma_f32_16x16x32_bf16 v[48:51], v[152:155], a[8:11], v[48:51]
    ds_read_b128 v[148:151], v1 offset:25600
    v_mfma_f32_16x16x32_bf16 v[52:55], v[156:159], a[8:11], v[52:55]
    ds_read_b128 v[152:155], v1 offset:26624
    v_mfma_f32_16x16x32_bf16 v[56:59], v[104:107], a[8:11], v[56:59]
    ds_read_b128 v[156:159], v1 offset:27648
    s_waitcnt vmcnt(7) lgkmcnt(8)
    v_mfma_f32_16x16x32_bf16 v[40:43], v[108:111], a[12:15], v[40:43]
    ds_read_b128 v[104:107], v1 offset:28672
    v_mfma_f32_16x16x32_bf16 v[44:47], v[112:115], a[12:15], v[44:47]
    ds_read_b128 v[108:111], v1 offset:29696
    buffer_load_dwordx4 a[44:47], v1, s[4:7], s86 offen offset:3072 sc1
    v_mfma_f32_16x16x32_bf16 v[48:51], v[116:119], a[12:15], v[48:51]
    ds_read_b128 v[112:115], v1 offset:30720
    v_mfma_f32_16x16x32_bf16 v[52:55], v[120:123], a[12:15], v[52:55]
    ds_read_b128 v[116:119], v1 offset:31744
    v_mfma_f32_16x16x32_bf16 v[56:59], v[124:127], a[12:15], v[56:59]
    ds_read_b128 v[120:123], v3 offset:4096
    s_waitcnt vmcnt(7) lgkmcnt(8)
    v_mfma_f32_16x16x32_bf16 v[40:43], v[128:131], a[16:19], v[40:43]
    ds_read_b128 v[124:127], v3 offset:5120
    v_mfma_f32_16x16x32_bf16 v[44:47], v[132:135], a[16:19], v[44:47]
    ds_read_b128 v[128:131], v3 offset:6144
    s_add_u32 s87, s64, 12288
    buffer_load_dwordx4 a[48:51], v1, s[4:7], s87 offen offset:0 sc1
    v_mfma_f32_16x16x32_bf16 v[48:51], v[136:139], a[16:19], v[48:51]
    ds_read_b128 v[132:135], v3 offset:7168
    v_mfma_f32_16x16x32_bf16 v[52:55], v[140:143], a[16:19], v[52:55]
    ds_read_b128 v[136:139], v3 offset:8192
    v_mfma_f32_16x16x32_bf16 v[56:59], v[144:147], a[16:19], v[56:59]
    ds_read_b128 v[140:143], v3 offset:9216
    s_waitcnt vmcnt(7) lgkmcnt(8)
    v_mfma_f32_16x16x32_bf16 v[40:43], v[148:151], a[20:23], v[40:43]
    ds_read_b128 v[144:147], v3 offset:10240
    v_mfma_f32_16x16x32_bf16 v[44:47], v[152:155], a[20:23], v[44:47]
    ds_read_b128 v[148:151], v3 offset:11264
    buffer_load_dwordx4 a[52:55], v1, s[4:7], s87 offen offset:1024 sc1
    v_mfma_f32_16x16x32_bf16 v[48:51], v[156:159], a[20:23], v[48:51]
    ds_read_b128 v[152:155], v3 offset:12288
    v_mfma_f32_16x16x32_bf16 v[52:55], v[104:107], a[20:23], v[52:55]
    ds_read_b128 v[156:159], v3 offset:13312
    v_mfma_f32_16x16x32_bf16 v[56:59], v[108:111], a[20:23], v[56:59]
    ds_read_b128 v[104:107], v3 offset:14336
    s_waitcnt vmcnt(7) lgkmcnt(8)
    v_mfma_f32_16x16x32_bf16 v[40:43], v[112:115], a[24:27], v[40:43]
    ds_read_b128 v[108:111], v3 offset:15360
    v_mfma_f32_16x16x32_bf16 v[44:47], v[116:119], a[24:27], v[44:47]
    ds_read_b128 v[112:115], v3 offset:16384
    buffer_load_dwordx4 a[56:59], v1, s[4:7], s87 offen offset:2048 sc1
    v_mfma_f32_16x16x32_bf16 v[48:51], v[120:123], a[24:27], v[48:51]
    ds_read_b128 v[116:119], v3 offset:17408
    v_mfma_f32_16x16x32_bf16 v[52:55], v[124:127], a[24:27], v[52:55]
    ds_read_b128 v[120:123], v3 offset:18432
    v_mfma_f32_16x16x32_bf16 v[56:59], v[128:131], a[24:27], v[56:59]
    ds_read_b128 v[124:127], v3 offset:19456
    s_waitcnt vmcnt(7) lgkmcnt(8)
    v_mfma_f32_16x16x32_bf16 v[40:43], v[132:135], a[28:31], v[40:43]
    ds_read_b128 v[128:131], v3 offset:20480
    v_mfma_f32_16x16x32_bf16 v[44:47], v[136:139], a[28:31], v[44:47]
    ds_read_b128 v[132:135], v3 offset:21504
    buffer_load_dwordx4 a[60:63], v1, s[4:7], s87 offen offset:3072 sc1
    v_mfma_f32_16x16x32_bf16 v[48:51], v[140:143], a[28:31], v[48:51]
    ds_read_b128 v[136:139], v3 offset:22528
    v_mfma_f32_16x16x32_bf16 v[52:55], v[144:147], a[28:31], v[52:55]
    ds_read_b128 v[140:143], v3 offset:23552
    v_mfma_f32_16x16x32_bf16 v[56:59], v[148:151], a[28:31], v[56:59]
    ds_read_b128 v[144:147], v2 offset:0
    s_waitcnt vmcnt(7) lgkmcnt(8)
    v_mfma_f32_16x16x32_bf16 v[40:43], v[152:155], a[32:35], v[40:43]
    ds_read_b128 v[148:151], v2 offset:1024
    v_mfma_f32_16x16x32_bf16 v[44:47], v[156:159], a[32:35], v[44:47]
    ds_read_b128 v[152:155], v2 offset:2048
    s_add_u32 s84, s64, 16384
    buffer_load_dwordx4 a[64:67], v1, s[4:7], s84 offen offset:0 sc1
    v_mfma_f32_16x16x32_bf16 v[48:51], v[104:107], a[32:35], v[48:51]
    ds_read_b128 v[156:159], v2 offset:3072
    v_mfma_f32_16x16x32_bf16 v[52:55], v[108:111], a[32:35], v[52:55]
    ds_read_b128 v[104:107], v2 offset:4096
    v_mfma_f32_16x16x32_bf16 v[56:59], v[112:115], a[32:35], v[56:59]
    ds_read_b128 v[108:111], v2 offset:5120
    s_waitcnt vmcnt(7) lgkmcnt(8)
    v_mfma_f32_16x16x32_bf16 v[40:43], v[116:119], a[36:39], v[40:43]
    ds_read_b128 v[112:115], v2 offset:6144
    v_mfma_f32_16x16x32_bf16 v[44:47], v[120:123], a[36:39], v[44:47]
    ds_read_b128 v[116:119], v2 offset:7168
    buffer_load_dwordx4 a[68:71], v1, s[4:7], s84 offen offset:1024 sc1
    v_mfma_f32_16x16x32_bf16 v[48:51], v[124:127], a[36:39], v[48:51]
    ds_read_b128 v[120:123], v2 offset:40960
    v_mfma_f32_16x16x32_bf16 v[52:55], v[128:131], a[36:39], v[52:55]
    ds_read_b128 v[124:127], v2 offset:41984
    v_mfma_f32_16x16x32_bf16 v[56:59], v[132:135], a[36:39], v[56:59]
    ds_read_b128 v[128:131], v2 offset:43008
    s_waitcnt vmcnt(7) lgkmcnt(8)
    v_mfma_f32_16x16x32_bf16 v[40:43], v[136:139], a[40:43], v[40:43]
    ds_read_b128 v[132:135], v2 offset:44032
    v_mfma_f32_16x16x32_bf16 v[44:47], v[140:143], a[40:43], v[44:47]
    ds_read_b128 v[136:139], v2 offset:45056
    buffer_load_dwordx4 a[72:75], v1, s[4:7], s84 offen offset:2048 sc1
    v_mfma_f32_16x16x32_bf16 v[48:51], v[144:147], a[40:43], v[48:51]
    ds_read_b128 v[140:143], v2 offset:46080
    v_mfma_f32_16x16x32_bf16 v[52:55], v[148:151], a[40:43], v[52:55]
    ds_read_b128 v[144:147], v2 offset:47104
    v_mfma_f32_16x16x32_bf16 v[56:59], v[152:155], a[40:43], v[56:59]
    ds_read_b128 v[148:151], v2 offset:48128
    s_waitcnt vmcnt(7) lgkmcnt(8)
    v_mfma_f32_16x16x32_bf16 v[40:43], v[156:159], a[44:47], v[40:43]
    ds_read_b128 v[152:155], v2 offset:49152
    v_mfma_f32_16x16x32_bf16 v[44:47], v[104:107], a[44:47], v[44:47]
    ds_read_b128 v[156:159], v2 offset:50176
    buffer_load_dwordx4 a[76:79], v1, s[4:7], s84 offen offset:3072 sc1
    v_mfma_f32_16x16x32_bf16 v[48:51], v[108:111], a[44:47], v[48:51]
    ds_read_b128 v[104:107], v2 offset:51200
    v_mfma_f32_16x16x32_bf16 v[52:55], v[112:115], a[44:47], v[52:55]
    ds_read_b128 v[108:111], v2 offset:52224
    v_mfma_f32_16x16x32_bf16 v[56:59], v[116:119], a[44:47], v[56:59]
    ds_read_b128 v[112:115], v2 offset:53248
    s_waitcnt vmcnt(7) lgkmcnt(8)
    v_mfma_f32_16x16x32_bf16 v[40:43], v[120:123], a[48:51], v[40:43]
    ds_read_b128 v[116:119], v2 offset:54272
    v_mfma_f32_16x16x32_bf16 v[44:47], v[124:127], a[48:51], v[44:47]
    ds_read_b128 v[120:123], v2 offset:55296
    s_add_u32 s85, s64, 20480
    buffer_load_dwordx4 a[80:83], v1, s[4:7], s85 offen offset:0 sc1
    v_mfma_f32_16x16x32_bf16 v[48:51], v[128:131], a[48:51], v[48:51]
    ds_read_b128 v[124:127], v2 offset:56320
    v_mfma_f32_16x16x32_bf16 v[52:55], v[132:135], a[48:51], v[52:55]
    ds_read_b128 v[128:131], v2 offset:57344
    v_mfma_f32_16x16x32_bf16 v[56:59], v[136:139], a[48:51], v[56:59]
    ds_read_b128 v[132:135], v2 offset:58368
    s_waitcnt vmcnt(7) lgkmcnt(8)
    v_mfma_f32_16x16x32_bf16 v[40:43], v[140:143], a[52:55], v[40:43]
    ds_read_b128 v[136:139], v2 offset:59392
    v_mfma_f32_16x16x32_bf16 v[44:47], v[144:147], a[52:55], v[44:47]
    ds_read_b128 v[140:143], v2 offset:60416
    buffer_load_dwordx4 a[84:87], v1, s[4:7], s85 offen offset:1024 sc1
    v_mfma_f32_16x16x32_bf16 v[48:51], v[148:151], a[52:55], v[48:51]
    ds_read_b128 v[144:147], v2 offset:61440
    v_mfma_f32_16x16x32_bf16 v[52:55], v[152:155], a[52:55], v[52:55]
    ds_read_b128 v[148:151], v2 offset:62464
    v_mfma_f32_16x16x32_bf16 v[56:59], v[156:159], a[52:55], v[56:59]
    ds_read_b128 v[152:155], v2 offset:63488
    s_waitcnt vmcnt(7) lgkmcnt(8)
    v_mfma_f32_16x16x32_bf16 v[40:43], v[104:107], a[56:59], v[40:43]
    ds_read_b128 v[156:159], v2 offset:64512
    v_mfma_f32_16x16x32_bf16 v[44:47], v[108:111], a[56:59], v[44:47]
    ds_read_b128 v[104:107], v1 offset:32768
    buffer_load_dwordx4 a[88:91], v1, s[4:7], s85 offen offset:2048 sc1
    v_mfma_f32_16x16x32_bf16 v[48:51], v[112:115], a[56:59], v[48:51]
    ds_read_b128 v[108:111], v1 offset:33792
    v_mfma_f32_16x16x32_bf16 v[52:55], v[116:119], a[56:59], v[52:55]
    ds_read_b128 v[112:115], v1 offset:34816
    v_mfma_f32_16x16x32_bf16 v[56:59], v[120:123], a[56:59], v[56:59]
    ds_read_b128 v[116:119], v1 offset:35840
    s_waitcnt vmcnt(7) lgkmcnt(8)
    v_mfma_f32_16x16x32_bf16 v[40:43], v[124:127], a[60:63], v[40:43]
    ds_read_b128 v[120:123], v1 offset:36864
    v_mfma_f32_16x16x32_bf16 v[44:47], v[128:131], a[60:63], v[44:47]
    ds_read_b128 v[124:127], v1 offset:37888
    buffer_load_dwordx4 a[92:95], v1, s[4:7], s85 offen offset:3072 sc1
    v_mfma_f32_16x16x32_bf16 v[48:51], v[132:135], a[60:63], v[48:51]
    ds_read_b128 v[128:131], v1 offset:38912
    v_mfma_f32_16x16x32_bf16 v[52:55], v[136:139], a[60:63], v[52:55]
    ds_read_b128 v[132:135], v1 offset:39936
    s_mov_b32 exec_lo, 0x01110111
    s_mov_b32 exec_hi, 0x01110111
    buffer_load_dword v31, v27, s[36:39], s67 offen sc1
    buffer_load_dword v31, v27, s[36:39], s67 offen offset:1024 sc1
    buffer_load_dword v31, v28, s[36:39], s67 offen sc1
    buffer_load_dword v31, v29, s[4:7], s68 offen sc1
    s_mov_b64 exec, -1
    v_mfma_f32_16x16x32_bf16 v[56:59], v[140:143], a[60:63], v[56:59]
    ds_read_b128 v[136:139], v1 offset:40960
    s_waitcnt vmcnt(11) lgkmcnt(8)
    v_mfma_f32_16x16x32_bf16 v[40:43], v[144:147], a[64:67], v[40:43]
    ds_read_b128 v[140:143], v1 offset:41984
    v_mfma_f32_16x16x32_bf16 v[44:47], v[148:151], a[64:67], v[44:47]
    ds_read_b128 v[144:147], v1 offset:43008
    s_cmp_eq_u32 s48, 0
    s_cbranch_scc0 Ll0_73
    s_add_u32 s80, s51, 8192
    s_add_u32 m0, s81, 81920
    s_nop 0
    buffer_load_dwordx4 v1, s[4:7], s80 offen sc1 lds
    s_add_u32 s80, s51, 12288
    s_add_u32 m0, s81, 86016
    s_nop 0
    buffer_load_dwordx4 v1, s[4:7], s80 offen sc1 lds
Ll0_73:
    v_mfma_f32_16x16x32_bf16 v[48:51], v[152:155], a[64:67], v[48:51]
    ds_read_b128 v[148:151], v1 offset:44032
    v_mfma_f32_16x16x32_bf16 v[52:55], v[156:159], a[64:67], v[52:55]
    ds_read_b128 v[152:155], v1 offset:45056
    v_mfma_f32_16x16x32_bf16 v[56:59], v[104:107], a[64:67], v[56:59]
    ds_read_b128 v[156:159], v1 offset:46080
    s_waitcnt vmcnt(10) lgkmcnt(8)
    v_mfma_f32_16x16x32_bf16 v[40:43], v[108:111], a[68:71], v[40:43]
    ds_read_b128 v[104:107], v1 offset:47104
    v_mfma_f32_16x16x32_bf16 v[44:47], v[112:115], a[68:71], v[44:47]
    ds_read_b128 v[108:111], v1 offset:48128
    v_mfma_f32_16x16x32_bf16 v[48:51], v[116:119], a[68:71], v[48:51]
    ds_read_b128 v[112:115], v1 offset:49152
    v_mfma_f32_16x16x32_bf16 v[52:55], v[120:123], a[68:71], v[52:55]
    ds_read_b128 v[116:119], v1 offset:50176
    v_mfma_f32_16x16x32_bf16 v[56:59], v[124:127], a[68:71], v[56:59]
    ds_read_b128 v[120:123], v1 offset:51200
    s_waitcnt vmcnt(9) lgkmcnt(8)
    v_mfma_f32_16x16x32_bf16 v[40:43], v[128:131], a[72:75], v[40:43]
    ds_read_b128 v[124:127], v1 offset:52224
    v_mfma_f32_16x16x32_bf16 v[44:47], v[132:135], a[72:75], v[44:47]
    ds_read_b128 v[128:131], v1 offset:53248
    v_mfma_f32_16x16x32_bf16 v[48:51], v[136:139], a[72:75], v[48:51]
    ds_read_b128 v[132:135], v1 offset:54272
    v_mfma_f32_16x16x32_bf16 v[52:55], v[140:143], a[72:75], v[52:55]
    ds_read_b128 v[136:139], v1 offset:55296
    s_cmp_eq_u32 s48, 0
    s_cbranch_scc0 Ll0_74
    s_add_u32 s80, s51, 16384
    s_add_u32 m0, s81, 90112
    s_nop 0
    buffer_load_dwordx4 v1, s[4:7], s80 offen sc1 lds
    s_add_u32 s80, s51, 20480
    s_add_u32 m0, s81, 94208
    s_nop 0
    buffer_load_dwordx4 v1, s[4:7], s80 offen sc1 lds
Ll0_74:
    v_mfma_f32_16x16x32_bf16 v[56:59], v[144:147], a[72:75], v[56:59]
    ds_read_b128 v[140:143], v1 offset:56320
    s_waitcnt vmcnt(8) lgkmcnt(8)
    v_mfma_f32_16x16x32_bf16 v[40:43], v[148:151], a[76:79], v[40:43]
    ds_read_b128 v[144:147], v1 offset:57344
    v_mfma_f32_16x16x32_bf16 v[44:47], v[152:155], a[76:79], v[44:47]
    ds_read_b128 v[148:151], v1 offset:58368
    v_mfma_f32_16x16x32_bf16 v[48:51], v[156:159], a[76:79], v[48:51]
    ds_read_b128 v[152:155], v1 offset:59392
    v_mfma_f32_16x16x32_bf16 v[52:55], v[104:107], a[76:79], v[52:55]
    ds_read_b128 v[156:159], v1 offset:60416
    v_mfma_f32_16x16x32_bf16 v[56:59], v[108:111], a[76:79], v[56:59]
    ds_read_b128 v[104:107], v1 offset:61440
    s_waitcnt vmcnt(7) lgkmcnt(8)
    v_mfma_f32_16x16x32_bf16 v[40:43], v[112:115], a[80:83], v[40:43]
    ds_read_b128 v[108:111], v1 offset:62464
    v_mfma_f32_16x16x32_bf16 v[44:47], v[116:119], a[80:83], v[44:47]
    ds_read_b128 v[112:115], v1 offset:63488
    v_mfma_f32_16x16x32_bf16 v[48:51], v[120:123], a[80:83], v[48:51]
    ds_read_b128 v[116:119], v1 offset:64512
    v_mfma_f32_16x16x32_bf16 v[52:55], v[124:127], a[80:83], v[52:55]
    ds_read_b128 v[120:123], v3 offset:0
    v_mfma_f32_16x16x32_bf16 v[56:59], v[128:131], a[80:83], v[56:59]
    ds_read_b128 v[124:127], v3 offset:1024
    s_waitcnt vmcnt(6) lgkmcnt(8)
    v_mfma_f32_16x16x32_bf16 v[40:43], v[132:135], a[84:87], v[40:43]
    ds_read_b128 v[128:131], v3 offset:2048
    v_mfma_f32_16x16x32_bf16 v[44:47], v[136:139], a[84:87], v[44:47]
    ds_read_b128 v[132:135], v3 offset:3072
    s_cmp_eq_u32 s48, 0
    s_cbranch_scc0 Ll0_75
    s_add_u32 s80, s51, 24576
    s_add_u32 m0, s81, 98304
    s_nop 0
    buffer_load_dwordx4 v1, s[4:7], s80 offen sc1 lds
    s_add_u32 s80, s51, 28672
    s_add_u32 m0, s81, 102400
    s_nop 0
    buffer_load_dwordx4 v1, s[4:7], s80 offen sc1 lds
Ll0_75:
    v_mfma_f32_16x16x32_bf16 v[48:51], v[140:143], a[84:87], v[48:51]
    v_mfma_f32_16x16x32_bf16 v[52:55], v[144:147], a[84:87], v[52:55]
    v_mfma_f32_16x16x32_bf16 v[56:59], v[148:151], a[84:87], v[56:59]
    s_waitcnt vmcnt(5) lgkmcnt(5)
    v_mfma_f32_16x16x32_bf16 v[40:43], v[152:155], a[88:91], v[40:43]
    v_mfma_f32_16x16x32_bf16 v[44:47], v[156:159], a[88:91], v[44:47]
    v_mfma_f32_16x16x32_bf16 v[48:51], v[104:107], a[88:91], v[48:51]
    v_mfma_f32_16x16x32_bf16 v[52:55], v[108:111], a[88:91], v[52:55]
    v_mfma_f32_16x16x32_bf16 v[56:59], v[112:115], a[88:91], v[56:59]
    s_waitcnt vmcnt(4) lgkmcnt(0)
    v_mfma_f32_16x16x32_bf16 v[40:43], v[116:119], a[92:95], v[40:43]
    v_mfma_f32_16x16x32_bf16 v[44:47], v[120:123], a[92:95], v[44:47]
    v_mfma_f32_16x16x32_bf16 v[48:51], v[124:127], a[92:95], v[48:51]
    v_mfma_f32_16x16x32_bf16 v[52:55], v[128:131], a[92:95], v[52:55]
    v_mfma_f32_16x16x32_bf16 v[56:59], v[132:135], a[92:95], v[56:59]
    s_nop 3
    v_cvt_pk_bf16_f32 v4, v40, v41
    v_cvt_pk_bf16_f32 v5, v42, v43
    v_cvt_pk_bf16_f32 v6, v44, v45
    v_cvt_pk_bf16_f32 v7, v46, v47
    v_cvt_pk_bf16_f32 v8, v48, v49
    v_cvt_pk_bf16_f32 v9, v50, v51
    v_cvt_pk_bf16_f32 v10, v52, v53
    v_cvt_pk_bf16_f32 v11, v54, v55
    v_cvt_pk_bf16_f32 v12, v56, v57
    v_cvt_pk_bf16_f32 v13, v58, v59
    s_cmp_eq_u32 s48, 1
    s_cbranch_scc0 Lnotlast_76
    s_mul_i32 s60, s58, 20480
    s_mul_i32 s61, s56, 160
    s_add_u32 s60, s60, s61
    v_mul_u32_u24 v26, 1280, v23
    v_lshl_add_u32 v27, v22, 3, v26
    v_lshl_add_u32 v26, v22, 4, v26
    s_cmp_eq_u32 s47, 0
    s_cbranch_scc1 Lsfast_77
    buffer_store_dwordx4 v[4:7], v26, s[36:39], s60 offen sc1
    buffer_store_dwordx4 v[8:11], v26, s[36:39], s60 offen offset:64 sc1
    buffer_store_dwordx2 v[12:13], v27, s[36:39], s60 offen offset:128 sc1
    s_branch Lsdone_78
Lsfast_77:
    buffer_store_dwordx4 v[4:7], v26, s[36:39], s60 offen
    buffer_store_dwordx4 v[8:11], v26, s[36:39], s60 offen offset:64
    buffer_store_dwordx2 v[12:13], v27, s[36:39], s60 offen offset:128
Lsdone_78:
    s_branch LFIN
Lnotlast_76:
    s_cmp_eq_u32 s47, 0
    s_cbranch_scc1 Lsfast_79
    buffer_store_dwordx4 v[4:7], v27, s[36:39], s67 offen sc1
    buffer_store_dwordx4 v[8:11], v27, s[36:39], s67 offen offset:1024 sc1
    buffer_store_dwordx2 v[12:13], v28, s[36:39], s67 offen sc1
    s_branch Lsdone_80
Lsfast_79:
    buffer_store_dwordx4 v[4:7], v27, s[36:39], s67 offen
    buffer_store_dwordx4 v[8:11], v27, s[36:39], s67 offen offset:1024
    buffer_store_dwordx2 v[12:13], v28, s[36:39], s67 offen
Lsdone_80:
    v_pk_mul_f32 v[62:63], v[40:41], v[40:41] op_sel:[0,0] op_sel_hi:[1,1]
    v_pk_mul_f32 v[64:65], v[42:43], v[42:43] op_sel:[0,0] op_sel_hi:[1,1]
    v_pk_add_f32 v[60:61], v[40:41], v[42:43] op_sel:[0,0] op_sel_hi:[1,1]
    v_pk_add_f32 v[66:67], v[44:45], v[46:47] op_sel:[0,0] op_sel_hi:[1,1]
    v_pk_fma_f32 v[62:63], v[44:45], v[44:45], v[62:63] op_sel:[0,0,0] op_sel_hi:[1,1,1]
    v_pk_fma_f32 v[64:65], v[46:47], v[46:47], v[64:65] op_sel:[0,0,0] op_sel_hi:[1,1,1]
    v_pk_fma_f32 v[62:63], v[48:49], v[48:49], v[62:63] op_sel:[0,0,0] op_sel_hi:[1,1,1]
    v_pk_add_f32 v[60:61], v[60:61], v[48:49] op_sel:[0,0] op_sel_hi:[1,1]
    v_pk_fma_f32 v[64:65], v[50:51], v[50:51], v[64:65] op_sel:[0,0,0] op_sel_hi:[1,1,1]
    v_pk_add_f32 v[66:67], v[66:67], v[50:51] op_sel:[0,0] op_sel_hi:[1,1]
    v_pk_fma_f32 v[62:63], v[52:53], v[52:53], v[62:63] op_sel:[0,0,0] op_sel_hi:[1,1,1]
    v_pk_add_f32 v[60:61], v[60:61], v[52:53] op_sel:[0,0] op_sel_hi:[1,1]
    v_pk_fma_f32 v[64:65], v[54:55], v[54:55], v[64:65] op_sel:[0,0,0] op_sel_hi:[1,1,1]
    v_pk_add_f32 v[66:67], v[66:67], v[54:55] op_sel:[0,0] op_sel_hi:[1,1]
    v_pk_fma_f32 v[62:63], v[56:57], v[56:57], v[62:63] op_sel:[0,0,0] op_sel_hi:[1,1,1]
    v_pk_add_f32 v[60:61], v[60:61], v[56:57] op_sel:[0,0] op_sel_hi:[1,1]
    v_pk_fma_f32 v[64:65], v[58:59], v[58:59], v[64:65] op_sel:[0,0,0] op_sel_hi:[1,1,1]
    v_pk_add_f32 v[66:67], v[66:67], v[58:59] op_sel:[0,0] op_sel_hi:[1,1]
    v_pk_add_f32 v[60:61], v[60:61], v[66:67] op_sel:[0,0] op_sel_hi:[1,1]
    v_pk_add_f32 v[62:63], v[62:63], v[64:65] op_sel:[0,0] op_sel_hi:[1,1]
    v_add_f32 v60, v60, v61
    v_add_f32 v62, v62, v63
    s_nop 1
    v_permlane16_swap_b32 v60, v62
    v_add_f32 v60, v60, v62
    v_mov_b32 v62, v60
    s_nop 1
    v_permlane32_swap_b32 v60, v62
    v_add_f32 v60, v60, v62
    s_mov_b32 exec_hi, 0
    s_cmp_eq_u32 s47, 0
    s_cbranch_scc1 Lsfast_81
    buffer_store_dword v60, v26, s[4:7], s68 offen sc1
    s_branch Lsdone_82
Lsfast_81:
    buffer_store_dword v60, v26, s[4:7], s68 offen
Lsdone_82:
    s_mov_b64 exec, -1
    s_barrier
    s_add_u32 s80, s51, 32768
    s_add_u32 m0, s81, 106496
    s_nop 0
    buffer_load_dwordx4 v1, s[4:7], s80 offen sc1 lds
    s_add_u32 s80, s51, 36864
    s_add_u32 m0, s81, 110592
    s_nop 0
    buffer_load_dwordx4 v1, s[4:7], s80 offen sc1 lds
    s_add_u32 s80, s51, 40960
    s_add_u32 m0, s81, 114688
    s_nop 0
    buffer_load_dwordx4 v1, s[4:7], s80 offen sc1 lds
    s_add_u32 s80, s51, 45056
    s_add_u32 m0, s81, 118784
    s_nop 0
    buffer_load_dwordx4 v1, s[4:7], s80 offen sc1 lds
    s_add_u32 s80, s51, 49152
    s_add_u32 m0, s81, 122880
    s_nop 0
    buffer_load_dwordx4 v1, s[4:7], s80 offen sc1 lds
    s_add_u32 s80, s51, 53248
    s_add_u32 m0, s81, 126976
    s_nop 0
    buffer_load_dwordx4 v1, s[4:7], s80 offen sc1 lds
    s_waitcnt vmcnt(6)
    v_mov_b32 v24, s50
    v_mov_b32 v25, 0
    s_mov_b64 exec, 1
    s_cmp_eq_u32 s47, 0
    s_cbranch_scc1 Lsfast_83
    buffer_store_dword v24, v25, s[4:7], s69 offen sc1
    s_branch Lsdone_84
Lsfast_83:
    buffer_store_dword v24, v25, s[4:7], s69 offen
Lsdone_84:
    s_mov_b64 exec, -1
    v_add_u32 v28, s81, v1
    v_add_u32 v29, s81, v2
    v_add_u32 v30, s81, v3
    s_add_u32 s80, s51, 57344
    s_add_u32 m0, s81, 131072
    s_nop 0
    buffer_load_dwordx4 v1, s[4:7], s80 offen sc1 lds
    s_add_u32 s80, s51, 61440
    s_add_u32 m0, s81, 135168
    s_nop 0
    buffer_load_dwordx4 v1, s[4:7], s80 offen sc1 lds
    s_add_u32 s80, s51, 65536
    s_add_u32 m0, s81, 139264
    s_nop 0
    buffer_load_dwordx4 v1, s[4:7], s80 offen sc1 lds
    s_waitcnt lgkmcnt(0)
    s_mov_b32 s48, 1
    s_mov_b32 s49, 0
    s_add_u32 s50, s83, 1
    s_mov_b32 s52, 262144
    v_and_b32 v26, 7, v23
    v_lshl_add_u32 v26, v22, 3, v26
    v_lshlrev_b32 v26, 4, v26
    v_add_u32 v173, 32768, v26
    v_add_u32 v26, s81, v1
    s_add_u32 s68, s44, 1
    s_lshr_b32 s68, s68, 1
    s_lshl_b32 s60, s44, 2
    s_lshr_b32 s69, 0x3422, s60
    s_and_b32 s69, s69, 15
    s_lshr_b32 s70, 0x4433, s60
    s_and_b32 s70, s70, 15
    s_lshl_b32 s60, s68, 12
    v_add_u32 v27, s60, v1
    s_lshl_b32 s60, s69, 12
    v_add_u32 v28, s60, v1
    s_lshl_b32 s60, s70, 12
    v_add_u32 v29, s60, v1
    s_lshl_b32 s60, s68, 4
    v_lshl_add_u32 v39, v22, 2, s60
    v_cmp_le_u32 vcc, 20, v39
    v_cmp_gt_u32 s[72:73], 40, v39
    v_mov_b32 v36, 0x40000000
    v_cndmask_b32 v30, 0, 1, vcc
    v_mul_u32_u24 v31, 800, v30
    v_lshl_add_u32 v31, v39, 1, v31
    v_mul_u32_u24 v35, 20, v30
    s_lshl_b32 s60, s69, 4
    s_sub_u32 s60, s60, 40
    v_add_u32 v37, s60, v23
    v_sub_u32 v37, v37, v35
    v_cmp_gt_u32 vcc, 20, v37
    v_mul_u32_u24 v37, 40, v37
    s_and_b64 vcc, vcc, s[72:73]
    v_add_u32 v37, v37, v31
    v_cndmask_b32 v33, v36, v37, vcc
    s_lshl_b32 s60, s70, 4
    s_sub_u32 s60, s60, 40
    v_add_u32 v37, s60, v23
    v_sub_u32 v37, v37, v35
    v_cmp_gt_u32 vcc, 20, v37
    v_mul_u32_u24 v37, 40, v37
    s_and_b64 vcc, vcc, s[72:73]
    v_add_u32 v37, v37, v31
    v_cndmask_b32 v34, v36, v37, vcc
    v_cmp_eq_u32 vcc, 0, v23
    v_add_u32 v37, 800, v31
    s_and_b64 vcc, vcc, s[72:73]
    v_cndmask_b32 v35, v36, v37, vcc
    s_mul_i32 s71, s54, 28672
    s_add_u32 s71, s71, 491520
    s_lshl_b32 s60, s45, 1
    s_add_u32 s60, s60, s53
    s_mul_i32 s60, s60, 1792
    s_add_u32 s74, s60, s71
    v_cmp_gt_u32 s[66:67], 8, v23
    v_and_b32 v30, 31, v15
    s_mul_i32 s60, s44, 27
    v_add_u32 v39, s60, v30
    v_lshrrev_b32 v31, 5, v15
    v_mul_u32_u24 v37, 1792, v31
    v_lshl_add_u32 v37, v39, 4, v37
    v_cmp_gt_u32 vcc, 105, v39
    s_nop 1
    v_cndmask_b32 v37, v36, v37, vcc
    v_cmp_gt_u32 vcc, 27, v30
    s_nop 1
    v_cndmask_b32 v37, v36, v37, vcc
    v_lshlrev_b32 v39, 5, v39
    v_lshl_add_u32 v39, v31, 4, v39
    v_add_u32 v39, 157952, v39
    v_lshlrev_b32 v32, 2, v23
    v_add_u32 v32, 156928, v32
    v_lshlrev_b32 v38, 4, v22
    v_add_u32 v38, 157248, v38
    s_lshl_b32 s63, s45, 3
    s_lshl_b32 s60, s53, 2
    s_add_u32 s63, s63, s60
    s_add_u32 s63, s63, s44
    s_lshl_b32 s63, s63, 6
    s_add_u32 s63, s63, 12288
    v_lshlrev_b32 v30, 2, v15
    s_mul_i32 s64, s57, 20480
    s_add_u32 s64, s64, 0
    s_lshl_b32 s62, s57, 10
    s_add_u32 s62, s62, 7823360
    s_mov_b64 exec, 0xffff
    s_mov_b32 s82, 0
Lpoll_85:
    buffer_load_dword v24, v30, s[4:7], s63 offen sc1
    s_add_u32 s82, s82, 1
    s_waitcnt vmcnt(0)
    v_cmp_eq_u32 vcc, s83, v24
    s_cmp_eq_u64 vcc, exec
    s_cbranch_scc1 Lpdone_86
    s_cmp_lt_u32 s82, 200000
    s_cbranch_scc1 Lpoll_85
    s_branch LEND
Lpdone_86:
    s_mov_b64 exec, -1
    s_add_u32 s84, s64, 0
    buffer_load_dwordx4 a[0:3], v1, s[36:39], s84 offen offset:0 sc1
    s_add_u32 s85, s64, 20480
    buffer_load_dwordx4 a[4:7], v1, s[36:39], s85 offen offset:0 sc1
    buffer_load_dwordx4 v[192:195], v1, s[4:7], s62 offen sc1
    buffer_load_dwordx4 v[196:199], v1, s[4:7], s62 offen offset:1024 sc1
    buffer_load_dwordx4 a[8:11], v1, s[36:39], s84 offen offset:1024 sc1
    buffer_load_dwordx4 a[12:15], v1, s[36:39], s85 offen offset:1024 sc1
    buffer_load_dwordx4 a[16:19], v1, s[36:39], s84 offen offset:2048 sc1
    buffer_load_dwordx4 a[20:23], v1, s[36:39], s85 offen offset:2048 sc1
    buffer_load_dwordx4 a[24:27], v1, s[36:39], s84 offen offset:3072 sc1
    buffer_load_dwordx4 a[28:31], v1, s[36:39], s85 offen offset:3072 sc1
    s_barrier
    ds_read_b128 v[104:107], v2 offset:8192
    ds_read_b128 v[108:111], v2 offset:9216
    ds_read_b128 v[112:115], v2 offset:10240
    ds_read_b128 v[116:119], v2 offset:11264
    ds_read_b128 v[120:123], v2 offset:12288
    ds_read_b128 v[124:127], v2 offset:13312
    ds_read_b128 v[128:131], v2 offset:14336
    ds_read_b128 v[132:135], v2 offset:15360
    ds_read_b128 v[136:139], v2 offset:16384
    s_waitcnt vmcnt(8) lgkmcnt(8)
    v_mfma_f32_16x16x32_bf16 v[40:43], a[0:3], v[104:107], 0
    v_mfma_f32_16x16x32_bf16 v[44:47], a[4:7], v[104:107], 0
    ds_read_b128 v[140:143], v2 offset:17408
    s_waitcnt lgkmcnt(8)
    v_mfma_f32_16x16x32_bf16 v[48:51], a[0:3], v[108:111], 0
    s_add_u32 s86, s64, 4096
    buffer_load_dwordx4 a[32:35], v1, s[36:39], s86 offen offset:0 sc1
    s_add_u32 s87, s64, 24576
    v_mfma_f32_16x16x32_bf16 v[52:55], a[4:7], v[108:111], 0
    ds_read_b128 v[104:107], v2 offset:18432
    buffer_load_dwordx4 a[36:39], v1, s[36:39], s87 offen offset:0 sc1
    s_waitcnt lgkmcnt(8)
    v_mfma_f32_16x16x32_bf16 v[56:59], a[0:3], v[112:115], 0
    s_waitcnt vmcnt(8)
    v_add_f32_dpp v200, v192, v192 row_ror:8 row_mask:0xf bank_mask:0x3
    v_add_f32_dpp v201, v193, v193 row_ror:8 row_mask:0xf bank_mask:0x3
    v_add_f32_dpp v202, v194, v194 row_ror:8 row_mask:0xf bank_mask:0x3
    v_mfma_f32_16x16x32_bf16 v[60:63], a[4:7], v[112:115], 0
    ds_read_b128 v[108:111], v2 offset:19456
    v_add_f32_dpp v203, v195, v195 row_ror:8 row_mask:0xf bank_mask:0x3
    v_add_f32_dpp v200, v196, v196 row_ror:8 row_mask:0xf bank_mask:0xc
    s_waitcnt lgkmcnt(8)
    v_mfma_f32_16x16x32_bf16 v[64:67], a[0:3], v[116:119], 0
    s_add_u32 s80, s51, 69632
    s_add_u32 m0, s81, 143360
    s_nop 0
    buffer_load_dwordx4 v1, s[4:7], s80 offen sc1 lds
    v_mfma_f32_16x16x32_bf16 v[68:71], a[4:7], v[116:119], 0
    ds_read_b128 v[112:115], v2 offset:20480
    v_add_f32_dpp v201, v197, v197 row_ror:8 row_mask:0xf bank_mask:0xc
    v_add_f32_dpp v202, v198, v198 row_ror:8 row_mask:0xf bank_mask:0xc
    s_waitcnt lgkmcnt(8)
    v_mfma_f32_16x16x32_bf16 v[72:75], a[0:3], v[120:123], 0
    v_add_f32_dpp v203, v199, v199 row_ror:8 row_mask:0xf bank_mask:0xc
    v_mov_b32 v204, v200
    v_mov_b32 v205, v201
    v_mov_b32 v206, v202
    v_mfma_f32_16x16x32_bf16 v[76:79], a[4:7], v[120:123], 0
    ds_read_b128 v[116:119], v2 offset:21504
    v_mov_b32 v207, v203
    v_permlane16_swap_b32 v200, v204
    s_waitcnt vmcnt(7) lgkmcnt(8)
    v_mfma_f32_16x16x32_bf16 v[40:43], a[8:11], v[124:127], v[40:43]
    v_permlane16_swap_b32 v201, v205
    v_permlane16_swap_b32 v202, v206
    v_permlane16_swap_b32 v203, v207
    v_mfma_f32_16x16x32_bf16 v[44:47], a[12:15], v[124:127], v[44:47]
    ds_read_b128 v[120:123], v2 offset:22528
    v_add_f32 v200, v200, v204
    v_add_f32 v201, v201, v205
    s_waitcnt lgkmcnt(8)
    v_mfma_f32_16x16x32_bf16 v[48:51], a[8:11], v[128:131], v[48:51]
    buffer_load_dwordx4 a[40:43], v1, s[36:39], s86 offen offset:1024 sc1
    buffer_load_dwordx4 a[44:47], v1, s[36:39], s87 offen offset:1024 sc1
    v_mfma_f32_16x16x32_bf16 v[52:55], a[12:15], v[128:131], v[52:55]
    ds_read_b128 v[124:127], v2 offset:23552
    v_add_f32 v202, v202, v206
    v_add_f32 v203, v203, v207
    s_waitcnt lgkmcnt(8)
    v_mfma_f32_16x16x32_bf16 v[56:59], a[8:11], v[132:135], v[56:59]
    s_add_u32 s80, s51, 73728
    s_add_u32 m0, s81, 147456
    s_nop 0
    buffer_load_dwordx4 v1, s[4:7], s80 offen sc1 lds
    v_mfma_f32_16x16x32_bf16 v[60:63], a[12:15], v[132:135], v[60:63]
    ds_read_b128 v[128:131], v2 offset:24576
    v_mov_b32 v204, v200
    v_mov_b32 v205, v201
    s_waitcnt lgkmcnt(8)
    v_mfma_f32_16x16x32_bf16 v[64:67], a[8:11], v[136:139], v[64:67]
    v_mov_b32 v206, v202
    v_mov_b32 v207, v203
    v_permlane32_swap_b32 v200, v204
    v_permlane32_swap_b32 v201, v205
    v_mfma_f32_16x16x32_bf16 v[68:71], a[12:15], v[136:139], v[68:71]
    ds_read_b128 v[132:135], v2 offset:25600
    v_permlane32_swap_b32 v202, v206
    v_permlane32_swap_b32 v203, v207
    s_waitcnt lgkmcnt(8)
    v_mfma_f32_16x16x32_bf16 v[72:75], a[8:11], v[140:143], v[72:75]
    v_add_f32 v200, v200, v204
    v_add_f32 v201, v201, v205
    v_add_f32 v202, v202, v206
    v_add_f32 v203, v203, v207
    v_mfma_f32_16x16x32_bf16 v[76:79], a[12:15], v[140:143], v[76:79]
    ds_read_b128 v[136:139], v2 offset:26624
    v_mov_b32_dpp v204, v200 row_shl:4 row_mask:0xf bank_mask:0xf
    v_mov_b32_dpp v205, v201 row_shl:4 row_mask:0xf bank_mask:0xf
    s_waitcnt vmcnt(8) lgkmcnt(8)
    v_mfma_f32_16x16x32_bf16 v[40:43], a[16:19], v[104:107], v[40:43]
    v_mov_b32_dpp v206, v202 row_shl:4 row_mask:0xf bank_mask:0xf
    v_mov_b32_dpp v207, v203 row_shl:4 row_mask:0xf bank_mask:0xf
    s_mov_b32 s60, 0xbacccccd
    v_mfma_f32_16x16x32_bf16 v[44:47], a[20:23], v[104:107], v[44:47]
    ds_read_b128 v[140:143], v2 offset:27648
    s_mov_b32 s61, 0x3acccccd
    v_mul_f32 v200, s60, v200
    s_waitcnt lgkmcnt(8)
    v_mfma_f32_16x16x32_bf16 v[48:51], a[16:19], v[108:111], v[48:51]
    buffer_load_dwordx4 a[48:51], v1, s[36:39], s86 offen offset:2048 sc1
    buffer_load_dwordx4 a[52:55], v1, s[36:39], s87 offen offset:2048 sc1
    v_mfma_f32_16x16x32_bf16 v[52:55], a[20:23], v[108:111], v[52:55]
    ds_read_b128 v[104:107], v2 offset:28672
    s_add_u32 s80, s51, 77824
    s_add_u32 m0, s81, 151552
    s_waitcnt lgkmcnt(8)
    v_mfma_f32_16x16x32_bf16 v[56:59], a[16:19], v[112:115], v[56:59]
    buffer_load_dwordx4 v1, s[4:7], s80 offen sc1 lds
    v_mul_f32 v201, s60, v201
    v_mul_f32 v202, s60, v202
    v_mfma_f32_16x16x32_bf16 v[60:63], a[20:23], v[112:115], v[60:63]
    ds_read_b128 v[108:111], v2 offset:29696
    v_mul_f32 v203, s60, v203
    v_mul_f32 v208, v200, v200
    s_waitcnt lgkmcnt(8)
    v_mfma_f32_16x16x32_bf16 v[64:67], a[16:19], v[116:119], v[64:67]
    v_mul_f32 v209, v201, v201
    v_mul_f32 v210, v202, v202
    v_mul_f32 v211, v203, v203
    v_fma_f32 v204, v204, s61, -v208
    v_mfma_f32_16x16x32_bf16 v[68:71], a[20:23], v[116:119], v[68:71]
    ds_read_b128 v[112:115], v2 offset:30720
    v_fma_f32 v205, v205, s61, -v209
    v_fma_f32 v206, v206, s61, -v210
    s_waitcnt lgkmcnt(8)
    v_mfma_f32_16x16x32_bf16 v[72:75], a[16:19], v[120:123], v[72:75]
    v_fma_f32 v207, v207, s61, -v211
    v_max_f32 v204, 0, v204
    v_max_f32 v205, 0, v205
    v_max_f32 v206, 0, v206
    v_mfma_f32_16x16x32_bf16 v[76:79], a[20:23], v[120:123], v[76:79]
    ds_read_b128 v[116:119], v2 offset:31744
    v_max_f32 v207, 0, v207
    v_add_f32 v204, 0x3727c5ac, v204
    s_waitcnt vmcnt(9) lgkmcnt(8)
    v_mfma_f32_16x16x32_bf16 v[40:43], a[24:27], v[124:127], v[40:43]
    s_add_u32 s80, s51, 81920
    s_add_u32 m0, s81, 0
    s_nop 0
    buffer_load_dwordx4 v1, s[4:7], s80 offen sc1 lds
    v_mfma_f32_16x16x32_bf16 v[44:47], a[28:31], v[124:127], v[44:47]
    ds_read_b128 v[120:123], v2 offset:32768
    v_add_f32 v205, 0x3727c5ac, v205
    s_waitcnt lgkmcnt(8)
    v_mfma_f32_16x16x32_bf16 v[48:51], a[24:27], v[128:131], v[48:51]
    buffer_load_dwordx4 a[56:59], v1, s[36:39], s86 offen offset:3072 sc1
    buffer_load_dwordx4 a[60:63], v1, s[36:39], s87 offen offset:3072 sc1
    v_mfma_f32_16x16x32_bf16 v[52:55], a[28:31], v[128:131], v[52:55]
    ds_read_b128 v[124:127], v2 offset:33792
    v_add_f32 v206, 0x3727c5ac, v206
    v_add_f32 v207, 0x3727c5ac, v207
    s_waitcnt lgkmcnt(8)
    v_mfma_f32_16x16x32_bf16 v[56:59], a[24:27], v[132:135], v[56:59]
    v_rsq_f32 v204, v204
    v_rsq_f32 v205, v205
    v_rsq_f32 v206, v206
    v_rsq_f32 v207, v207
    v_mfma_f32_16x16x32_bf16 v[60:63], a[28:31], v[132:135], v[60:63]
    ds_read_b128 v[128:131], v2 offset:34816
    v_lshrrev_b32 v208, 3, v23
    v_and_b32 v209, 3, v23
    s_waitcnt lgkmcnt(8)
    v_mfma_f32_16x16x32_bf16 v[64:67], a[24:27], v[136:139], v[64:67]
    v_lshlrev_b32 v209, 4, v209
    v_lshl_add_u32 v208, v208, 6, v209
    s_lshl_b32 s65, s44, 8
    s_add_u32 s65, s65, 155904
    v_mfma_f32_16x16x32_bf16 v[68:71], a[28:31], v[136:139], v[68:71]
    ds_read_b128 v[132:135], v2 offset:35840
    v_add_u32 v208, s65, v208
    s_mov_b64 exec, 0x0f0f
    ds_write_b128 v208, v[200:203]
    ds_write_b128 v208, v[204:207] offset:128
    s_mov_b64 exec, -1
    s_waitcnt lgkmcnt(10)
    v_mfma_f32_16x16x32_bf16 v[72:75], a[24:27], v[140:143], v[72:75]
    v_mfma_f32_16x16x32_bf16 v[76:79], a[28:31], v[140:143], v[76:79]
    ds_read_b128 v[136:139], v2 offset:36864
    s_add_u32 s80, s51, 86016
    s_add_u32 m0, s81, 4096
    s_waitcnt vmcnt(10) lgkmcnt(10)
    v_mfma_f32_16x16x32_bf16 v[40:43], a[32:35], v[104:107], v[40:43]
    buffer_load_dwordx4 v1, s[4:7], s80 offen sc1 lds
    v_lshl_add_u32 v30, v22, 4, s65
    v_mfma_f32_16x16x32_bf16 v[44:47], a[36:39], v[104:107], v[44:47]
    ds_read_b128 v[140:143], v2 offset:37888
    v_lshl_add_u32 v31, v23, 2, s65
    ds_read_b128 v[144:147], v30 offset:0
    s_waitcnt lgkmcnt(11)
    v_mfma_f32_16x16x32_bf16 v[48:51], a[32:35], v[108:111], v[48:51]
    s_add_u32 s84, s64, 8192
    buffer_load_dwordx4 a[64:67], v1, s[36:39], s84 offen offset:0 sc1
    s_add_u32 s85, s64, 28672
    v_mfma_f32_16x16x32_bf16 v[52:55], a[36:39], v[108:111], v[52:55]
    ds_read_b128 v[104:107], v2 offset:38912
    buffer_load_dwordx4 a[68:71], v1, s[36:39], s85 offen offset:0 sc1
    s_waitcnt lgkmcnt(11)
    v_mfma_f32_16x16x32_bf16 v[56:59], a[32:35], v[112:115], v[56:59]
    ds_read_b128 v[152:155], v30 offset:128
    ds_read_b32 v174, v31 offset:0
    ds_read_b32 v176, v31 offset:128
    ds_read_b128 v[148:151], v30 offset:64
    v_mfma_f32_16x16x32_bf16 v[60:63], a[36:39], v[112:115], v[60:63]
    s_waitcnt lgkmcnt(14)
    ds_read_b128 v[108:111], v2 offset:39936
    s_waitcnt lgkmcnt(14)
    ds_read_b128 v[156:159], v30 offset:192
    v_mfma_f32_16x16x32_bf16 v[64:67], a[32:35], v[116:119], v[64:67]
    s_add_u32 s80, s51, 90112
    s_add_u32 m0, s81, 8192
    s_nop 0
    buffer_load_dwordx4 v1, s[4:7], s80 offen sc1 lds
    v_mfma_f32_16x16x32_bf16 v[68:71], a[36:39], v[116:119], v[68:71]
    s_waitcnt lgkmcnt(14)
    ds_read_b128 v[112:115], v2 offset:40960
    v_mfma_f32_16x16x32_bf16 v[72:75], a[32:35], v[120:123], v[72:75]
    s_waitcnt lgkmcnt(14)
    ds_read_b32 v175, v31 offset:64
    s_waitcnt lgkmcnt(14)
    ds_read_b32 v177, v31 offset:192
    v_mfma_f32_16x16x32_bf16 v[76:79], a[36:39], v[120:123], v[76:79]
    s_waitcnt lgkmcnt(14)
    ds_read_b128 v[116:119], v2 offset:41984
    s_waitcnt lgkmcnt(14)
    ds_read_b32 v168, v32 offset:0
    s_waitcnt vmcnt(11)
    v_mfma_f32_16x16x32_bf16 v[40:43], a[40:43], v[124:127], v[40:43]
    s_waitcnt lgkmcnt(14)
    ds_read_b32 v169, v32 offset:64
    v_mfma_f32_16x16x32_bf16 v[44:47], a[44:47], v[124:127], v[44:47]
    s_waitcnt lgkmcnt(14)
    ds_read_b128 v[120:123], v2 offset:43008
    s_waitcnt lgkmcnt(14)
    ds_read_b32 v170, v32 offset:128
    v_mfma_f32_16x16x32_bf16 v[48:51], a[40:43], v[128:131], v[48:51]
    buffer_load_dwordx4 a[72:75], v1, s[36:39], s84 offen offset:1024 sc1
    buffer_load_dwordx4 a[76:79], v1, s[36:39], s85 offen offset:1024 sc1
    v_mfma_f32_16x16x32_bf16 v[52:55], a[44:47], v[128:131], v[52:55]
    s_waitcnt lgkmcnt(14)
    ds_read_b128 v[124:127], v2 offset:44032
    v_mfma_f32_16x16x32_bf16 v[56:59], a[40:43], v[132:135], v[56:59]
    s_add_u32 s80, s51, 94208
    s_add_u32 m0, s81, 12288
    s_nop 0
    buffer_load_dwordx4 v1, s[4:7], s80 offen sc1 lds
    v_mfma_f32_16x16x32_bf16 v[60:63], a[44:47], v[132:135], v[60:63]
    s_waitcnt lgkmcnt(14)
    ds_read_b128 v[128:131], v2 offset:45056
    s_waitcnt lgkmcnt(14)
    ds_read_b32 v171, v32 offset:192
    v_mfma_f32_16x16x32_bf16 v[64:67], a[40:43], v[136:139], v[64:67]
    s_waitcnt lgkmcnt(14)
    ds_read_b32 v172, v32 offset:256
    s_waitcnt lgkmcnt(14)
    ds_read_b128 v[180:183], v38 offset:0
    v_mfma_f32_16x16x32_bf16 v[68:71], a[44:47], v[136:139], v[68:71]
    s_waitcnt lgkmcnt(14)
    ds_read_b128 v[132:135], v2 offset:46080
    v_mfma_f32_16x16x32_bf16 v[72:75], a[40:43], v[140:143], v[72:75]
    s_waitcnt lgkmcnt(14)
    ds_read_b128 v[184:187], v38 offset:64
    s_waitcnt lgkmcnt(14)
    ds_read_b128 v[188:191], v38 offset:128
    v_mfma_f32_16x16x32_bf16 v[76:79], a[44:47], v[140:143], v[76:79]
    s_waitcnt lgkmcnt(14)
    ds_read_b128 v[136:139], v2 offset:47104
    s_mov_b32 s60, 0x3fb8aa3b
    s_waitcnt vmcnt(11)
    v_mfma_f32_16x16x32_bf16 v[40:43], a[48:51], v[104:107], v[40:43]
    s_waitcnt lgkmcnt(1)
    v_mul_f32 v160, s60, v152
    v_mul_f32 v161, s60, v153
    v_mul_f32 v162, s60, v154
    v_mfma_f32_16x16x32_bf16 v[44:47], a[52:55], v[104:107], v[44:47]
    ds_read_b128 v[140:143], v2 offset:48128
    v_mul_f32 v163, s60, v155
    v_mul_f32 v164, s60, v156
    v_mfma_f32_16x16x32_bf16 v[48:51], a[48:51], v[108:111], v[48:51]
    buffer_load_dwordx4 a[80:83], v1, s[36:39], s84 offen offset:2048 sc1
    buffer_load_dwordx4 a[84:87], v1, s[36:39], s85 offen offset:2048 sc1
    v_mfma_f32_16x16x32_bf16 v[52:55], a[52:55], v[108:111], v[52:55]
    ds_read_b128 v[104:107], v2 offset:49152
    s_add_u32 s80, s51, 98304
    s_add_u32 m0, s81, 16384
    v_mfma_f32_16x16x32_bf16 v[56:59], a[48:51], v[112:115], v[56:59]
    buffer_load_dwordx4 v1, s[4:7], s80 offen sc1 lds
    v_mul_f32 v165, s60, v157
    v_mul_f32 v166, s60, v158
    v_mfma_f32_16x16x32_bf16 v[60:63], a[52:55], v[112:115], v[60:63]
    ds_read_b128 v[108:111], v2 offset:50176
    v_mul_f32 v167, s60, v159
    v_mul_f32 v178, s60, v176
    v_mfma_f32_16x16x32_bf16 v[64:67], a[48:51], v[116:119], v[64:67]
    v_mul_f32 v179, s60, v177
    v_mfma_f32_16x16x32_bf16 v[68:71], a[52:55], v[116:119], v[68:71]
    ds_read_b128 v[112:115], v2 offset:51200
    v_mfma_f32_16x16x32_bf16 v[72:75], a[48:51], v[120:123], v[72:75]
    v_mfma_f32_16x16x32_bf16 v[76:79], a[52:55], v[120:123], v[76:79]
    ds_read_b128 v[116:119], v2 offset:52224
    s_waitcnt vmcnt(10)
    v_mfma_f32_16x16x32_bf16 v[40:43], a[56:59], v[124:127], v[40:43]
    v_mfma_f32_16x16x32_bf16 v[44:47], a[60:63], v[124:127], v[44:47]
    ds_read_b128 v[120:123], v2 offset:53248
    v_mfma_f32_16x16x32_bf16 v[48:51], a[56:59], v[128:131], v[48:51]
    buffer_load_dwordx4 a[88:91], v1, s[36:39], s84 offen offset:3072 sc1
    buffer_load_dwordx4 a[92:95], v1, s[36:39], s85 offen offset:3072 sc1
    v_mfma_f32_16x16x32_bf16 v[52:55], a[60:63], v[128:131], v[52:55]
    ds_read_b128 v[124:127], v2 offset:54272
    v_mfma_f32_16x16x32_bf16 v[56:59], a[56:59], v[132:135], v[56:59]
    v_mfma_f32_16x16x32_bf16 v[60:63], a[60:63], v[132:135], v[60:63]
    ds_read_b128 v[128:131], v2 offset:55296
    s_waitcnt lgkmcnt(8)
    v_mfma_f32_16x16x32_bf16 v[64:67], a[56:59], v[136:139], v[64:67]
    v_mfma_f32_16x16x32_bf16 v[68:71], a[60:63], v[136:139], v[68:71]
    ds_read_b128 v[132:135], v2 offset:56320
    s_waitcnt lgkmcnt(8)
    v_mfma_f32_16x16x32_bf16 v[72:75], a[56:59], v[140:143], v[72:75]
    v_mfma_f32_16x16x32_bf16 v[76:79], a[60:63], v[140:143], v[76:79]
    ds_read_b128 v[136:139], v2 offset:57344
    s_waitcnt vmcnt(9) lgkmcnt(8)
    v_mfma_f32_16x16x32_bf16 v[40:43], a[64:67], v[104:107], v[40:43]
    v_mfma_f32_16x16x32_bf16 v[44:47], a[68:71], v[104:107], v[44:47]
    ds_read_b128 v[140:143], v2 offset:58368
    s_waitcnt lgkmcnt(8)
    v_mfma_f32_16x16x32_bf16 v[48:51], a[64:67], v[108:111], v[48:51]
    s_add_u32 s86, s64, 12288
    buffer_load_dwordx4 a[96:99], v1, s[36:39], s86 offen offset:0 sc1
    s_add_u32 s87, s64, 32768
    v_mfma_f32_16x16x32_bf16 v[52:55], a[68:71], v[108:111], v[52:55]
    ds_read_b128 v[104:107], v2 offset:59392
    buffer_load_dwordx4 a[100:103], v1, s[36:39], s87 offen offset:0 sc1
    s_waitcnt lgkmcnt(8)
    v_mfma_f32_16x16x32_bf16 v[56:59], a[64:67], v[112:115], v[56:59]
    v_mfma_f32_16x16x32_bf16 v[60:63], a[68:71], v[112:115], v[60:63]
    ds_read_b128 v[108:111], v2 offset:60416
    s_waitcnt lgkmcnt(8)
    v_mfma_f32_16x16x32_bf16 v[64:67], a[64:67], v[116:119], v[64:67]
    v_mfma_f32_16x16x32_bf16 v[68:71], a[68:71], v[116:119], v[68:71]
    ds_read_b128 v[112:115], v2 offset:61440
    s_waitcnt lgkmcnt(8)
    v_mfma_f32_16x16x32_bf16 v[72:75], a[64:67], v[120:123], v[72:75]
    v_mfma_f32_16x16x32_bf16 v[76:79], a[68:71], v[120:123], v[76:79]
    ds_read_b128 v[116:119], v2 offset:62464
    s_waitcnt vmcnt(8) lgkmcnt(8)
    v_mfma_f32_16x16x32_bf16 v[40:43], a[72:75], v[124:127], v[40:43]
    v_mfma_f32_16x16x32_bf16 v[44:47], a[76:79], v[124:127], v[44:47]
    ds_read_b128 v[120:123], v2 offset:63488
    s_waitcnt lgkmcnt(8)
    v_mfma_f32_16x16x32_bf16 v[48:51], a[72:75], v[128:131], v[48:51]
    buffer_load_dwordx4 a[104:107], v1, s[36:39], s86 offen offset:1024 sc1
    buffer_load_dwordx4 a[108:111], v1, s[36:39], s87 offen offset:1024 sc1
    v_mfma_f32_16x16x32_bf16 v[52:55], a[76:79], v[128:131], v[52:55]
    ds_read_b128 v[124:127], v2 offset:64512
    s_waitcnt lgkmcnt(8)
    v_mfma_f32_16x16x32_bf16 v[56:59], a[72:75], v[132:135], v[56:59]
    v_mfma_f32_16x16x32_bf16 v[60:63], a[76:79], v[132:135], v[60:63]
    ds_read_b128 v[128:131], v3 offset:0
    s_waitcnt lgkmcnt(8)
    v_mfma_f32_16x16x32_bf16 v[64:67], a[72:75], v[136:139], v[64:67]
    v_mfma_f32_16x16x32_bf16 v[68:71], a[76:79], v[136:139], v[68:71]
    ds_read_b128 v[132:135], v3 offset:1024
    s_waitcnt lgkmcnt(8)
    v_mfma_f32_16x16x32_bf16 v[72:75], a[72:75], v[140:143], v[72:75]
    v_mfma_f32_16x16x32_bf16 v[76:79], a[76:79], v[140:143], v[76:79]
    ds_read_b128 v[136:139], v3 offset:2048
    s_waitcnt vmcnt(7) lgkmcnt(8)
    v_mfma_f32_16x16x32_bf16 v[40:43], a[80:83], v[104:107], v[40:43]
    v_mfma_f32_16x16x32_bf16 v[44:47], a[84:87], v[104:107], v[44:47]
    ds_read_b128 v[140:143], v3 offset:3072
    s_waitcnt lgkmcnt(8)
    v_mfma_f32_16x16x32_bf16 v[48:51], a[80:83], v[108:111], v[48:51]
    buffer_load_dwordx4 a[112:115], v1, s[36:39], s86 offen offset:2048 sc1
    buffer_load_dwordx4 a[116:119], v1, s[36:39], s87 offen offset:2048 sc1
    v_mfma_f32_16x16x32_bf16 v[52:55], a[84:87], v[108:111], v[52:55]
    ds_read_b128 v[104:107], v3 offset:4096
    s_waitcnt lgkmcnt(8)
    v_mfma_f32_16x16x32_bf16 v[56:59], a[80:83], v[112:115], v[56:59]
    v_mfma_f32_16x16x32_bf16 v[60:63], a[84:87], v[112:115], v[60:63]
    ds_read_b128 v[108:111], v3 offset:5120
    s_waitcnt lgkmcnt(8)
    v_mfma_f32_16x16x32_bf16 v[64:67], a[80:83], v[116:119], v[64:67]
    v_mfma_f32_16x16x32_bf16 v[68:71], a[84:87], v[116:119], v[68:71]
    ds_read_b128 v[112:115], v3 offset:6144
    s_waitcnt lgkmcnt(8)
    v_mfma_f32_16x16x32_bf16 v[72:75], a[80:83], v[120:123], v[72:75]
    v_mfma_f32_16x16x32_bf16 v[76:79], a[84:87], v[120:123], v[76:79]
    ds_read_b128 v[116:119], v3 offset:7168
    s_waitcnt vmcnt(6) lgkmcnt(8)
    v_mfma_f32_16x16x32_bf16 v[40:43], a[88:91], v[124:127], v[40:43]
    v_mfma_f32_16x16x32_bf16 v[44:47], a[92:95], v[124:127], v[44:47]
    ds_read_b128 v[120:123], v3 offset:8192
    s_waitcnt lgkmcnt(8)
    v_mfma_f32_16x16x32_bf16 v[48:51], a[88:91], v[128:131], v[48:51]
    buffer_load_dwordx4 a[120:123], v1, s[36:39], s86 offen offset:3072 sc1
    buffer_load_dwordx4 a[124:127], v1, s[36:39], s87 offen offset:3072 sc1
    v_mfma_f32_16x16x32_bf16 v[52:55], a[92:95], v[128:131], v[52:55]
    ds_read_b128 v[124:127], v3 offset:9216
    s_waitcnt lgkmcnt(8)
    v_mfma_f32_16x16x32_bf16 v[56:59], a[88:91], v[132:135], v[56:59]
    v_mfma_f32_16x16x32_bf16 v[60:63], a[92:95], v[132:135], v[60:63]
    ds_read_b128 v[128:131], v3 offset:10240
    s_waitcnt lgkmcnt(8)
    v_mfma_f32_16x16x32_bf16 v[64:67], a[88:91], v[136:139], v[64:67]
    v_mfma_f32_16x16x32_bf16 v[68:71], a[92:95], v[136:139], v[68:71]
    ds_read_b128 v[132:135], v3 offset:11264
    s_waitcnt lgkmcnt(8)
    v_mfma_f32_16x16x32_bf16 v[72:75], a[88:91], v[140:143], v[72:75]
    s_barrier
    v_mfma_f32_16x16x32_bf16 v[76:79], a[92:95], v[140:143], v[76:79]
    ds_read_b128 v[136:139], v3 offset:12288
    s_waitcnt vmcnt(6) lgkmcnt(8)
    v_mfma_f32_16x16x32_bf16 v[40:43], a[96:99], v[104:107], v[40:43]
    v_mfma_f32_16x16x32_bf16 v[44:47], a[100:103], v[104:107], v[44:47]
    ds_read_b128 v[140:143], v3 offset:13312
    s_waitcnt lgkmcnt(8)
    v_mfma_f32_16x16x32_bf16 v[48:51], a[96:99], v[108:111], v[48:51]
    s_add_u32 s84, s64, 16384
    buffer_load_dwordx4 a[128:131], v1, s[36:39], s84 offen offset:0 sc1
    s_add_u32 s85, s64, 36864
    v_mfma_f32_16x16x32_bf16 v[52:55], a[100:103], v[108:111], v[52:55]
    ds_read_b128 v[104:107], v3 offset:14336
    buffer_load_dwordx4 a[132:135], v1, s[36:39], s85 offen offset:0 sc1
    s_waitcnt lgkmcnt(8)
    v_mfma_f32_16x16x32_bf16 v[56:59], a[96:99], v[112:115], v[56:59]
    v_mfma_f32_16x16x32_bf16 v[60:63], a[100:103], v[112:115], v[60:63]
    ds_read_b128 v[108:111], v3 offset:15360
    s_waitcnt lgkmcnt(8)
    v_mfma_f32_16x16x32_bf16 v[64:67], a[96:99], v[116:119], v[64:67]
    v_mfma_f32_16x16x32_bf16 v[68:71], a[100:103], v[116:119], v[68:71]
    ds_read_b128 v[112:115], v3 offset:16384
    s_waitcnt lgkmcnt(8)
    v_mfma_f32_16x16x32_bf16 v[72:75], a[96:99], v[120:123], v[72:75]
    v_mfma_f32_16x16x32_bf16 v[76:79], a[100:103], v[120:123], v[76:79]
    ds_read_b128 v[116:119], v3 offset:17408
    s_waitcnt vmcnt(6) lgkmcnt(8)
    v_mfma_f32_16x16x32_bf16 v[40:43], a[104:107], v[124:127], v[40:43]
    v_mfma_f32_16x16x32_bf16 v[44:47], a[108:111], v[124:127], v[44:47]
    ds_read_b128 v[120:123], v3 offset:18432
    s_waitcnt lgkmcnt(8)
    v_mfma_f32_16x16x32_bf16 v[48:51], a[104:107], v[128:131], v[48:51]
    buffer_load_dwordx4 a[136:139], v1, s[36:39], s84 offen offset:1024 sc1
    buffer_load_dwordx4 a[140:143], v1, s[36:39], s85 offen offset:1024 sc1
    v_mfma_f32_16x16x32_bf16 v[52:55], a[108:111], v[128:131], v[52:55]
    ds_read_b128 v[124:127], v3 offset:19456
    s_waitcnt lgkmcnt(8)
    v_mfma_f32_16x16x32_bf16 v[56:59], a[104:107], v[132:135], v[56:59]
    v_mfma_f32_16x16x32_bf16 v[60:63], a[108:111], v[132:135], v[60:63]
    ds_read_b128 v[128:131], v3 offset:20480
    s_waitcnt lgkmcnt(8)
    v_mfma_f32_16x16x32_bf16 v[64:67], a[104:107], v[136:139], v[64:67]
    v_mfma_f32_16x16x32_bf16 v[68:71], a[108:111], v[136:139], v[68:71]
    ds_read_b128 v[132:135], v3 offset:21504
    s_waitcnt lgkmcnt(8)
    v_mfma_f32_16x16x32_bf16 v[72:75], a[104:107], v[140:143], v[72:75]
    v_mfma_f32_16x16x32_bf16 v[76:79], a[108:111], v[140:143], v[76:79]
    ds_read_b128 v[136:139], v3 offset:22528
    s_waitcnt vmcnt(6) lgkmcnt(8)
    v_mfma_f32_16x16x32_bf16 v[40:43], a[112:115], v[104:107], v[40:43]
    v_mfma_f32_16x16x32_bf16 v[44:47], a[116:119], v[104:107], v[44:47]
    ds_read_b128 v[140:143], v3 offset:23552
    s_waitcnt lgkmcnt(8)
    v_mfma_f32_16x16x32_bf16 v[48:51], a[112:115], v[108:111], v[48:51]
    buffer_load_dwordx4 a[144:147], v1, s[36:39], s84 offen offset:2048 sc1
    buffer_load_dwordx4 a[148:151], v1, s[36:39], s85 offen offset:2048 sc1
    v_mfma_f32_16x16x32_bf16 v[52:55], a[116:119], v[108:111], v[52:55]
    ds_read_b128 v[104:107], v1 offset:0
    s_waitcnt lgkmcnt(8)
    v_mfma_f32_16x16x32_bf16 v[56:59], a[112:115], v[112:115], v[56:59]
    v_mfma_f32_16x16x32_bf16 v[60:63], a[116:119], v[112:115], v[60:63]
    ds_read_b128 v[108:111], v1 offset:1024
    s_waitcnt lgkmcnt(8)
    v_mfma_f32_16x16x32_bf16 v[64:67], a[112:115], v[116:119], v[64:67]
    v_mfma_f32_16x16x32_bf16 v[68:71], a[116:119], v[116:119], v[68:71]
    ds_read_b128 v[112:115], v1 offset:2048
    s_waitcnt lgkmcnt(8)
    v_mfma_f32_16x16x32_bf16 v[72:75], a[112:115], v[120:123], v[72:75]
    v_mfma_f32_16x16x32_bf16 v[76:79], a[116:119], v[120:123], v[76:79]
    ds_read_b128 v[116:119], v1 offset:3072
    s_waitcnt vmcnt(6) lgkmcnt(8)
    v_mfma_f32_16x16x32_bf16 v[40:43], a[120:123], v[124:127], v[40:43]
    v_mfma_f32_16x16x32_bf16 v[44:47], a[124:127], v[124:127], v[44:47]
    ds_read_b128 v[120:123], v1 offset:4096
    s_waitcnt lgkmcnt(8)
    v_mfma_f32_16x16x32_bf16 v[48:51], a[120:123], v[128:131], v[48:51]
    buffer_load_dwordx4 a[152:155], v1, s[36:39], s84 offen offset:3072 sc1
    buffer_load_dwordx4 a[156:159], v1, s[36:39], s85 offen offset:3072 sc1
    v_mfma_f32_16x16x32_bf16 v[52:55], a[124:127], v[128:131], v[52:55]
    ds_read_b128 v[124:127], v1 offset:5120
    s_waitcnt lgkmcnt(8)
    v_mfma_f32_16x16x32_bf16 v[56:59], a[120:123], v[132:135], v[56:59]
    v_mfma_f32_16x16x32_bf16 v[60:63], a[124:127], v[132:135], v[60:63]
    ds_read_b128 v[128:131], v1 offset:6144
    s_waitcnt lgkmcnt(8)
    v_mfma_f32_16x16x32_bf16 v[64:67], a[120:123], v[136:139], v[64:67]
    s_add_u32 s80, s51, 102400
    s_add_u32 m0, s81, 20480
    s_nop 0
    buffer_load_dwordx4 v1, s[4:7], s80 offen sc1 lds
    v_mfma_f32_16x16x32_bf16 v[68:71], a[124:127], v[136:139], v[68:71]
    ds_read_b128 v[132:135], v1 offset:7168
    s_waitcnt lgkmcnt(8)
    v_mfma_f32_16x16x32_bf16 v[72:75], a[120:123], v[140:143], v[72:75]
    s_add_u32 s80, s51, 106496
    s_add_u32 m0, s81, 24576
    s_nop 0
    buffer_load_dwordx4 v1, s[4:7], s80 offen sc1 lds
    v_mfma_f32_16x16x32_bf16 v[76:79], a[124:127], v[140:143], v[76:79]
    ds_read_b128 v[136:139], v1 offset:8192
    s_waitcnt vmcnt(8) lgkmcnt(8)
    v_mfma_f32_16x16x32_bf16 v[40:43], a[128:131], v[104:107], v[40:43]
    v_mfma_f32_16x16x32_bf16 v[44:47], a[132:135], v[104:107], v[44:47]
    ds_read_b128 v[140:143], v1 offset:9216
    s_waitcnt lgkmcnt(8)
    v_mfma_f32_16x16x32_bf16 v[48:51], a[128:131], v[108:111], v[48:51]
    s_add_u32 s80, s51, 110592
    s_add_u32 m0, s81, 28672
    s_nop 0
    buffer_load_dwordx4 v1, s[4:7], s80 offen sc1 lds
    v_mfma_f32_16x16x32_bf16 v[52:55], a[132:135], v[108:111], v[52:55]
    ds_read_b128 v[104:107], v1 offset:10240
    s_waitcnt lgkmcnt(8)
    v_mfma_f32_16x16x32_bf16 v[56:59], a[128:131], v[112:115], v[56:59]
    v_mfma_f32_16x16x32_bf16 v[60:63], a[132:135], v[112:115], v[60:63]
    ds_read_b128 v[108:111], v1 offset:11264
    s_waitcnt lgkmcnt(8)
    v_mfma_f32_16x16x32_bf16 v[64:67], a[128:131], v[116:119], v[64:67]
    s_add_u32 s80, s51, 114688
    s_add_u32 m0, s81, 32768
    s_nop 0
    buffer_load_dwordx4 v1, s[4:7], s80 offen sc1 lds
    v_mfma_f32_16x16x32_bf16 v[68:71], a[132:135], v[116:119], v[68:71]
    ds_read_b128 v[112:115], v1 offset:12288
    s_waitcnt lgkmcnt(8)
    v_mfma_f32_16x16x32_bf16 v[72:75], a[128:131], v[120:123], v[72:75]
    v_mfma_f32_16x16x32_bf16 v[76:79], a[132:135], v[120:123], v[76:79]
    ds_read_b128 v[116:119], v1 offset:13312
    s_waitcnt vmcnt(8) lgkmcnt(8)
    v_mfma_f32_16x16x32_bf16 v[40:43], a[136:139], v[124:127], v[40:43]
    s_add_u32 s80, s51, 118784
    s_add_u32 m0, s81, 36864
    s_nop 0
    buffer_load_dwordx4 v1, s[4:7], s80 offen sc1 lds
    v_mfma_f32_16x16x32_bf16 v[44:47], a[140:143], v[124:127], v[44:47]
    ds_read_b128 v[120:123], v1 offset:14336
    s_waitcnt lgkmcnt(8)
    v_mfma_f32_16x16x32_bf16 v[48:51], a[136:139], v[128:131], v[48:51]
    s_add_u32 s80, s51, 122880
    s_add_u32 m0, s81, 40960
    s_nop 0
    buffer_load_dwordx4 v1, s[4:7], s80 offen sc1 lds
    v_mfma_f32_16x16x32_bf16 v[52:55], a[140:143], v[128:131], v[52:55]
    ds_read_b128 v[124:127], v1 offset:15360
    s_waitcnt lgkmcnt(8)
    v_mfma_f32_16x16x32_bf16 v[56:59], a[136:139], v[132:135], v[56:59]
    v_mfma_f32_16x16x32_bf16 v[60:63], a[140:143], v[132:135], v[60:63]
    ds_read_b128 v[128:131], v1 offset:16384
    s_waitcnt lgkmcnt(8)
    v_mfma_f32_16x16x32_bf16 v[64:67], a[136:139], v[136:139], v[64:67]
    s_add_u32 s80, s51, 126976
    s_add_u32 m0, s81, 45056
    s_nop 0
    buffer_load_dwordx4 v1, s[4:7], s80 offen sc1 lds
    v_mfma_f32_16x16x32_bf16 v[68:71], a[140:143], v[136:139], v[68:71]
    ds_read_b128 v[132:135], v1 offset:17408
    s_waitcnt lgkmcnt(8)
    v_mfma_f32_16x16x32_bf16 v[72:75], a[136:139], v[140:143], v[72:75]
    v_mfma_f32_16x16x32_bf16 v[76:79], a[140:143], v[140:143], v[76:79]
    ds_read_b128 v[136:139], v1 offset:18432
    s_waitcnt vmcnt(9) lgkmcnt(8)
    v_mfma_f32_16x16x32_bf16 v[40:43], a[144:147], v[104:107], v[40:43]
    s_add_u32 s80, s51, 131072
    s_add_u32 m0, s81, 49152
    s_nop 0
    buffer_load_dwordx4 v1, s[4:7], s80 offen sc1 lds
    v_mfma_f32_16x16x32_bf16 v[44:47], a[148:151], v[104:107], v[44:47]
    ds_read_b128 v[140:143], v1 offset:19456
    s_waitcnt lgkmcnt(8)
    v_mfma_f32_16x16x32_bf16 v[48:51], a[144:147], v[108:111], v[48:51]
    v_mfma_f32_16x16x32_bf16 v[52:55], a[148:151], v[108:111], v[52:55]
    s_waitcnt lgkmcnt(7)
    v_mfma_f32_16x16x32_bf16 v[56:59], a[144:147], v[112:115], v[56:59]
    s_add_u32 s80, s51, 135168
    s_add_u32 m0, s81, 53248
    s_nop 0
    buffer_load_dwordx4 v1, s[4:7], s80 offen sc1 lds
    v_mfma_f32_16x16x32_bf16 v[60:63], a[148:151], v[112:115], v[60:63]
    s_waitcnt lgkmcnt(6)
    v_mfma_f32_16x16x32_bf16 v[64:67], a[144:147], v[116:119], v[64:67]
    s_add_u32 s80, s51, 139264
    s_add_u32 m0, s81, 57344
    s_nop 0
    buffer_load_dwordx4 v1, s[4:7], s80 offen sc1 lds
    v_mfma_f32_16x16x32_bf16 v[68:71], a[148:151], v[116:119], v[68:71]
    s_waitcnt lgkmcnt(5)
    v_mfma_f32_16x16x32_bf16 v[72:75], a[144:147], v[120:123], v[72:75]
    v_mfma_f32_16x16x32_bf16 v[76:79], a[148:151], v[120:123], v[76:79]
    s_waitcnt vmcnt(10) lgkmcnt(4)
    v_mfma_f32_16x16x32_bf16 v[40:43], a[152:155], v[124:127], v[40:43]
    s_add_u32 s80, s51, 143360
    s_add_u32 m0, s81, 61440
    s_nop 0
    buffer_load_dwordx4 v1, s[4:7], s80 offen sc1 lds
    v_mfma_f32_16x16x32_bf16 v[44:47], a[156:159], v[124:127], v[44:47]
    s_waitcnt lgkmcnt(3)
    v_mfma_f32_16x16x32_bf16 v[48:51], a[152:155], v[128:131], v[48:51]
    v_mfma_f32_16x16x32_bf16 v[52:55], a[156:159], v[128:131], v[52:55]
    s_waitcnt lgkmcnt(2)
    v_mfma_f32_16x16x32_bf16 v[56:59], a[152:155], v[132:135], v[56:59]
    s_add_u32 s80, s51, 147456
    s_add_u32 m0, s81, 65536
    s_nop 0
    buffer_load_dwordx4 v1, s[4:7], s80 offen sc1 lds
    v_mfma_f32_16x16x32_bf16 v[60:63], a[156:159], v[132:135], v[60:63]
    s_waitcnt lgkmcnt(1)
    v_mfma_f32_16x16x32_bf16 v[64:67], a[152:155], v[136:139], v[64:67]
    v_mfma_f32_16x16x32_bf16 v[68:71], a[156:159], v[136:139], v[68:71]
    s_waitcnt lgkmcnt(0)
    v_mfma_f32_16x16x32_bf16 v[72:75], a[152:155], v[140:143], v[72:75]
    s_add_u32 s80, s51, 151552
    s_add_u32 m0, s81, 69632
    s_nop 0
    buffer_load_dwordx4 v1, s[4:7], s80 offen sc1 lds
    v_mfma_f32_16x16x32_bf16 v[76:79], a[156:159], v[140:143], v[76:79]
    v_pk_fma_f32 v[40:41], v[144:145], v[168:169], v[40:41] op_sel:[0,0,0] op_sel_hi:[1,0,1]
    v_pk_fma_f32 v[42:43], v[146:147], v[168:169], v[42:43] op_sel:[0,0,0] op_sel_hi:[1,0,1]
    v_pk_fma_f32 v[44:45], v[148:149], v[168:169], v[44:45] op_sel:[0,0,0] op_sel_hi:[1,0,1]
    v_pk_fma_f32 v[46:47], v[150:151], v[168:169], v[46:47] op_sel:[0,0,0] op_sel_hi:[1,0,1]
    v_pk_fma_f32 v[48:49], v[144:145], v[168:169], v[48:49] op_sel:[0,1,0] op_sel_hi:[1,1,1]
    v_pk_fma_f32 v[50:51], v[146:147], v[168:169], v[50:51] op_sel:[0,1,0] op_sel_hi:[1,1,1]
    v_pk_fma_f32 v[52:53], v[148:149], v[168:169], v[52:53] op_sel:[0,1,0] op_sel_hi:[1,1,1]
    v_pk_fma_f32 v[54:55], v[150:151], v[168:169], v[54:55] op_sel:[0,1,0] op_sel_hi:[1,1,1]
    v_pk_fma_f32 v[56:57], v[144:145], v[170:171], v[56:57] op_sel:[0,0,0] op_sel_hi:[1,0,1]
    v_pk_fma_f32 v[58:59], v[146:147], v[170:171], v[58:59] op_sel:[0,0,0] op_sel_hi:[1,0,1]
    v_pk_fma_f32 v[60:61], v[148:149], v[170:171], v[60:61] op_sel:[0,0,0] op_sel_hi:[1,0,1]
    v_pk_fma_f32 v[62:63], v[150:151], v[170:171], v[62:63] op_sel:[0,0,0] op_sel_hi:[1,0,1]
    v_pk_fma_f32 v[64:65], v[144:145], v[170:171], v[64:65] op_sel:[0,1,0] op_sel_hi:[1,1,1]
    v_pk_fma_f32 v[66:67], v[146:147], v[170:171], v[66:67] op_sel:[0,1,0] op_sel_hi:[1,1,1]
    v_pk_fma_f32 v[68:69], v[148:149], v[170:171], v[68:69] op_sel:[0,1,0] op_sel_hi:[1,1,1]
    v_pk_fma_f32 v[70:71], v[150:151], v[170:171], v[70:71] op_sel:[0,1,0] op_sel_hi:[1,1,1]
    v_pk_fma_f32 v[72:73], v[144:145], v[172:173], v[72:73] op_sel:[0,0,0] op_sel_hi:[1,0,1]
    v_pk_fma_f32 v[74:75], v[146:147], v[172:173], v[74:75] op_sel:[0,0,0] op_sel_hi:[1,0,1]
    v_pk_fma_f32 v[76:77], v[148:149], v[172:173], v[76:77] op_sel:[0,0,0] op_sel_hi:[1,0,1]
    v_pk_fma_f32 v[78:79], v[150:151], v[172:173], v[78:79] op_sel:[0,0,0] op_sel_hi:[1,0,1]
    s_waitcnt lgkmcnt(0)
    s_barrier
    v_pk_mul_f32 v[64:65], v[64:65], v[152:153] op_sel:[0,0] op_sel_hi:[1,1]
    v_pk_mul_f32 v[66:67], v[66:67], v[154:155] op_sel:[0,0] op_sel_hi:[1,1]
    v_pk_mul_f32 v[68:69], v[68:69], v[156:157] op_sel:[0,0] op_sel_hi:[1,1]
    v_pk_mul_f32 v[70:71], v[70:71], v[158:159] op_sel:[0,0] op_sel_hi:[1,1]
    v_cvt_pk_bf16_f32 v208, v64, v65
    v_cvt_pk_bf16_f32 v209, v66, v67
    v_cvt_pk_bf16_f32 v210, v68, v69
    v_cvt_pk_bf16_f32 v211, v70, v71
    ds_write_b128 v26, v[208:211] offset:12288
    v_pk_mul_f32 v[72:73], v[72:73], v[152:153] op_sel:[0,0] op_sel_hi:[1,1]
    v_pk_mul_f32 v[74:75], v[74:75], v[154:155] op_sel:[0,0] op_sel_hi:[1,1]
    v_pk_mul_f32 v[76:77], v[76:77], v[156:157] op_sel:[0,0] op_sel_hi:[1,1]
    v_pk_mul_f32 v[78:79], v[78:79], v[158:159] op_sel:[0,0] op_sel_hi:[1,1]
    v_cvt_pk_bf16_f32 v212, v72, v73
    v_cvt_pk_bf16_f32 v213, v74, v75
    s_add_u32 s80, s95, 0
    s_add_u32 m0, s81, 73728
    s_nop 0
    buffer_load_dwordx4 v1, s[4:7], s80 offen sc1 lds
    v_cvt_pk_bf16_f32 v214, v76, v77
    v_cvt_pk_bf16_f32 v215, v78, v79
    ds_write_b128 v26, v[212:215] offset:16384
    v_pk_mul_f32 v[216:217], v[40:41], v[160:161] op_sel:[0,0] op_sel_hi:[1,1]
    v_pk_fma_f32 v[218:219], v[40:41], v[152:153], v[18:19] op_sel:[0,0,0] op_sel_hi:[1,1,0]
    v_exp_f32_e64 v216, v216 clamp
    v_exp_f32_e64 v217, v217 clamp
    v_max_f32 v216, v216, v218
    v_max_f32 v217, v217, v219
    v_pk_add_f32 v[216:217], v[216:217], v[18:19] op_sel:[0,1] op_sel_hi:[1,1]
    v_cvt_pk_bf16_f32 v196, v216, v217
    v_pk_mul_f32 v[220:221], v[42:43], v[162:163] op_sel:[0,0] op_sel_hi:[1,1]
    v_pk_fma_f32 v[222:223], v[42:43], v[154:155], v[18:19] op_sel:[0,0,0] op_sel_hi:[1,1,0]
    v_exp_f32_e64 v220, v220 clamp
    v_exp_f32_e64 v221, v221 clamp
    v_max_f32 v220, v220, v222
    v_max_f32 v221, v221, v223
    v_pk_add_f32 v[220:221], v[220:221], v[18:19] op_sel:[0,1] op_sel_hi:[1,1]
    v_cvt_pk_bf16_f32 v197, v220, v221
    v_pk_mul_f32 v[216:217], v[44:45], v[164:165] op_sel:[0,0] op_sel_hi:[1,1]
    v_pk_fma_f32 v[218:219], v[44:45], v[156:157], v[18:19] op_sel:[0,0,0] op_sel_hi:[1,1,0]
    v_exp_f32_e64 v216, v216 clamp
    v_exp_f32_e64 v217, v217 clamp
    s_add_u32 s80, s95, 4096
    s_add_u32 m0, s81, 77824
    s_nop 0
    buffer_load_dwordx4 v1, s[4:7], s80 offen sc1 lds
    v_max_f32 v216, v216, v218
    v_max_f32 v217, v217, v219
    v_pk_add_f32 v[216:217], v[216:217], v[18:19] op_sel:[0,1] op_sel_hi:[1,1]
    v_cvt_pk_bf16_f32 v198, v216, v217
    v_pk_mul_f32 v[220:221], v[46:47], v[166:167] op_sel:[0,0] op_sel_hi:[1,1]
    v_pk_fma_f32 v[222:223], v[46:47], v[158:159], v[18:19] op_sel:[0,0,0] op_sel_hi:[1,1,0]
    v_exp_f32_e64 v220, v220 clamp
    v_exp_f32_e64 v221, v221 clamp
    v_max_f32 v220, v220, v222
    v_max_f32 v221, v221, v223
    v_pk_add_f32 v[220:221], v[220:221], v[18:19] op_sel:[0,1] op_sel_hi:[1,1]
    v_cvt_pk_bf16_f32 v199, v220, v221
    ds_write_b128 v26, v[196:199] offset:0
    v_pk_mul_f32 v[216:217], v[48:49], v[160:161] op_sel:[0,0] op_sel_hi:[1,1]
    v_pk_fma_f32 v[218:219], v[48:49], v[152:153], v[18:19] op_sel:[0,0,0] op_sel_hi:[1,1,0]
    v_exp_f32_e64 v216, v216 clamp
    v_exp_f32_e64 v217, v217 clamp
    v_max_f32 v216, v216, v218
    v_max_f32 v217, v217, v219
    v_pk_add_f32 v[216:217], v[216:217], v[18:19] op_sel:[0,1] op_sel_hi:[1,1]
    v_cvt_pk_bf16_f32 v200, v216, v217
    v_pk_mul_f32 v[220:221], v[50:51], v[162:163] op_sel:[0,0] op_sel_hi:[1,1]
    v_pk_fma_f32 v[222:223], v[50:51], v[154:155], v[18:19] op_sel:[0,0,0] op_sel_hi:[1,1,0]
    v_exp_f32_e64 v220, v220 clamp
    s_add_u32 s80, s95, 8192
    s_add_u32 m0, s81, 81920
    s_nop 0
    buffer_load_dwordx4 v1, s[4:7], s80 offen sc1 lds
    v_exp_f32_e64 v221, v221 clamp
    v_max_f32 v220, v220, v222
    v_max_f32 v221, v221, v223
    v_pk_add_f32 v[220:221], v[220:221], v[18:19] op_sel:[0,1] op_sel_hi:[1,1]
    v_cvt_pk_bf16_f32 v201, v220, v221
    v_pk_mul_f32 v[216:217], v[52:53], v[164:165] op_sel:[0,0] op_sel_hi:[1,1]
    v_pk_fma_f32 v[218:219], v[52:53], v[156:157], v[18:19] op_sel:[0,0,0] op_sel_hi:[1,1,0]
    v_exp_f32_e64 v216, v216 clamp
    v_exp_f32_e64 v217, v217 clamp
    v_max_f32 v216, v216, v218
    v_max_f32 v217, v217, v219
    v_pk_add_f32 v[216:217], v[216:217], v[18:19] op_sel:[0,1] op_sel_hi:[1,1]
    v_cvt_pk_bf16_f32 v202, v216, v217
    v_pk_mul_f32 v[220:221], v[54:55], v[166:167] op_sel:[0,0] op_sel_hi:[1,1]
    v_pk_fma_f32 v[222:223], v[54:55], v[158:159], v[18:19] op_sel:[0,0,0] op_sel_hi:[1,1,0]
    v_exp_f32_e64 v220, v220 clamp
    v_exp_f32_e64 v221, v221 clamp
    v_max_f32 v220, v220, v222
    v_max_f32 v221, v221, v223
    v_pk_add_f32 v[220:221], v[220:221], v[18:19] op_sel:[0,1] op_sel_hi:[1,1]
    v_cvt_pk_bf16_f32 v203, v220, v221
    ds_write_b128 v26, v[200:203] offset:4096
    v_pk_mul_f32 v[216:217], v[56:57], v[160:161] op_sel:[0,0] op_sel_hi:[1,1]
    v_pk_fma_f32 v[218:219], v[56:57], v[152:153], v[18:19] op_sel:[0,0,0] op_sel_hi:[1,1,0]
    s_add_u32 s80, s95, 12288
    s_add_u32 m0, s81, 86016
    s_nop 0
    buffer_load_dwordx4 v1, s[4:7], s80 offen sc1 lds
    v_exp_f32_e64 v216, v216 clamp
    v_exp_f32_e64 v217, v217 clamp
    v_max_f32 v216, v216, v218
    v_max_f32 v217, v217, v219
    v_pk_add_f32 v[216:217], v[216:217], v[18:19] op_sel:[0,1] op_sel_hi:[1,1]
    v_pk_mul_f32 v[218:219], v[56:57], v[152:153] op_sel:[0,0] op_sel_hi:[1,1]
    v_cndmask_b32 v216, v218, v216, s[66:67]
    v_cndmask_b32 v217, v219, v217, s[66:67]
    v_cvt_pk_bf16_f32 v204, v216, v217
    v_pk_mul_f32 v[220:221], v[58:59], v[162:163] op_sel:[0,0] op_sel_hi:[1,1]
    v_pk_fma_f32 v[222:223], v[58:59], v[154:155], v[18:19] op_sel:[0,0,0] op_sel_hi:[1,1,0]
    v_exp_f32_e64 v220, v220 clamp
    v_exp_f32_e64 v221, v221 clamp
    v_max_f32 v220, v220, v222
    v_max_f32 v221, v221, v223
    v_pk_add_f32 v[220:221], v[220:221], v[18:19] op_sel:[0,1] op_sel_hi:[1,1]
    v_pk_mul_f32 v[222:223], v[58:59], v[154:155] op_sel:[0,0] op_sel_hi:[1,1]
    v_cndmask_b32 v220, v222, v220, s[66:67]
    v_cndmask_b32 v221, v223, v221, s[66:67]
    v_cvt_pk_bf16_f32 v205, v220, v221
    v_pk_mul_f32 v[216:217], v[60:61], v[164:165] op_sel:[0,0] op_sel_hi:[1,1]
    v_pk_fma_f32 v[218:219], v[60:61], v[156:157], v[18:19] op_sel:[0,0,0] op_sel_hi:[1,1,0]
    v_exp_f32_e64 v216, v216 clamp
    s_add_u32 s80, s95, 16384
    s_add_u32 m0, s81, 90112
    s_nop 0
    buffer_load_dwordx4 v1, s[4:7], s80 offen sc1 lds
    v_exp_f32_e64 v217, v217 clamp
    v_max_f32 v216, v216, v218
    v_max_f32 v217, v217, v219
    v_pk_add_f32 v[216:217], v[216:217], v[18:19] op_sel:[0,1] op_sel_hi:[1,1]
    v_pk_mul_f32 v[218:219], v[60:61], v[156:157] op_sel:[0,0] op_sel_hi:[1,1]
    v_cndmask_b32 v216, v218, v216, s[66:67]
    v_cndmask_b32 v217, v219, v217, s[66:67]
    v_cvt_pk_bf16_f32 v206, v216, v217
    v_pk_mul_f32 v[220:221], v[62:63], v[166:167] op_sel:[0,0] op_sel_hi:[1,1]
    v_pk_fma_f32 v[222:223], v[62:63], v[158:159], v[18:19] op_sel:[0,0,0] op_sel_hi:[1,1,0]
    v_exp_f32_e64 v220, v220 clamp
    v_exp_f32_e64 v221, v221 clamp
    v_max_f32 v220, v220, v222
    v_max_f32 v221, v221, v223
    v_pk_add_f32 v[220:221], v[220:221], v[18:19] op_sel:[0,1] op_sel_hi:[1,1]
    v_pk_mul_f32 v[222:223], v[62:63], v[158:159] op_sel:[0,0] op_sel_hi:[1,1]
    v_cndmask_b32 v220, v222, v220, s[66:67]
    v_cndmask_b32 v221, v223, v221, s[66:67]
    v_cvt_pk_bf16_f32 v207, v220, v221
    ds_write_b128 v26, v[204:207] offset:8192
    s_add_u32 s80, s95, 20480
    s_add_u32 m0, s81, 94208
    s_nop 0
    buffer_load_dwordx4 v1, s[4:7], s80 offen sc1 lds
    v_mov_b32 v192, 0x3f803f80
    v_mov_b32 v193, 0x3f803f80
    v_mov_b32 v194, 0x3f803f80
    v_mov_b32 v195, 0x3f803f80
    s_waitcnt lgkmcnt(0)
    s_barrier
    ds_read_b128 v[40:43], v27 offset:0
    ds_read_b128 v[44:47], v28 offset:0
    ds_read_b128 v[48:51], v29 offset:0
    ds_read_b128 v[52:55], v27 offset:1024
    ds_read_b128 v[56:59], v28 offset:1024
    ds_read_b128 v[60:63], v29 offset:1024
    ds_read_b128 v[64:67], v27 offset:2048
    ds_read_b128 v[68:71], v28 offset:2048
    ds_read_b128 v[72:75], v29 offset:2048
    ds_read_b128 v[76:79], v27 offset:3072
    ds_read_b128 v[80:83], v28 offset:3072
    ds_read_b128 v[84:87], v29 offset:3072
    s_waitcnt lgkmcnt(9)
    v_mfma_f32_16x16x32_bf16 v[200:203], v[40:43], v[44:47], 0
    v_mfma_f32_16x16x32_bf16 v[204:207], v[40:43], v[48:51], 0
    v_mfma_f32_16x16x32_bf16 v[208:211], v[40:43], v[192:195], 0
    s_waitcnt lgkmcnt(6)
    v_mfma_f32_16x16x32_bf16 v[200:203], v[52:55], v[56:59], v[200:203]
    v_mfma_f32_16x16x32_bf16 v[204:207], v[52:55], v[60:63], v[204:207]
    v_mfma_f32_16x16x32_bf16 v[208:211], v[52:55], v[192:195], v[208:211]
    s_waitcnt lgkmcnt(3)
    v_mfma_f32_16x16x32_bf16 v[200:203], v[64:67], v[68:71], v[200:203]
    v_mfma_f32_16x16x32_bf16 v[204:207], v[64:67], v[72:75], v[204:207]
    v_mfma_f32_16x16x32_bf16 v[208:211], v[64:67], v[192:195], v[208:211]
    s_waitcnt lgkmcnt(0)
    v_mfma_f32_16x16x32_bf16 v[200:203], v[76:79], v[80:83], v[200:203]
    v_mfma_f32_16x16x32_bf16 v[204:207], v[76:79], v[84:87], v[204:207]
    v_mfma_f32_16x16x32_bf16 v[208:211], v[76:79], v[192:195], v[208:211]
    s_nop 5
    v_cvt_pk_bf16_f32 v216, v200, v201
    v_cvt_pk_bf16_f32 v217, v202, v203
    buffer_store_dwordx2 v[216:217], v33, s[4:7], s74 offen sc1
    v_cvt_pk_bf16_f32 v218, v204, v205
    v_cvt_pk_bf16_f32 v219, v206, v207
    buffer_store_dwordx2 v[218:219], v34, s[4:7], s74 offen sc1
    v_cvt_pk_bf16_f32 v220, v208, v209
    v_cvt_pk_bf16_f32 v221, v210, v211
    buffer_store_dwordx2 v[220:221], v35, s[4:7], s74 offen sc1
    s_waitcnt vmcnt(9)
    s_barrier
    ds_read_b128 v[104:107], v1 offset:20480
    ds_read_b128 v[108:111], v1 offset:21504
    ds_read_b128 v[112:115], v173 offset:28672
    ds_read_b128 v[116:119], v1 offset:22528
    ds_read_b128 v[120:123], v1 offset:23552
    ds_read_b128 v[124:127], v173 offset:29184
    ds_read_b128 v[128:131], v1 offset:24576
    ds_read_b128 v[132:135], v1 offset:25600
    ds_read_b128 v[136:139], v173 offset:29696
    s_waitcnt lgkmcnt(8)
    v_mfma_f32_16x16x32_bf16 v[80:83], v[104:107], a[0:3], 0
    s_add_u32 s80, s95, 24576
    s_add_u32 m0, s81, 98304
    s_nop 0
    buffer_load_dwordx4 v1, s[4:7], s80 offen sc1 lds
    v_mfma_f32_16x16x32_bf16 v[84:87], v[104:107], a[4:7], 0
    ds_read_b128 v[140:143], v1 offset:26624
    s_waitcnt lgkmcnt(8)
    v_mfma_f32_16x16x32_bf16 v[88:91], v[108:111], a[0:3], 0
    v_mfma_f32_16x16x32_bf16 v[92:95], v[108:111], a[4:7], 0
    ds_read_b128 v[104:107], v1 offset:27648
    s_waitcnt lgkmcnt(8)
    v_mfma_f32_16x16x32_bf16 v[96:99], v[112:115], a[0:3], 0
    s_add_u32 s80, s95, 28672
    s_add_u32 m0, s81, 102400
    s_nop 0
    buffer_load_dwordx4 v1, s[4:7], s80 offen sc1 lds
    v_mfma_f32_16x16x32_bf16 v[100:103], v[112:115], a[4:7], 0
    ds_read_b128 v[108:111], v173 offset:30208
    v_lshrrev_b32 v26, 2, v23
    v_and_b32 v27, 3, v23
    s_waitcnt lgkmcnt(8)
    v_mfma_f32_16x16x32_bf16 v[80:83], v[116:119], a[8:11], v[80:83]
    v_mad_u32_u24 v74, v26, 5, v27
    v_mad_u32_u24 v75, v26, 5, 4
    v_cmp_eq_u32 vcc, 0, v27
    v_mov_b32 v27, 161312
    v_mfma_f32_16x16x32_bf16 v[84:87], v[116:119], a[12:15], v[84:87]
    ds_read_b128 v[112:115], v1 offset:28672
    v_cmp_eq_u32 s[68:69], 0, v22
    v_cndmask_b32 v75, 20, v75, vcc
    s_waitcnt lgkmcnt(8)
    v_mfma_f32_16x16x32_bf16 v[88:91], v[120:123], a[8:11], v[88:91]
    v_cmp_gt_u32 s[72:73], 2, v22
    v_mul_u32_u24 v26, 80, v74
    v_add_u32 v26, 157952, v26
    v_lshl_add_u32 v28, v22, 4, v26
    v_mfma_f32_16x16x32_bf16 v[92:95], v[120:123], a[12:15], v[92:95]
    ds_read_b128 v[116:119], v1 offset:29696
    v_add_u32 v26, 64, v26
    v_cndmask_b32 v29, v27, v26, s[68:69]
    s_waitcnt lgkmcnt(8)
    v_mfma_f32_16x16x32_bf16 v[96:99], v[124:127], a[8:11], v[96:99]
    s_add_u32 s80, s95, 32768
    s_add_u32 m0, s81, 106496
    s_nop 0
    buffer_load_dwordx4 v1, s[4:7], s80 offen sc1 lds
    v_mfma_f32_16x16x32_bf16 v[100:103], v[124:127], a[12:15], v[100:103]
    ds_read_b128 v[120:123], v173 offset:30720
    v_add_u32 v26, 1664, v28
    v_cndmask_b32 v30, v26, v27, s[68:69]
    s_waitcnt lgkmcnt(8)
    v_mfma_f32_16x16x32_bf16 v[80:83], v[128:131], a[16:19], v[80:83]
    v_add_u32 v26, 64, v26
    v_cndmask_b32 v31, v27, v26, s[72:73]
    v_mul_u32_u24 v26, 80, v75
    v_add_u32 v26, 157952, v26
    v_mfma_f32_16x16x32_bf16 v[84:87], v[128:131], a[20:23], v[84:87]
    ds_read_b128 v[124:127], v1 offset:30720
    v_lshl_add_u32 v32, v22, 4, v26
    v_add_u32 v26, 64, v26
    s_waitcnt lgkmcnt(8)
    v_mfma_f32_16x16x32_bf16 v[88:91], v[132:135], a[16:19], v[88:91]
    s_add_u32 s80, s95, 36864
    s_add_u32 m0, s81, 110592
    s_nop 0
    buffer_load_dwordx4 v1, s[4:7], s80 offen sc1 lds
    v_mfma_f32_16x16x32_bf16 v[92:95], v[132:135], a[20:23], v[92:95]
    ds_read_b128 v[128:131], v1 offset:31744
    v_cndmask_b32 v33, v27, v26, s[68:69]
    v_add_u32 v26, 1664, v32
    s_waitcnt lgkmcnt(8)
    v_mfma_f32_16x16x32_bf16 v[96:99], v[136:139], a[16:19], v[96:99]
    v_cndmask_b32 v34, v26, v27, s[68:69]
    v_add_u32 v26, 64, v26
    v_cndmask_b32 v35, v27, v26, s[72:73]
    s_mul_i32 s60, s54, 5
    v_mfma_f32_16x16x32_bf16 v[100:103], v[136:139], a[20:23], v[100:103]
    ds_read_b128 v[132:135], v173 offset:31232
    v_add_u32 v26, s60, v22
    v_lshlrev_b32 v26, 8, v26
    s_waitcnt lgkmcnt(8)
    v_mfma_f32_16x16x32_bf16 v[80:83], v[140:143], a[24:27], v[80:83]
    v_lshl_add_u32 v26, v23, 4, v26
    s_add_u32 s60, s60, 4
    s_lshl_b32 s60, s60, 8
    v_lshl_add_u32 v27, v23, 4, s60
    v_mfma_f32_16x16x32_bf16 v[84:87], v[140:143], a[28:31], v[84:87]
    ds_read_b128 v[136:139], v1 offset:32768
    v_lshl_add_u32 v27, v22, 2, v27
    s_mul_i32 s62, s57, 24576
    s_waitcnt lgkmcnt(8)
    v_mfma_f32_16x16x32_bf16 v[88:91], v[104:107], a[24:27], v[88:91]
    s_add_u32 s80, s95, 40960
    s_add_u32 m0, s81, 114688
    s_nop 0
    buffer_load_dwordx4 v1, s[4:7], s80 offen sc1 lds
    v_mfma_f32_16x16x32_bf16 v[92:95], v[104:107], a[28:31], v[92:95]
    ds_read_b128 v[140:143], v1 offset:33792
    s_add_u32 s62, s62, 14901248
    s_lshl_b32 s63, s45, 1
    s_waitcnt lgkmcnt(8)
    v_mfma_f32_16x16x32_bf16 v[96:99], v[108:111], a[24:27], v[96:99]
    s_add_u32 s63, s63, s53
    s_lshl_b32 s63, s63, 2
    s_add_u32 s63, s63, s44
    s_lshl_b32 s63, s63, 4
    v_mfma_f32_16x16x32_bf16 v[100:103], v[108:111], a[28:31], v[100:103]
    ds_read_b128 v[104:107], v173 offset:31744
    s_add_u32 s63, s63, s54
    s_lshl_b32 s63, s63, 2
    s_waitcnt lgkmcnt(8)
    v_mfma_f32_16x16x32_bf16 v[80:83], v[112:115], a[32:35], v[80:83]
    s_add_u32 s80, s95, 45056
    s_add_u32 m0, s81, 118784
    s_nop 0
    buffer_load_dwordx4 v1, s[4:7], s80 offen sc1 lds
    v_mfma_f32_16x16x32_bf16 v[84:87], v[112:115], a[36:39], v[84:87]
    ds_read_b128 v[108:111], v1 offset:34816
    s_add_u32 s63, s63, 0
    s_waitcnt lgkmcnt(8)
    v_mfma_f32_16x16x32_bf16 v[88:91], v[116:119], a[32:35], v[88:91]
    v_mfma_f32_16x16x32_bf16 v[92:95], v[116:119], a[36:39], v[92:95]
    ds_read_b128 v[112:115], v1 offset:35840
    s_waitcnt lgkmcnt(8)
    v_mfma_f32_16x16x32_bf16 v[96:99], v[120:123], a[32:35], v[96:99]
    v_mfma_f32_16x16x32_bf16 v[100:103], v[120:123], a[36:39], v[100:103]
    ds_read_b128 v[116:119], v173 offset:32256
    s_waitcnt lgkmcnt(8)
    v_mfma_f32_16x16x32_bf16 v[80:83], v[124:127], a[40:43], v[80:83]
    s_add_u32 s80, s95, 49152
    s_add_u32 m0, s81, 122880
    s_nop 0
    buffer_load_dwordx4 v1, s[4:7], s80 offen sc1 lds
    v_mfma_f32_16x16x32_bf16 v[84:87], v[124:127], a[44:47], v[84:87]
    ds_read_b128 v[120:123], v1 offset:36864
    s_waitcnt lgkmcnt(8)
    v_mfma_f32_16x16x32_bf16 v[88:91], v[128:131], a[40:43], v[88:91]
    v_mfma_f32_16x16x32_bf16 v[92:95], v[128:131], a[44:47], v[92:95]
    ds_read_b128 v[124:127], v1 offset:37888
    s_waitcnt lgkmcnt(8)
    v_mfma_f32_16x16x32_bf16 v[96:99], v[132:135], a[40:43], v[96:99]
    s_add_u32 s80, s95, 53248
    s_add_u32 m0, s81, 126976
    s_nop 0
    buffer_load_dwordx4 v1, s[4:7], s80 offen sc1 lds
    v_mfma_f32_16x16x32_bf16 v[100:103], v[132:135], a[44:47], v[100:103]
    ds_read_b128 v[128:131], v173 offset:32768
    s_waitcnt lgkmcnt(8)
    v_mfma_f32_16x16x32_bf16 v[80:83], v[136:139], a[48:51], v[80:83]
    v_mfma_f32_16x16x32_bf16 v[84:87], v[136:139], a[52:55], v[84:87]
    ds_read_b128 v[132:135], v1 offset:38912
    s_waitcnt lgkmcnt(8)
    v_mfma_f32_16x16x32_bf16 v[88:91], v[140:143], a[48:51], v[88:91]
    v_mfma_f32_16x16x32_bf16 v[92:95], v[140:143], a[52:55], v[92:95]
    ds_read_b128 v[136:139], v1 offset:39936
    s_waitcnt lgkmcnt(8)
    v_mfma_f32_16x16x32_bf16 v[96:99], v[104:107], a[48:51], v[96:99]
    s_add_u32 s80, s95, 57344
    s_add_u32 m0, s81, 131072
    s_nop 0
    buffer_load_dwordx4 v1, s[4:7], s80 offen sc1 lds
    v_mfma_f32_16x16x32_bf16 v[100:103], v[104:107], a[52:55], v[100:103]
    ds_read_b128 v[140:143], v173 offset:33280
    s_waitcnt lgkmcnt(8)
    v_mfma_f32_16x16x32_bf16 v[80:83], v[108:111], a[56:59], v[80:83]
    v_mfma_f32_16x16x32_bf16 v[84:87], v[108:111], a[60:63], v[84:87]
    ds_read_b128 v[104:107], v1 offset:40960
    s_waitcnt lgkmcnt(8)
    v_mfma_f32_16x16x32_bf16 v[88:91], v[112:115], a[56:59], v[88:91]
    s_add_u32 s80, s95, 61440
    s_add_u32 m0, s81, 135168
    s_nop 0
    buffer_load_dwordx4 v1, s[4:7], s80 offen sc1 lds
    v_mfma_f32_16x16x32_bf16 v[92:95], v[112:115], a[60:63], v[92:95]
    ds_read_b128 v[108:111], v1 offset:41984
    s_waitcnt lgkmcnt(8)
    v_mfma_f32_16x16x32_bf16 v[96:99], v[116:119], a[56:59], v[96:99]
    v_mfma_f32_16x16x32_bf16 v[100:103], v[116:119], a[60:63], v[100:103]
    ds_read_b128 v[112:115], v173 offset:33792
    s_waitcnt lgkmcnt(8)
    v_mfma_f32_16x16x32_bf16 v[80:83], v[120:123], a[64:67], v[80:83]
    v_mfma_f32_16x16x32_bf16 v[84:87], v[120:123], a[68:71], v[84:87]
    ds_read_b128 v[116:119], v1 offset:43008
    s_waitcnt lgkmcnt(8)
    v_mfma_f32_16x16x32_bf16 v[88:91], v[124:127], a[64:67], v[88:91]
    s_add_u32 s80, s95, 65536
    s_add_u32 m0, s81, 139264
    s_nop 0
    buffer_load_dwordx4 v1, s[4:7], s80 offen sc1 lds
    v_mfma_f32_16x16x32_bf16 v[92:95], v[124:127], a[68:71], v[92:95]
    ds_read_b128 v[120:123], v1 offset:44032
    s_waitcnt lgkmcnt(8)
    v_mfma_f32_16x16x32_bf16 v[96:99], v[128:131], a[64:67], v[96:99]
    v_mfma_f32_16x16x32_bf16 v[100:103], v[128:131], a[68:71], v[100:103]
    ds_read_b128 v[124:127], v173 offset:34304
    s_waitcnt lgkmcnt(8)
    v_mfma_f32_16x16x32_bf16 v[80:83], v[132:135], a[72:75], v[80:83]
    s_add_u32 s80, s95, 69632
    s_add_u32 m0, s81, 143360
    s_nop 0
    buffer_load_dwordx4 v1, s[4:7], s80 offen sc1 lds
    v_mfma_f32_16x16x32_bf16 v[84:87], v[132:135], a[76:79], v[84:87]
    ds_read_b128 v[128:131], v1 offset:45056
    s_waitcnt lgkmcnt(8)
    v_mfma_f32_16x16x32_bf16 v[88:91], v[136:139], a[72:75], v[88:91]
    v_mfma_f32_16x16x32_bf16 v[92:95], v[136:139], a[76:79], v[92:95]
    ds_read_b128 v[132:135], v1 offset:46080
    s_waitcnt lgkmcnt(8)
    v_mfma_f32_16x16x32_bf16 v[96:99], v[140:143], a[72:75], v[96:99]
    v_mfma_f32_16x16x32_bf16 v[100:103], v[140:143], a[76:79], v[100:103]
    ds_read_b128 v[136:139], v173 offset:34816
    s_waitcnt lgkmcnt(8)
    v_mfma_f32_16x16x32_bf16 v[80:83], v[104:107], a[80:83], v[80:83]
    v_mfma_f32_16x16x32_bf16 v[84:87], v[104:107], a[84:87], v[84:87]
    ds_read_b128 v[140:143], v1 offset:47104
    s_waitcnt lgkmcnt(8)
    v_mfma_f32_16x16x32_bf16 v[88:91], v[108:111], a[80:83], v[88:91]
    v_mfma_f32_16x16x32_bf16 v[92:95], v[108:111], a[84:87], v[92:95]
    ds_read_b128 v[104:107], v1 offset:48128
    s_waitcnt lgkmcnt(8)
    v_mfma_f32_16x16x32_bf16 v[96:99], v[112:115], a[80:83], v[96:99]
    v_mfma_f32_16x16x32_bf16 v[100:103], v[112:115], a[84:87], v[100:103]
    ds_read_b128 v[108:111], v173 offset:35328
    s_waitcnt lgkmcnt(8)
    v_mfma_f32_16x16x32_bf16 v[80:83], v[116:119], a[88:91], v[80:83]
    v_mfma_f32_16x16x32_bf16 v[84:87], v[116:119], a[92:95], v[84:87]
    ds_read_b128 v[112:115], v1 offset:49152
    s_waitcnt lgkmcnt(8)
    v_mfma_f32_16x16x32_bf16 v[88:91], v[120:123], a[88:91], v[88:91]
    v_mfma_f32_16x16x32_bf16 v[92:95], v[120:123], a[92:95], v[92:95]
    ds_read_b128 v[116:119], v1 offset:50176
    s_waitcnt lgkmcnt(8)
    v_mfma_f32_16x16x32_bf16 v[96:99], v[124:127], a[88:91], v[96:99]
    v_mfma_f32_16x16x32_bf16 v[100:103], v[124:127], a[92:95], v[100:103]
    ds_read_b128 v[120:123], v173 offset:35840
    s_waitcnt lgkmcnt(8)
    v_mfma_f32_16x16x32_bf16 v[80:83], v[128:131], a[96:99], v[80:83]
    s_add_u32 s80, s71, 0
    buffer_load_dwordx4 v[192:195], v37, s[4:7], s80 offen sc1
    v_mfma_f32_16x16x32_bf16 v[84:87], v[128:131], a[100:103], v[84:87]
    ds_read_b128 v[124:127], v1 offset:51200
    s_waitcnt lgkmcnt(8)
    v_mfma_f32_16x16x32_bf16 v[88:91], v[132:135], a[96:99], v[88:91]
    v_mfma_f32_16x16x32_bf16 v[92:95], v[132:135], a[100:103], v[92:95]
    ds_read_b128 v[128:131], v1 offset:52224
    s_waitcnt lgkmcnt(8)
    v_mfma_f32_16x16x32_bf16 v[96:99], v[136:139], a[96:99], v[96:99]
    s_add_u32 s80, s71, 3584
    buffer_load_dwordx4 v[196:199], v37, s[4:7], s80 offen sc1
    v_mfma_f32_16x16x32_bf16 v[100:103], v[136:139], a[100:103], v[100:103]
    ds_read_b128 v[132:135], v173 offset:36352
    s_waitcnt lgkmcnt(8)
    v_mfma_f32_16x16x32_bf16 v[80:83], v[140:143], a[104:107], v[80:83]
    v_mfma_f32_16x16x32_bf16 v[84:87], v[140:143], a[108:111], v[84:87]
    ds_read_b128 v[136:139], v1 offset:53248
    s_waitcnt lgkmcnt(8)
    v_mfma_f32_16x16x32_bf16 v[88:91], v[104:107], a[104:107], v[88:91]
    s_add_u32 s80, s71, 7168
    buffer_load_dwordx4 v[200:203], v37, s[4:7], s80 offen sc1
    v_mfma_f32_16x16x32_bf16 v[92:95], v[104:107], a[108:111], v[92:95]
    ds_read_b128 v[140:143], v1 offset:54272
    s_waitcnt lgkmcnt(8)
    v_mfma_f32_16x16x32_bf16 v[96:99], v[108:111], a[104:107], v[96:99]
    v_mfma_f32_16x16x32_bf16 v[100:103], v[108:111], a[108:111], v[100:103]
    ds_read_b128 v[104:107], v173 offset:36864
    s_waitcnt lgkmcnt(8)
    v_mfma_f32_16x16x32_bf16 v[80:83], v[112:115], a[112:115], v[80:83]
    s_add_u32 s80, s71, 10752
    buffer_load_dwordx4 v[204:207], v37, s[4:7], s80 offen sc1
    v_mfma_f32_16x16x32_bf16 v[84:87], v[112:115], a[116:119], v[84:87]
    ds_read_b128 v[108:111], v1 offset:55296
    s_waitcnt lgkmcnt(8)
    v_mfma_f32_16x16x32_bf16 v[88:91], v[116:119], a[112:115], v[88:91]
    v_mfma_f32_16x16x32_bf16 v[92:95], v[116:119], a[116:119], v[92:95]
    ds_read_b128 v[112:115], v1 offset:56320
    s_waitcnt lgkmcnt(8)
    v_mfma_f32_16x16x32_bf16 v[96:99], v[120:123], a[112:115], v[96:99]
    s_add_u32 s80, s71, 14336
    buffer_load_dwordx4 v[208:211], v37, s[4:7], s80 offen sc1
    v_mfma_f32_16x16x32_bf16 v[100:103], v[120:123], a[116:119], v[100:103]
    ds_read_b128 v[116:119], v173 offset:37376
    s_waitcnt lgkmcnt(8)
    v_mfma_f32_16x16x32_bf16 v[80:83], v[124:127], a[120:123], v[80:83]
    v_mfma_f32_16x16x32_bf16 v[84:87], v[124:127], a[124:127], v[84:87]
    ds_read_b128 v[120:123], v1 offset:57344
    s_waitcnt lgkmcnt(8)
    v_mfma_f32_16x16x32_bf16 v[88:91], v[128:131], a[120:123], v[88:91]
    s_add_u32 s80, s71, 17920
    buffer_load_dwordx4 v[212:215], v37, s[4:7], s80 offen sc1
    v_mfma_f32_16x16x32_bf16 v[92:95], v[128:131], a[124:127], v[92:95]
    ds_read_b128 v[124:127], v1 offset:58368
    s_waitcnt lgkmcnt(8)
    v_mfma_f32_16x16x32_bf16 v[96:99], v[132:135], a[120:123], v[96:99]
    v_mfma_f32_16x16x32_bf16 v[100:103], v[132:135], a[124:127], v[100:103]
    ds_read_b128 v[128:131], v173 offset:37888
    s_waitcnt lgkmcnt(8)
    v_mfma_f32_16x16x32_bf16 v[80:83], v[136:139], a[128:131], v[80:83]
    s_add_u32 s80, s71, 21504
    buffer_load_dwordx4 v[216:219], v37, s[4:7], s80 offen sc1
    v_mfma_f32_16x16x32_bf16 v[84:87], v[136:139], a[132:135], v[84:87]
    ds_read_b128 v[132:135], v1 offset:59392
    s_waitcnt lgkmcnt(8)
    v_mfma_f32_16x16x32_bf16 v[88:91], v[140:143], a[128:131], v[88:91]
    v_mfma_f32_16x16x32_bf16 v[92:95], v[140:143], a[132:135], v[92:95]
    ds_read_b128 v[136:139], v1 offset:60416
    s_waitcnt lgkmcnt(8)
    v_mfma_f32_16x16x32_bf16 v[96:99], v[104:107], a[128:131], v[96:99]
    s_add_u32 s80, s71, 25088
    buffer_load_dwordx4 v[220:223], v37, s[4:7], s80 offen sc1
    v_mfma_f32_16x16x32_bf16 v[100:103], v[104:107], a[132:135], v[100:103]
    ds_read_b128 v[140:143], v173 offset:38400
    s_waitcnt lgkmcnt(8)
    v_mfma_f32_16x16x32_bf16 v[80:83], v[108:111], a[136:139], v[80:83]
    v_mfma_f32_16x16x32_bf16 v[84:87], v[108:111], a[140:143], v[84:87]
    s_waitcnt lgkmcnt(7)
    v_mfma_f32_16x16x32_bf16 v[88:91], v[112:115], a[136:139], v[88:91]
    v_mfma_f32_16x16x32_bf16 v[92:95], v[112:115], a[140:143], v[92:95]
    s_waitcnt lgkmcnt(6)
    v_mfma_f32_16x16x32_bf16 v[96:99], v[116:119], a[136:139], v[96:99]
    v_mfma_f32_16x16x32_bf16 v[100:103], v[116:119], a[140:143], v[100:103]
    s_waitcnt lgkmcnt(5)
    v_mfma_f32_16x16x32_bf16 v[80:83], v[120:123], a[144:147], v[80:83]
    v_mfma_f32_16x16x32_bf16 v[84:87], v[120:123], a[148:151], v[84:87]
    s_waitcnt lgkmcnt(4)
    v_mfma_f32_16x16x32_bf16 v[88:91], v[124:127], a[144:147], v[88:91]
    v_mfma_f32_16x16x32_bf16 v[92:95], v[124:127], a[148:151], v[92:95]
    s_waitcnt lgkmcnt(3)
    v_mfma_f32_16x16x32_bf16 v[96:99], v[128:131], a[144:147], v[96:99]
    v_mfma_f32_16x16x32_bf16 v[100:103], v[128:131], a[148:151], v[100:103]
    s_waitcnt lgkmcnt(2)
    v_mfma_f32_16x16x32_bf16 v[80:83], v[132:135], a[152:155], v[80:83]
    v_mfma_f32_16x16x32_bf16 v[84:87], v[132:135], a[156:159], v[84:87]
    s_waitcnt lgkmcnt(1)
    v_mfma_f32_16x16x32_bf16 v[88:91], v[136:139], a[152:155], v[88:91]
    v_mfma_f32_16x16x32_bf16 v[92:95], v[136:139], a[156:159], v[92:95]
    s_waitcnt lgkmcnt(0)
    v_mfma_f32_16x16x32_bf16 v[96:99], v[140:143], a[152:155], v[96:99]
    v_mfma_f32_16x16x32_bf16 v[100:103], v[140:143], a[156:159], v[100:103]
    s_nop 0
    v_pk_fma_f32 v[80:81], v[180:181], v[174:175], v[80:81] op_sel:[0,0,0] op_sel_hi:[1,0,1]
    v_pk_fma_f32 v[82:83], v[182:183], v[174:175], v[82:83] op_sel:[0,0,0] op_sel_hi:[1,0,1]
    s_nop 0
    v_pk_fma_f32 v[88:89], v[184:185], v[174:175], v[88:89] op_sel:[0,0,0] op_sel_hi:[1,0,1]
    v_pk_fma_f32 v[90:91], v[186:187], v[174:175], v[90:91] op_sel:[0,0,0] op_sel_hi:[1,0,1]
    s_nop 0
    v_pk_fma_f32 v[96:97], v[188:189], v[174:175], v[96:97] op_sel:[0,0,0] op_sel_hi:[1,0,1]
    v_pk_fma_f32 v[98:99], v[190:191], v[174:175], v[98:99] op_sel:[0,0,0] op_sel_hi:[1,0,1]
    v_pk_fma_f32 v[84:85], v[180:181], v[174:175], v[84:85] op_sel:[0,1,0] op_sel_hi:[1,1,1]
    v_pk_fma_f32 v[86:87], v[182:183], v[174:175], v[86:87] op_sel:[0,1,0] op_sel_hi:[1,1,1]
    v_pk_fma_f32 v[92:93], v[184:185], v[174:175], v[92:93] op_sel:[0,1,0] op_sel_hi:[1,1,1]
    v_pk_fma_f32 v[94:95], v[186:187], v[174:175], v[94:95] op_sel:[0,1,0] op_sel_hi:[1,1,1]
    v_pk_fma_f32 v[100:101], v[188:189], v[174:175], v[100:101] op_sel:[0,1,0] op_sel_hi:[1,1,1]
    s_add_u32 s80, s95, 73728
    s_add_u32 m0, s81, 147456
    s_nop 0
    buffer_load_dwordx4 v1, s[4:7], s80 offen sc1 lds
    v_pk_fma_f32 v[102:103], v[190:191], v[174:175], v[102:103] op_sel:[0,1,0] op_sel_hi:[1,1,1]
    v_pk_mul_f32 v[156:157], v[80:81], v[178:179] op_sel:[0,0] op_sel_hi:[1,0]
    v_pk_fma_f32 v[158:159], v[80:81], v[176:177], v[18:19] op_sel:[0,0,0] op_sel_hi:[1,0,0]
    v_exp_f32_e64 v156, v156 clamp
    v_exp_f32_e64 v157, v157 clamp
    v_max_f32 v156, v156, v158
    v_max_f32 v157, v157, v159
    v_pk_add_f32 v[156:157], v[156:157], v[18:19] op_sel:[0,1] op_sel_hi:[1,1]
    v_cvt_pk_bf16_f32 v144, v156, v157
    v_pk_mul_f32 v[160:161], v[82:83], v[178:179] op_sel:[0,0] op_sel_hi:[1,0]
    v_pk_fma_f32 v[162:163], v[82:83], v[176:177], v[18:19] op_sel:[0,0,0] op_sel_hi:[1,0,0]
    v_exp_f32_e64 v160, v160 clamp
    v_exp_f32_e64 v161, v161 clamp
    v_max_f32 v160, v160, v162
    v_max_f32 v161, v161, v163
    v_pk_add_f32 v[160:161], v[160:161], v[18:19] op_sel:[0,1] op_sel_hi:[1,1]
    v_cvt_pk_bf16_f32 v145, v160, v161
    v_pk_mul_f32 v[156:157], v[88:89], v[178:179] op_sel:[0,0] op_sel_hi:[1,0]
    s_add_u32 s80, s95, 77824
    s_add_u32 m0, s81, 151552
    s_nop 0
    buffer_load_dwordx4 v1, s[4:7], s80 offen sc1 lds
    v_pk_fma_f32 v[158:159], v[88:89], v[176:177], v[18:19] op_sel:[0,0,0] op_sel_hi:[1,0,0]
    v_exp_f32_e64 v156, v156 clamp
    v_exp_f32_e64 v157, v157 clamp
    v_max_f32 v156, v156, v158
    v_max_f32 v157, v157, v159
    v_pk_add_f32 v[156:157], v[156:157], v[18:19] op_sel:[0,1] op_sel_hi:[1,1]
    v_cvt_pk_bf16_f32 v146, v156, v157
    v_pk_mul_f32 v[160:161], v[90:91], v[178:179] op_sel:[0,0] op_sel_hi:[1,0]
    v_pk_fma_f32 v[162:163], v[90:91], v[176:177], v[18:19] op_sel:[0,0,0] op_sel_hi:[1,0,0]
    v_exp_f32_e64 v160, v160 clamp
    v_exp_f32_e64 v161, v161 clamp
    v_max_f32 v160, v160, v162
    v_max_f32 v161, v161, v163
    v_pk_add_f32 v[160:161], v[160:161], v[18:19] op_sel:[0,1] op_sel_hi:[1,1]
    v_cvt_pk_bf16_f32 v147, v160, v161
    v_pk_mul_f32 v[156:157], v[96:97], v[178:179] op_sel:[0,0] op_sel_hi:[1,0]
    v_pk_fma_f32 v[158:159], v[96:97], v[176:177], v[18:19] op_sel:[0,0,0] op_sel_hi:[1,0,0]
    v_exp_f32_e64 v156, v156 clamp
    s_add_u32 s80, s95, 81920
    s_add_u32 m0, s81, 0
    s_nop 0
    buffer_load_dwordx4 v1, s[4:7], s80 offen sc1 lds
    v_exp_f32_e64 v157, v157 clamp
    v_max_f32 v156, v156, v158
    v_max_f32 v157, v157, v159
    v_pk_add_f32 v[156:157], v[156:157], v[18:19] op_sel:[0,1] op_sel_hi:[1,1]
    v_cvt_pk_bf16_f32 v148, v156, v157
    v_pk_mul_f32 v[160:161], v[98:99], v[178:179] op_sel:[0,0] op_sel_hi:[1,0]
    v_pk_fma_f32 v[162:163], v[98:99], v[176:177], v[18:19] op_sel:[0,0,0] op_sel_hi:[1,0,0]
    v_exp_f32_e64 v160, v160 clamp
    v_exp_f32_e64 v161, v161 clamp
    v_max_f32 v160, v160, v162
    v_max_f32 v161, v161, v163
    v_pk_add_f32 v[160:161], v[160:161], v[18:19] op_sel:[0,1] op_sel_hi:[1,1]
    v_cvt_pk_bf16_f32 v149, v160, v161
    v_pk_mul_f32 v[156:157], v[84:85], v[178:179] op_sel:[0,1] op_sel_hi:[1,1]
    v_pk_fma_f32 v[158:159], v[84:85], v[176:177], v[18:19] op_sel:[0,1,0] op_sel_hi:[1,1,0]
    v_exp_f32_e64 v156, v156 clamp
    v_exp_f32_e64 v157, v157 clamp
    s_add_u32 s80, s95, 86016
    s_add_u32 m0, s81, 4096
    s_nop 0
    buffer_load_dwordx4 v1, s[4:7], s80 offen sc1 lds
    v_max_f32 v156, v156, v158
    v_max_f32 v157, v157, v159
    v_pk_add_f32 v[156:157], v[156:157], v[18:19] op_sel:[0,1] op_sel_hi:[1,1]
    v_cvt_pk_bf16_f32 v150, v156, v157
    v_pk_mul_f32 v[160:161], v[86:87], v[178:179] op_sel:[0,1] op_sel_hi:[1,1]
    v_pk_fma_f32 v[162:163], v[86:87], v[176:177], v[18:19] op_sel:[0,1,0] op_sel_hi:[1,1,0]
    v_exp_f32_e64 v160, v160 clamp
    v_exp_f32_e64 v161, v161 clamp
    v_max_f32 v160, v160, v162
    v_max_f32 v161, v161, v163
    v_pk_add_f32 v[160:161], v[160:161], v[18:19] op_sel:[0,1] op_sel_hi:[1,1]
    v_cvt_pk_bf16_f32 v151, v160, v161
    v_pk_mul_f32 v[156:157], v[92:93], v[178:179] op_sel:[0,1] op_sel_hi:[1,1]
    v_pk_fma_f32 v[158:159], v[92:93], v[176:177], v[18:19] op_sel:[0,1,0] op_sel_hi:[1,1,0]
    v_exp_f32_e64 v156, v156 clamp
    v_exp_f32_e64 v157, v157 clamp
    v_max_f32 v156, v156, v158
    v_max_f32 v157, v157, v159
    s_add_u32 s80, s95, 90112
    s_add_u32 m0, s81, 8192
    s_nop 0
    buffer_load_dwordx4 v1, s[4:7], s80 offen sc1 lds
    v_pk_add_f32 v[156:157], v[156:157], v[18:19] op_sel:[0,1] op_sel_hi:[1,1]
    v_cvt_pk_bf16_f32 v152, v156, v157
    v_pk_mul_f32 v[160:161], v[94:95], v[178:179] op_sel:[0,1] op_sel_hi:[1,1]
    v_pk_fma_f32 v[162:163], v[94:95], v[176:177], v[18:19] op_sel:[0,1,0] op_sel_hi:[1,1,0]
    v_exp_f32_e64 v160, v160 clamp
    v_exp_f32_e64 v161, v161 clamp
    v_max_f32 v160, v160, v162
    v_max_f32 v161, v161, v163
    v_pk_add_f32 v[160:161], v[160:161], v[18:19] op_sel:[0,1] op_sel_hi:[1,1]
    v_cvt_pk_bf16_f32 v153, v160, v161
    v_pk_mul_f32 v[156:157], v[100:101], v[178:179] op_sel:[0,1] op_sel_hi:[1,1]
    v_pk_fma_f32 v[158:159], v[100:101], v[176:177], v[18:19] op_sel:[0,1,0] op_sel_hi:[1,1,0]
    v_exp_f32_e64 v156, v156 clamp
    v_exp_f32_e64 v157, v157 clamp
    v_max_f32 v156, v156, v158
    v_max_f32 v157, v157, v159
    v_pk_add_f32 v[156:157], v[156:157], v[18:19] op_sel:[0,1] op_sel_hi:[1,1]
    v_cvt_pk_bf16_f32 v154, v156, v157
    s_add_u32 s80, s95, 94208
    s_add_u32 m0, s81, 12288
    s_nop 0
    buffer_load_dwordx4 v1, s[4:7], s80 offen sc1 lds
    v_pk_mul_f32 v[160:161], v[102:103], v[178:179] op_sel:[0,1] op_sel_hi:[1,1]
    v_pk_fma_f32 v[162:163], v[102:103], v[176:177], v[18:19] op_sel:[0,1,0] op_sel_hi:[1,1,0]
    v_exp_f32_e64 v160, v160 clamp
    v_exp_f32_e64 v161, v161 clamp
    v_max_f32 v160, v160, v162
    v_max_f32 v161, v161, v163
    v_pk_add_f32 v[160:161], v[160:161], v[18:19] op_sel:[0,1] op_sel_hi:[1,1]
    v_cvt_pk_bf16_f32 v155, v160, v161
    v_cndmask_b32 v148, 0, v148, s[72:73]
    v_cndmask_b32 v149, 0, v149, s[72:73]
    v_cndmask_b32 v154, 0, v154, s[72:73]
    v_cndmask_b32 v155, 0, v155, s[72:73]
    s_mov_b32 s82, 0
    s_waitcnt vmcnt(6)
Lchk_87:
    v_max_u32 v77, v192, v193
    v_max3_u32 v77, v194, v195, v77
    v_max3_u32 v77, v196, v197, v77
    v_max3_u32 v77, v198, v199, v77
    v_max3_u32 v77, v200, v201, v77
    v_max3_u32 v77, v202, v203, v77
    v_max3_u32 v77, v204, v205, v77
    v_max3_u32 v77, v206, v207, v77
    v_max3_u32 v77, v208, v209, v77
    v_max3_u32 v77, v210, v211, v77
    v_max3_u32 v77, v212, v213, v77
    v_max3_u32 v77, v214, v215, v77
    v_max3_u32 v77, v216, v217, v77
    v_max3_u32 v77, v218, v219, v77
    v_max3_u32 v77, v220, v221, v77
    v_max3_u32 v77, v222, v223, v77
    v_cmp_eq_u32 vcc, -1, v77
    s_add_u32 s82, s82, 1
    s_cmp_eq_u64 vcc, 0
    s_cbranch_scc1 Lok_88
    s_cmp_ge_u32 s82, 200000
    s_cbranch_scc1 LEND
    s_add_u32 s80, s71, 0
    buffer_load_dwordx4 v[192:195], v37, s[4:7], s80 offen sc1
    s_add_u32 s80, s71, 3584
    buffer_load_dwordx4 v[196:199], v37, s[4:7], s80 offen sc1
    s_add_u32 s80, s71, 7168
    buffer_load_dwordx4 v[200:203], v37, s[4:7], s80 offen sc1
    s_add_u32 s80, s71, 10752
    buffer_load_dwordx4 v[204:207], v37, s[4:7], s80 offen sc1
    s_add_u32 s80, s71, 14336
    buffer_load_dwordx4 v[208:211], v37, s[4:7], s80 offen sc1
    s_add_u32 s80, s71, 17920
    buffer_load_dwordx4 v[212:215], v37, s[4:7], s80 offen sc1
    s_add_u32 s80, s71, 21504
    buffer_load_dwordx4 v[216:219], v37, s[4:7], s80 offen sc1
    s_add_u32 s80, s71, 25088
    buffer_load_dwordx4 v[220:223], v37, s[4:7], s80 offen sc1
    s_waitcnt vmcnt(0)
    s_branch Lchk_87
Lok_88:
    v_mov_b32 v48, 0x3f80
    v_mov_b32 v49, 0x3f800000
    v_lshlrev_b32 v40, 16, v192
    v_and_b32 v41, 0xffff0000, v192
    v_lshlrev_b32 v42, 16, v193
    v_and_b32 v43, 0xffff0000, v193
    v_lshlrev_b32 v44, 16, v194
    v_and_b32 v45, 0xffff0000, v194
    v_lshlrev_b32 v46, 16, v195
    v_and_b32 v47, 0xffff0000, v195
    v_dot2c_f32_bf16 v40, v196, v48
    v_dot2c_f32_bf16 v41, v196, v49
    v_dot2c_f32_bf16 v42, v197, v48
    v_dot2c_f32_bf16 v43, v197, v49
    v_dot2c_f32_bf16 v44, v198, v48
    v_dot2c_f32_bf16 v45, v198, v49
    v_dot2c_f32_bf16 v46, v199, v48
    v_dot2c_f32_bf16 v47, v199, v49
    v_dot2c_f32_bf16 v40, v200, v48
    v_dot2c_f32_bf16 v41, v200, v49
    v_dot2c_f32_bf16 v42, v201, v48
    v_dot2c_f32_bf16 v43, v201, v49
    v_dot2c_f32_bf16 v44, v202, v48
    v_dot2c_f32_bf16 v45, v202, v49
    v_dot2c_f32_bf16 v46, v203, v48
    v_dot2c_f32_bf16 v47, v203, v49
    v_dot2c_f32_bf16 v40, v204, v48
    v_dot2c_f32_bf16 v41, v204, v49
    v_dot2c_f32_bf16 v42, v205, v48
    v_dot2c_f32_bf16 v43, v205, v49
    v_dot2c_f32_bf16 v44, v206, v48
    v_dot2c_f32_bf16 v45, v206, v49
    v_dot2c_f32_bf16 v46, v207, v48
    v_dot2c_f32_bf16 v47, v207, v49
    v_dot2c_f32_bf16 v40, v208, v48
    v_dot2c_f32_bf16 v41, v208, v49
    v_dot2c_f32_bf16 v42, v209, v48
    v_dot2c_f32_bf16 v43, v209, v49
    v_dot2c_f32_bf16 v44, v210, v48
    v_dot2c_f32_bf16 v45, v210, v49
    v_dot2c_f32_bf16 v46, v211, v48
    v_dot2c_f32_bf16 v47, v211, v49
    v_dot2c_f32_bf16 v40, v212, v48
    v_dot2c_f32_bf16 v41, v212, v49
    v_dot2c_f32_bf16 v42, v213, v48
    v_dot2c_f32_bf16 v43, v213, v49
    v_dot2c_f32_bf16 v44, v214, v48
    v_dot2c_f32_bf16 v45, v214, v49
    v_dot2c_f32_bf16 v46, v215, v48
    v_dot2c_f32_bf16 v47, v215, v49
    v_dot2c_f32_bf16 v40, v216, v48
    v_dot2c_f32_bf16 v41, v216, v49
    v_dot2c_f32_bf16 v42, v217, v48
    v_dot2c_f32_bf16 v43, v217, v49
    v_dot2c_f32_bf16 v44, v218, v48
    v_dot2c_f32_bf16 v45, v218, v49
    v_dot2c_f32_bf16 v46, v219, v48
    v_dot2c_f32_bf16 v47, v219, v49
    v_dot2c_f32_bf16 v40, v220, v48
    v_dot2c_f32_bf16 v41, v220, v49
    v_dot2c_f32_bf16 v42, v221, v48
    v_dot2c_f32_bf16 v43, v221, v49
    v_dot2c_f32_bf16 v44, v222, v48
    v_dot2c_f32_bf16 v45, v222, v49
    v_dot2c_f32_bf16 v46, v223, v48
    v_dot2c_f32_bf16 v47, v223, v49
    v_permlane32_swap_b32 v40, v44
    v_permlane32_swap_b32 v41, v45
    v_permlane32_swap_b32 v42, v46
    v_permlane32_swap_b32 v43, v47
    v_pk_add_f32 v[40:41], v[40:41], v[44:45] op_sel:[0,0] op_sel_hi:[1,1]
    v_pk_add_f32 v[42:43], v[42:43], v[46:47] op_sel:[0,0] op_sel_hi:[1,1]
    s_mov_b32 exec_lo, 0x7ffffff
    s_mov_b32 exec_hi, 0x7ffffff
    ds_write_b128 v39, v[40:43]
    s_mov_b64 exec, -1
    s_waitcnt lgkmcnt(0)
    s_barrier
    ds_read_b128 v[96:99], v32
    ds_read_b128 v[100:103], v33
    ds_read_b128 v[104:107], v34
    ds_read_b128 v[108:111], v35
    ds_read_b128 v[80:83], v28
    ds_read_b128 v[84:87], v29
    ds_read_b128 v[88:91], v30
    ds_read_b128 v[92:95], v31
    s_waitcnt lgkmcnt(4)
    v_cvt_pk_bf16_f32 v120, v96, v97
    v_cvt_pk_bf16_f32 v121, v98, v99
    v_cvt_pk_bf16_f32 v122, v100, v101
    v_cvt_pk_bf16_f32 v123, v102, v103
    v_cvt_pk_bf16_f32 v124, v104, v105
    v_cvt_pk_bf16_f32 v125, v106, v107
    v_cvt_pk_bf16_f32 v126, v108, v109
    v_cvt_pk_bf16_f32 v127, v110, v111
    v_mfma_f32_16x16x32_bf16 v[196:199], v[120:123], v[144:147], 0
    s_nop 0
    v_mfma_f32_16x16x32_bf16 v[204:207], v[124:127], v[146:149], 0
    v_mfma_f32_16x16x32_bf16 v[212:215], v[120:123], v[150:153], 0
    v_mfma_f32_16x16x32_bf16 v[220:223], v[124:127], v[152:155], 0
    s_waitcnt lgkmcnt(0)
    v_cvt_pk_bf16_f32 v112, v80, v81
    v_cvt_pk_bf16_f32 v113, v82, v83
    v_cvt_pk_bf16_f32 v114, v84, v85
    v_cvt_pk_bf16_f32 v115, v86, v87
    v_cvt_pk_bf16_f32 v116, v88, v89
    v_cvt_pk_bf16_f32 v117, v90, v91
    v_cvt_pk_bf16_f32 v118, v92, v93
    v_cvt_pk_bf16_f32 v119, v94, v95
    v_mfma_f32_16x16x32_bf16 v[192:195], v[112:115], v[144:147], 0
    s_nop 0
    v_mfma_f32_16x16x32_bf16 v[200:203], v[116:119], v[146:149], 0
    v_mfma_f32_16x16x32_bf16 v[208:211], v[112:115], v[150:153], 0
    v_mfma_f32_16x16x32_bf16 v[216:219], v[116:119], v[152:155], 0
    v_add_f32 v197, v19, v197
    v_add_f32 v205, v19, v205
    v_add_f32 v213, v19, v213
    v_add_f32 v221, v19, v221
    v_rcp_f32 v197, v197
    v_rcp_f32 v205, v205
    v_rcp_f32 v213, v213
    v_rcp_f32 v221, v221
    v_pk_mul_f32 v[192:193], v[192:193], v[196:197] op_sel:[0,1] op_sel_hi:[1,1]
    v_pk_mul_f32 v[194:195], v[194:195], v[196:197] op_sel:[0,1] op_sel_hi:[1,1]
    v_mul_f32 v196, v196, v197
    v_pk_mul_f32 v[200:201], v[200:201], v[204:205] op_sel:[0,1] op_sel_hi:[1,1]
    v_pk_mul_f32 v[202:203], v[202:203], v[204:205] op_sel:[0,1] op_sel_hi:[1,1]
    v_mul_f32 v204, v204, v205
    v_cvt_pk_bf16_f32 v40, v192, v193
    v_cvt_pk_bf16_f32 v41, v194, v195
    v_cvt_pk_bf16_f32 v42, v196, v200
    v_cvt_pk_bf16_f32 v43, v201, v202
    v_cvt_pk_bf16_f32 v44, v203, v204
    s_add_u32 s60, s62, 0
    s_cmp_eq_u32 s47, 0
    s_cbranch_scc1 Lsfast_89
    buffer_store_dwordx4 v[40:43], v26, s[4:7], s60 offen sc1
    buffer_store_dword v44, v27, s[4:7], s60 offen sc1
    s_branch Lsdone_90
Lsfast_89:
    buffer_store_dwordx4 v[40:43], v26, s[4:7], s60 offen
    buffer_store_dword v44, v27, s[4:7], s60 offen
Lsdone_90:
    v_pk_mul_f32 v[208:209], v[208:209], v[212:213] op_sel:[0,1] op_sel_hi:[1,1]
    v_pk_mul_f32 v[210:211], v[210:211], v[212:213] op_sel:[0,1] op_sel_hi:[1,1]
    v_mul_f32 v212, v212, v213
    v_pk_mul_f32 v[216:217], v[216:217], v[220:221] op_sel:[0,1] op_sel_hi:[1,1]
    v_pk_mul_f32 v[218:219], v[218:219], v[220:221] op_sel:[0,1] op_sel_hi:[1,1]
    v_mul_f32 v220, v220, v221
    v_cvt_pk_bf16_f32 v46, v208, v209
    v_cvt_pk_bf16_f32 v47, v210, v211
    v_cvt_pk_bf16_f32 v48, v212, v216
    v_cvt_pk_bf16_f32 v49, v217, v218
    v_cvt_pk_bf16_f32 v50, v219, v220
    s_add_u32 s60, s62, 24576
    s_cmp_eq_u32 s47, 0
    s_cbranch_scc1 Lsfast_91
    buffer_store_dwordx4 v[46:49], v26, s[4:7], s60 offen sc1
    buffer_store_dword v50, v27, s[4:7], s60 offen sc1
    s_branch Lsdone_92
Lsfast_91:
    buffer_store_dwordx4 v[46:49], v26, s[4:7], s60 offen
    buffer_store_dword v50, v27, s[4:7], s60 offen
Lsdone_92:
    s_add_u32 s80, s95, 98304
    s_add_u32 m0, s81, 16384
    s_nop 0
    buffer_load_dwordx4 v1, s[4:7], s80 offen sc1 lds
    s_add_u32 s80, s96, 0
    s_add_u32 m0, s81, 20480
    s_nop 0
    buffer_load_dwordx4 v1, s[4:7], s80 offen sc1 lds
    s_add_u32 s80, s96, 4096
    s_add_u32 m0, s81, 24576
    s_nop 0
    buffer_load_dwordx4 v1, s[4:7], s80 offen sc1 lds
    s_add_u32 s80, s96, 8192
    s_add_u32 m0, s81, 28672
    s_nop 0
    buffer_load_dwordx4 v1, s[4:7], s80 offen sc1 lds
    s_add_u32 s80, s96, 12288
    s_add_u32 m0, s81, 32768
    s_nop 0
    buffer_load_dwordx4 v1, s[4:7], s80 offen sc1 lds
    s_add_u32 s80, s96, 16384
    s_add_u32 m0, s81, 36864
    s_nop 0
    buffer_load_dwordx4 v1, s[4:7], s80 offen sc1 lds
    s_waitcnt vmcnt(6)
    v_mov_b32 v24, s50
    v_mov_b32 v25, 0
    s_mov_b64 exec, 1
    s_cmp_eq_u32 s47, 0
    s_cbranch_scc1 Lsfast_93
    buffer_store_dword v24, v25, s[4:7], s63 offen sc1
    s_branch Lsdone_94
Lsfast_93:
    buffer_store_dword v24, v25, s[4:7], s63 offen
Lsdone_94:
    s_mov_b64 exec, -1
    s_add_u32 s80, s96, 20480
    s_add_u32 m0, s81, 40960
    s_nop 0
    buffer_load_dwordx4 v1, s[4:7], s80 offen sc1 lds
    s_branch LP2
LFIN:
LEND:
    s_endpgm
LCODE_END:
.fill 64, 4, 0xbf800000
.section .rodata,"a"
.p2align 6
.amdhsa_kernel interleave_layers__linear_attn_block__mixer_gmlp__prompt_kernel
  .amdhsa_next_free_vgpr 512
  .amdhsa_next_free_sgpr 102
  .amdhsa_accum_offset 256
  .amdhsa_group_segment_fixed_size 0
  .amdhsa_kernarg_size 88
  .amdhsa_user_sgpr_count 2
  .amdhsa_user_sgpr_kernarg_segment_ptr 1
  .amdhsa_system_sgpr_workgroup_id_x 1
.end_amdhsa_kernel
```
